```python
import torch

def _softmax(x, axis=-1):
    return torch.softmax(x, dim=axis)

def _gelu(x):
    return torch.nn.functional.gelu(x, approximate='tanh')

def _silu(x):
    return torch.nn.functional.silu(x)

def _sigmoid(x):
    return torch.sigmoid(x)

def _layernorm(x, axis=-1, eps=1e-05):
    m = x.mean(dim=axis, keepdim=True)
    v = x.var(dim=axis, keepdim=True, unbiased=False)
    return (x - m) / torch.sqrt(v + eps)

def _scatter_add(tgt, idx, src, axis=0):
    return tgt.clone().index_add_(axis, idx, src)

def _segment_sum(src, seg, n):
    out = torch.zeros((n,) + src.shape[1:], dtype=src.dtype)
    return out.index_add_(0, seg, src)

def _pad(x, pw):
    flat = tuple((v for pair in reversed(pw) for v in pair))
    return torch.nn.functional.pad(x, flat)
kernel_name = 'adaLN_cond__sliding_block__glu_gated_geglu__prompt'

def setup_inputs():

    _w = lambda a: (lambda t: t.to(torch.bfloat16) if t.is_floating_point() else t)(torch.as_tensor(a))

    def _A_setup():
        B, S, D = (1, 2048, 640)
        return {'x': _w((lambda *s: torch.randn(*s, dtype=torch.bfloat16) * 0.05)(B, S, D)), 'wqkv': _w((lambda *s: torch.randn(*s, dtype=torch.bfloat16) * 0.05)(D, 3 * D)), 'wo': _w((lambda *s: torch.randn(*s, dtype=torch.bfloat16) * 0.05)(D, D))}
    _A_in = _A_setup()

    def _B_setup():
        B, S, Dm, Df = (1, 2048, 640, 1536)
        return {'x': _w((lambda *s: torch.randn(*s, dtype=torch.bfloat16) * 0.05)(B, S, Dm)), 'w_gate': _w((lambda *s: torch.randn(*s, dtype=torch.bfloat16) * 0.8)(Dm, Df) * Dm ** (-0.5)), 'w_up': _w((lambda *s: torch.randn(*s, dtype=torch.bfloat16) * 0.8)(Dm, Df) * Dm ** (-0.5)), 'w_down': _w((lambda *s: torch.randn(*s, dtype=torch.bfloat16) * 0.8)(Df, Dm) * Df ** (-0.5))}
    _B_in = _B_setup()
    return {'A_x': _A_in['x'], 'A_wqkv': _A_in['wqkv'], 'A_wo': _A_in['wo'], 'B_x': _B_in['x'], 'B_w_gate': _B_in['w_gate'], 'B_w_up': _B_in['w_up'], 'B_w_down': _B_in['w_down'], 'c': _w((lambda *s: torch.randn(*s, dtype=torch.bfloat16) * 0.2)(1, 640) * 8.0), 'w_mod': _w((lambda *s: torch.randn(*s, dtype=torch.bfloat16) * 0.2)(640, 6 * 640) * 640 ** (-0.5) * 8.0)}

def reference(A_x, A_wqkv, A_wo, B_x, B_w_gate, B_w_up, B_w_down, c, w_mod):

    def _A_ref(x, wqkv, wo):
        B, S, D = x.shape
        H = 32
        Dh = D // H
        W = 256
        qkv = (lambda x, *d: x.permute(*d))((x @ wqkv).reshape(B, S, 3, H, Dh), 2, 0, 3, 1, 4)
        q, k, v = (qkv[0], qkv[1], qkv[2])
        scores = torch.einsum('bhqd,bhkd->bhqk', q, k) * Dh ** (-0.5)
        idx = torch.arange(S)
        mask = (idx[:, None] - idx[None, :] >= 0) & (idx[:, None] - idx[None, :] < W)
        scores = torch.where(mask[None, None], scores, -1000000000.0)
        p = _softmax(scores, axis=-1)
        o = torch.einsum('bhqk,bhkd->bhqd', p, v)
        return (lambda x, *d: x.permute(*d))(o, 0, 2, 1, 3).reshape(B, S, D) @ wo

    def _B_ref(x, w_gate, w_up, w_down):
        g = torch.einsum('bsd,df->bsf', x, w_gate)
        u = torch.einsum('bsd,df->bsf', x, w_up)
        h = _gelu(g) * u
        return torch.einsum('bsf,fd->bsd', h, w_down)
    x = A_x
    mod = (_silu(c) @ w_mod).reshape(c.shape[0], 6, 1, -1)
    sa, ca, ga, sb, cb, gb = (mod[:, 0].clone(), mod[:, 1].clone(), mod[:, 2].clone(), mod[:, 3].clone(), mod[:, 4].clone(), mod[:, 5].clone())
    h = _layernorm(x, axis=-1) * (1 + ca) + sa
    x = x + ga * _A_ref(h, A_wqkv, A_wo)
    h = _layernorm(x, axis=-1) * (1 + cb) + sb
    x = x + gb * _B_ref(h, B_w_gate, B_w_up, B_w_down)
    return x
```

```asm
; @launch grid=(256,1,1) block=(256,1,1) lds=163840
.amdgcn_target "amdgcn-amd-amdhsa--gfx950"
.text
.globl adaLN_cond__sliding_block__glu_gated_geglu__prompt_kernel
.p2align 8
.type adaLN_cond__sliding_block__glu_gated_geglu__prompt_kernel,@function
adaLN_cond__sliding_block__glu_gated_geglu__prompt_kernel:
    s_load_dwordx8 s[64:71], s[0:1], 64
    s_load_dwordx16 s[48:63], s[0:1], 0
    s_cmp_ge_u32 s2, 256
    s_cbranch_scc1 .Lend
    s_getpc_b64 s[44:45]
.Lpc0:
    v_mov_b32 v37, v0
    s_bfe_u32 s72, s2, 0x30003
    v_lshrrev_b32 v2, 2, v37
    v_lshl_add_u32 v2, s72, 6, v2
    v_lshlrev_b32 v2, 7, v2
    v_min_u32 v2, .Lcode_end-.Lpc0-4, v2
    global_load_dword v199, v2, s[44:45] sc0 sc1
    v_lshrrev_b32 v2, 6, v37
    v_and_b32 v3, 63, v37
    v_readfirstlane_b32 s3, v2
    s_mov_b32 s34, 4915200
    s_mov_b32 s35, 0x20000
    s_movk_i32 s30, 1280
    s_mov_b32 s31, 0x20000
    s_sub_u32 s74, s2, 16
    s_cmp_lt_u32 s2, 240
    s_cselect_b32 s74, s2, s74
    s_lshr_b32 s75, s74, 2
    s_and_b32 s76, s74, 3
    v_lshrrev_b32 v6, 3, v3
    v_and_b32 v7, 7, v3
    v_lshlrev_b32 v7, 4, v7
    s_movk_i32 s72, 7680
    v_mad_u32_u24 v39, v6, s72, v7
    s_mul_i32 s77, s76, 160
    s_lshl3_add_u32 s77, s3, s77
    s_mul_i32 s77, s77, 7680
    s_lshl_b32 s72, s75, 7
    s_add_u32 s77, s77, s72
    v_min_u32 v9, 79, v37
    v_lshlrev_b32 v9, 2, v9
    s_mul_i32 s79, s76, 320
    s_waitcnt lgkmcnt(0)
    s_mov_b64 s[32:33], s[64:65]
    s_mov_b64 s[28:29], s[62:63]
    s_load_dword s42, s[70:71], 0
    buffer_load_dword v10, v9, s[28:31], s79 offen sc0 sc1
    s_mov_b32 s95, s77
    s_lshl_b32 s72, s3, 10
    s_add_u32 m0, s72, 0
    s_nop 0
    buffer_load_dwordx4 v39, s[32:35], s95 offen sc1 nt lds
    s_add_u32 s95, s95, 245760
    s_add_u32 m0, m0, 4096
    s_nop 0
    buffer_load_dwordx4 v39, s[32:35], s95 offen sc1 nt lds
    s_add_u32 s95, s95, 245760
    s_add_u32 m0, m0, 4096
    s_nop 0
    buffer_load_dwordx4 v39, s[32:35], s95 offen sc1 nt lds
    s_add_u32 s95, s95, 245760
    s_add_u32 m0, m0, 4096
    s_nop 0
    buffer_load_dwordx4 v39, s[32:35], s95 offen sc1 nt lds
    s_add_u32 s95, s95, 245760
    s_add_u32 m0, m0, 4096
    s_nop 0
    buffer_load_dwordx4 v39, s[32:35], s95 offen sc1 nt lds
    s_mov_b64 s[4:5], s[70:71]
    s_mov_b32 s6, 32505856
    s_mov_b32 s7, 0x20000
    s_mov_b64 s[8:9], s[48:49]
    s_mov_b32 s10, 2621440
    s_mov_b32 s11, 0x20000
    s_mov_b64 s[12:13], s[50:51]
    s_mov_b32 s14, 2457600
    s_mov_b32 s15, 0x20000
    s_mov_b64 s[20:21], s[56:57]
    s_mov_b32 s22, 1966080
    s_mov_b32 s23, 0x20000
    s_mov_b64 s[24:25], s[58:59]
    s_mov_b32 s26, 1966080
    s_mov_b32 s27, 0x20000
    s_mov_b64 s[36:37], s[66:67]
    s_mov_b32 s38, 2621440
    s_mov_b32 s39, 0x20000
    s_mov_b32 s19, 0x20000
    s_and_b32 s72, s2, 7
    s_lshr_b32 s73, s2, 3
    s_and_b32 s41, s73, 15
    s_lshr_b32 s73, s73, 4
    s_lshl1_add_u32 s40, s72, s73
    s_and_b32 s46, s41, 7
    s_lshr_b32 s47, s41, 3
    v_lshlrev_b32 v1, 4, v3
    v_mov_b32 v2, 1073741824
    s_mul_i32 s80, s74, 171
    s_lshr_b32 s80, s80, 9
    s_mul_i32 s81, s80, 3
    s_sub_u32 s81, s74, s81
    s_movk_i32 s72, 3840
    v_mad_u32_u24 v8, v6, s72, v7
    s_mul_i32 s77, s80, 30720
    s_mul_i32 s72, s81, 1280
    s_add_u32 s77, s77, s72
    s_mul_i32 s78, s3, 3072
    s_add_u32 m0, s78, 20480
    s_add_u32 s82, s3, 8
    s_min_u32 s82, s82, 9
    s_lshl_b32 s72, s3, 7
    s_add_u32 s72, s72, s77
    buffer_load_dwordx4 v8, s[12:15], s72 offen sc1 nt lds
    s_add_u32 s72, s72, 512
    s_add_u32 m0, m0, 1024
    s_nop 0
    buffer_load_dwordx4 v8, s[12:15], s72 offen sc1 nt lds
    s_lshl_b32 s72, s82, 7
    s_add_u32 s72, s72, s77
    s_add_u32 m0, m0, 1024
    s_nop 0
    buffer_load_dwordx4 v8, s[12:15], s72 offen sc1 nt lds
    v_mul_u32_u24 v36, 80, v7
    v_lshl_add_u32 v36, v6, 4, v36
    v_cmp_gt_u32 vcc, 32, v3
    s_nop 1
    v_cndmask_b32 v38, v2, v36, vcc
    s_lshl4_add_u32 s72, s40, s41
    s_mul_i32 s72, s72, 10240
    s_mul_i32 s73, s3, 320
    s_add_u32 s72, s72, s73
    buffer_load_dwordx4 v[24:27], v36, s[8:11], s72 offen sc0 sc1
    buffer_load_dwordx4 v[28:31], v36, s[8:11], s72 offen offset:128 sc0 sc1
    buffer_load_dwordx4 v[32:35], v38, s[8:11], s72 offen offset:256 sc0 sc1
    s_branch .Lpage0
.p2align 12
.Lpage0:
    s_lshl2_add_u32 s72, s41, s3
    s_lshl_b32 s72, s72, 2
    v_mov_b32 v4, s72
    v_cmp_eq_u32 vcc, 0, v3
    s_nop 1
    v_cndmask_b32 v4, v2, v4, vcc
    v_cmp_eq_u32 vcc, 0, v37
    s_nop 1
    v_cndmask_b32 v12, v2, 0, vcc
    v_bfe_u32 v13, v3, 2, 2
    v_lshlrev_b32 v13, 7, v13
    v_and_b32 v14, 3, v3
    v_lshl_add_u32 v15, v14, 3, v13
    v_lshrrev_b32 v16, 4, v3
    v_lshl_add_u32 v17, v16, 10, v15
    s_lshl_b32 s72, s3, 5
    v_add_u32 v17, s72, v17
    v_lshlrev_b32 v18, 4, v16
    v_lshl_add_u32 v19, v16, 5, v15
    v_lshlrev_b32 v15, 6, v16
    v_and_b32 v76, 15, v3
    v_cmp_eq_u32 vcc, 0, v76
    s_nop 1
    v_cndmask_b32 v15, v2, v15, vcc
    s_cmp_ge_u32 s2, 240
    s_cselect_b32 s72, 1073741824, 0
    v_or_b32 v15, s72, v15
    s_lshl2_add_u32 s96, s75, s3
    s_lshl_b32 s96, s96, 8
    s_lshl4_add_u32 s96, s76, s96
    s_add_u32 s96, s96, 65536
    s_mov_b32 s18, 819200
    s_mov_b32 s55, 108800
    s_movk_i32 s73, 3277
    s_mov_b32 s54, 3932160
    s_cmp_lt_u32 s2, 192
    s_cselect_b64 s[16:17], s[60:61], s[52:53]
    s_cmov_b32 s18, 1966080
    s_cmov_b32 s55, 252160
    s_cmov_b32 s73, 1366
    s_cmov_b32 s54, 9437184
    s_cselect_b32 s72, 0, 192
    s_sub_u32 s77, s2, s72
    s_mul_i32 s73, s73, s77
    s_lshr_b32 s73, s73, 16
    s_mul_i32 s73, s73, 1280
    s_add_u32 s54, s54, s73
    s_lshr_b32 s72, s77, 2
    s_mul_i32 s72, s72, 5120
    s_add_u32 s54, s54, s72
    s_and_b32 s72, s77, 3
    s_lshl_b32 s72, s72, 8
    s_add_u32 s54, s54, s72
    s_mul_i32 s72, s77, 205
    s_lshr_b32 s72, s72, 10
    s_mul_i32 s73, s72, 5
    s_sub_u32 s73, s77, s73
    s_mul_i32 s72, s72, 40
    s_lshr_b32 s78, s73, 1
    s_mul_i32 s78, s78, 20
    s_and_b32 s79, s73, 1
    s_lshl2_add_u32 s78, s79, s78
    s_cmp_eq_u32 s73, 4
    s_cselect_b32 s78, 16, s78
    s_cselect_b32 s79, 20, 8
    s_add_u32 s72, s72, s78
    s_lshl_b32 s77, s77, 3
    s_cmp_lt_u32 s2, 192
    s_cselect_b32 s77, s77, s72
    s_cselect_b32 s79, 4, s79
    s_mul_i32 s77, s77, 1280
    v_lshrrev_b32 v76, 5, v3
    v_and_b32 v77, 3, v6
    v_mad_u32_u24 v76, v76, s79, v77
    s_movk_i32 s72, 1280
    v_mad_u32_u24 v38, v76, s72, v7
    s_sub_u32 s72, 3, s3
    s_lshl_b32 s72, s72, 7
    s_add_u32 s66, s72, s77
    s_add_u32 s48, s2, 16
    s_mov_b32 s57, 108800
    s_movk_i32 s73, 3277
    s_mov_b32 s56, 3932160
    s_cmp_lt_u32 s48, 192
    s_cmov_b32 s57, 252160
    s_cmov_b32 s73, 1366
    s_cmov_b32 s56, 9437184
    s_cselect_b32 s72, 0, 192
    s_sub_u32 s77, s48, s72
    s_mul_i32 s73, s73, s77
    s_lshr_b32 s73, s73, 16
    s_mul_i32 s73, s73, 1280
    s_add_u32 s56, s56, s73
    s_lshr_b32 s72, s77, 2
    s_mul_i32 s72, s72, 5120
    s_add_u32 s56, s56, s72
    s_and_b32 s72, s77, 3
    s_lshl_b32 s72, s72, 8
    s_add_u32 s56, s56, s72
    s_mul_i32 s72, s77, 205
    s_lshr_b32 s72, s72, 10
    s_mul_i32 s73, s72, 5
    s_sub_u32 s73, s77, s73
    s_mul_i32 s72, s72, 40
    s_lshr_b32 s78, s73, 1
    s_mul_i32 s78, s78, 20
    s_and_b32 s79, s73, 1
    s_lshl2_add_u32 s78, s79, s78
    s_cmp_eq_u32 s73, 4
    s_cselect_b32 s78, 16, s78
    s_cselect_b32 s79, 20, 8
    s_add_u32 s72, s72, s78
    s_lshl_b32 s77, s77, 3
    s_cmp_lt_u32 s48, 192
    s_cselect_b32 s77, s77, s72
    s_cselect_b32 s79, 4, s79
    s_mul_i32 s77, s77, 1280
    v_lshrrev_b32 v76, 5, v3
    v_and_b32 v77, 3, v6
    v_mad_u32_u24 v76, v76, s79, v77
    s_movk_i32 s72, 1280
    v_mad_u32_u24 v39, v76, s72, v7
    s_sub_u32 s72, 3, s3
    s_lshl_b32 s72, s72, 7
    s_add_u32 s67, s72, s77
    s_movk_i32 s72, 3072
    v_mad_u32_u24 v36, v6, s72, v7
    s_mul_i32 s65, s80, 24576
    s_lshl_b32 s72, s81, 10
    s_add_u32 s65, s65, s72
    s_lshl_b32 s72, s3, 7
    s_add_u32 s65, s65, s72
    s_lshr_b32 s72, s80, 2
    s_mul_i32 s97, s72, 5120
    s_mul_i32 s72, s72, 3072
    s_add_u32 s72, s72, 102400
    s_cmp_eq_u32 s81, 0
    s_cmov_b32 s97, s72
    s_and_b32 s72, s80, 3
    s_lshl_b32 s72, s72, 8
    s_add_u32 s97, s97, s72
    s_add_u32 s97, s97, 1048576
    s_cmp_eq_u32 s81, 2
    s_cselect_b32 s77, 192, 0
    s_movk_i32 s78, 112
    s_cmov_b32 s78, 116
    s_mov_b32 s79, 170240
    s_lshl_b32 s72, s3, 6
    v_add_u32 v76, s72, v3
    v_mul_u32_u24 v77, 205, v76
    v_lshrrev_b32 v77, 12, v77
    v_mul_u32_u24 v78, 20, v77
    v_sub_u32 v76, v76, v78
    v_and_b32 v78, 1, v77
    v_lshrrev_b32 v77, 1, v77
    v_lshl_add_u32 v79, v78, 6, s77
    v_lshl_add_u32 v78, v78, 3, s78
    v_cmp_gt_u32 vcc, 16, v76
    s_nop 1
    v_cndmask_b32 v78, v78, v79, vcc
    v_add_lshl_u32 v76, v76, v78, 4
    v_mad_u32_u24 v20, v77, s79, v76
    v_cndmask_b32 v160, 0, v2, vcc
    s_lshl_b32 s72, s3, 6
    s_add_u32 s72, s72, 256
    v_add_u32 v76, s72, v3
    v_mul_u32_u24 v77, 205, v76
    v_lshrrev_b32 v77, 12, v77
    v_mul_u32_u24 v78, 20, v77
    v_sub_u32 v76, v76, v78
    v_and_b32 v78, 1, v77
    v_lshrrev_b32 v77, 1, v77
    v_lshl_add_u32 v79, v78, 6, s77
    v_lshl_add_u32 v78, v78, 3, s78
    v_cmp_gt_u32 vcc, 16, v76
    s_nop 1
    v_cndmask_b32 v78, v78, v79, vcc
    v_add_lshl_u32 v76, v76, v78, 4
    v_mad_u32_u24 v21, v77, s79, v76
    v_cndmask_b32 v161, 0, v2, vcc
    s_lshl_b32 s72, s82, 6
    v_add_u32 v76, s72, v3
    v_mul_u32_u24 v77, 205, v76
    v_lshrrev_b32 v77, 12, v77
    v_mul_u32_u24 v78, 20, v77
    v_sub_u32 v76, v76, v78
    v_and_b32 v78, 1, v77
    v_lshrrev_b32 v77, 1, v77
    v_lshl_add_u32 v79, v78, 6, s77
    v_lshl_add_u32 v78, v78, 3, s78
    v_cmp_gt_u32 vcc, 16, v76
    s_nop 1
    v_cndmask_b32 v78, v78, v79, vcc
    v_add_lshl_u32 v76, v76, v78, 4
    v_mad_u32_u24 v22, v77, s79, v76
    v_cndmask_b32 v162, 0, v2, vcc
    s_cmp_ge_u32 s3, 2
    s_cselect_b32 s72, 1073741824, 0
    v_or_b32 v22, s72, v22
    s_cmp_ge_u32 s2, 240
    s_cselect_b32 s72, 1073741824, 0
    v_or_b32 v20, s72, v20
    v_or_b32 v21, s72, v21
    v_or_b32 v22, s72, v22
    s_cmp_lg_u32 s81, 0
    s_cselect_b32 s72, 1073741824, 0
    v_or3_b32 v160, v160, s72, v20
    v_or3_b32 v161, v161, s72, v21
    v_or3_b32 v162, v162, s72, v22
    s_lshl2_add_u32 s84, s41, s3
    s_mul_i32 s84, s84, 62720
    s_add_u32 s84, s84, 4980736
    s_mul_i32 s85, s46, 108800
    s_mul_i32 s72, s3, 26880
    s_add_u32 s85, s85, s72
    s_add_u32 s85, s85, 3932160
    s_lshl2_add_u32 s89, s40, s3
    s_lshl1_add_u32 s90, s89, s47
    s_mul_i32 s90, s90, 20480
    s_mul_i32 s72, s46, 160
    s_add_u32 s90, s90, s72
    s_mul_i32 s89, s89, 40960
    s_add_u32 s89, s89, 11796480
    s_mul_i32 s92, s41, 170240
    s_add_u32 s92, s92, 1048576
    s_mul_i32 s70, s3, 5120
    s_add_u32 s71, s92, s70
    s_lshr_b32 s58, s80, 2
    s_mul_i32 s58, s58, 3072
    s_and_b32 s72, s80, 3
    s_lshl_b32 s72, s72, 8
    s_add_u32 s58, s58, s72
    s_add_u32 s58, s58, 4980736
    s_lshl_b32 s64, s81, 6
    s_lshl3_add_u32 s64, s3, s64
    s_cmp_ge_u32 s2, 240
    s_cselect_b32 s59, 1073741824, 0
    v_lshrrev_b32 v250, 1, v14
    v_lshl_add_u32 v250, v250, 3, v13
    v_and_b32 v252, 1, v14
    v_lshl_add_u32 v250, v252, 10, v250
    v_add_u32 v250, v250, v18
    s_lshl_b32 s77, s3, 12
    s_add_u32 s77, s77, 45056
    v_add_u32 v250, s77, v250
    s_sub_u32 s78, 3, s3
    s_lshl_b32 s78, s78, 10
    s_add_u32 s78, s78, 45056
    v_add_u32 v251, s78, v19
    v_and_b32 v252, 9, v3
    v_bfe_u32 v253, v3, 1, 1
    v_lshl_add_u32 v252, v253, 2, v252
    v_bfe_u32 v253, v3, 2, 1
    v_lshl_add_u32 v252, v253, 1, v252
    v_lshlrev_b32 v252, 4, v252
    v_or_b32 v252, s59, v252
    s_mov_b32 s73, 59648
    s_add_u32 s77, s64, 0
    v_add_u32 v253, s77, v16
    v_mul_u32_u24 v254, 171, v253
    v_lshrrev_b32 v254, 9, v254
    v_lshl_add_u32 v253, v253, 10, v252
    v_mad_u32_u24 v240, v254, s73, v253
    s_add_u32 s77, s64, 4
    v_add_u32 v253, s77, v16
    v_mul_u32_u24 v254, 171, v253
    v_lshrrev_b32 v254, 9, v254
    v_lshl_add_u32 v253, v253, 10, v252
    v_mad_u32_u24 v241, v254, s73, v253
    s_add_u32 s77, s64, 32
    v_add_u32 v253, s77, v16
    v_mul_u32_u24 v254, 171, v253
    v_lshrrev_b32 v254, 9, v254
    v_lshl_add_u32 v253, v253, 10, v252
    v_mad_u32_u24 v242, v254, s73, v253
    s_add_u32 s77, s64, 36
    v_add_u32 v253, s77, v16
    v_mul_u32_u24 v254, 171, v253
    v_lshrrev_b32 v254, 9, v254
    v_lshl_add_u32 v253, v253, 10, v252
    v_mad_u32_u24 v243, v254, s73, v253
    s_cmp_lt_u32 s3, 2
    s_cselect_b32 s79, 1073741824, 0
    s_sub_u32 s78, 3, s3
    s_lshl_b32 s78, s78, 6
    v_add_u32 v252, s78, v3
    v_mul_u32_u24 v253, 205, v252
    v_lshrrev_b32 v253, 14, v253
    v_mul_u32_u24 v254, 80, v253
    v_sub_u32 v252, v252, v254
    v_bfe_u32 v254, v252, 3, 2
    v_and_b32 v255, 3, v252
    v_lshl_add_u32 v254, v254, 2, v255
    v_bfe_u32 v255, v252, 2, 1
    v_lshl_add_u32 v254, v255, 6, v254
    v_cmp_gt_u32 vcc, 64, v252
    v_and_b32 v255, 15, v252
    v_lshrrev_b32 v252, 5, v252
    v_cndmask_b32 v254, v255, v254, vcc
    v_lshl_add_u32 v254, v252, 7, v254
    v_lshlrev_b32 v254, 4, v254
    v_mad_u32_u24 v244, v253, s55, v254
    v_mad_u32_u24 v247, v253, s57, v254
    s_sub_u32 s78, 7, s3
    s_lshl_b32 s78, s78, 6
    v_add_u32 v252, s78, v3
    v_mul_u32_u24 v253, 205, v252
    v_lshrrev_b32 v253, 14, v253
    v_mul_u32_u24 v254, 80, v253
    v_sub_u32 v252, v252, v254
    v_bfe_u32 v254, v252, 3, 2
    v_and_b32 v255, 3, v252
    v_lshl_add_u32 v254, v254, 2, v255
    v_bfe_u32 v255, v252, 2, 1
    v_lshl_add_u32 v254, v255, 6, v254
    v_cmp_gt_u32 vcc, 64, v252
    v_and_b32 v255, 15, v252
    v_lshrrev_b32 v252, 5, v252
    v_cndmask_b32 v254, v255, v254, vcc
    v_lshl_add_u32 v254, v252, 7, v254
    v_lshlrev_b32 v254, 4, v254
    v_mad_u32_u24 v245, v253, s55, v254
    v_mad_u32_u24 v248, v253, s57, v254
    s_sub_u32 s78, 11, s3
    s_lshl_b32 s78, s78, 6
    v_add_u32 v252, s78, v3
    v_mul_u32_u24 v253, 205, v252
    v_lshrrev_b32 v253, 14, v253
    v_mul_u32_u24 v254, 80, v253
    v_sub_u32 v252, v252, v254
    v_bfe_u32 v254, v252, 3, 2
    v_and_b32 v255, 3, v252
    v_lshl_add_u32 v254, v254, 2, v255
    v_bfe_u32 v255, v252, 2, 1
    v_lshl_add_u32 v254, v255, 6, v254
    v_cmp_gt_u32 vcc, 64, v252
    v_and_b32 v255, 15, v252
    v_lshrrev_b32 v252, 5, v252
    v_cndmask_b32 v254, v255, v254, vcc
    v_lshl_add_u32 v254, v252, 7, v254
    v_lshlrev_b32 v254, 4, v254
    v_or_b32 v254, s79, v254
    v_mad_u32_u24 v246, v253, s55, v254
    v_mad_u32_u24 v249, v253, s57, v254
    s_lshl_b32 s72, s40, 13
    s_add_u32 s72, s72, 262144
    v_mul_u32_u24 v78, 32768, v3
    v_lshrrev_b32 v78, 16, v78
    v_mul_u32_u24 v78, 1792, v78
    v_lshl_add_u32 v78, v3, 7, v78
    v_sub_u32 v79, 7, v3
    v_and_b32 v79, 1073741824, v79
    v_or_b32 v78, v78, v79
    buffer_load_dword v199, v78, s[4:7], s72 offen sc1
    s_lshl4_add_u32 s72, s40, s41
    s_lshl2_add_u32 s72, s72, s3
    s_lshl_b32 s72, s72, 7
    s_add_u32 s72, s72, 131072
    v_and_b32 v78, 1073741824, v4
    buffer_load_dword v199, v78, s[4:7], s72 offen sc1
    s_getreg_b32 s49, hwreg(HW_REG_XCC_ID, 0, 3)
    s_waitcnt lgkmcnt(0)
    s_mul_i32 s42, s42, 0x9e3779b1
    s_add_u32 s42, s42, 0x7f4a7c15
    s_mov_b32 s50, s42
    s_and_b32 s42, s42, -8
    s_or_b32 s51, s42, s49
    v_mov_b32 v5, s42
    v_mov_b32 v80, s51
    s_lshl_b32 s72, s40, 7
    s_lshl2_add_u32 s72, s41, s72
    buffer_store_dword v80, v12, s[4:7], s72 offen offset:1024 sc1
    s_waitcnt vmcnt(14)
    v_lshlrev_b32 v76, 16, v10
    v_and_b32 v77, 0xffff0000, v10
    v_mul_f32 v78, 0xbfb8aa3b, v76
    v_mul_f32 v79, 0xbfb8aa3b, v77
    v_exp_f32 v78, v78
    v_exp_f32 v79, v79
    v_add_f32 v78, 1.0, v78
    v_add_f32 v79, 1.0, v79
    v_rcp_f32 v78, v78
    v_rcp_f32 v79, v79
    v_mul_f32 v76, v76, v78
    v_mul_f32 v77, v77, v79
    v_cvt_pk_bf16_f32 v76, v76, v77
    ds_write_b32 v9, v76 offset:41472
    s_mov_b32 s73, 0x07060503
    s_mov_b32 s77, 0x07060502
    s_mov_b32 s78, 0x07060501
    s_waitcnt vmcnt(9)
    s_waitcnt lgkmcnt(0)
    s_barrier
    ds_read_b64_tr_b16 v[200:201], v17 offset:0
    ds_read_b64_tr_b16 v[202:203], v17 offset:512
    ds_read_b128 v[220:223], v18 offset:41472
    ds_read_b64_tr_b16 v[204:205], v17 offset:4096
    ds_read_b64_tr_b16 v[206:207], v17 offset:4608
    ds_read_b128 v[224:227], v18 offset:41536
    ds_read_b64_tr_b16 v[208:209], v17 offset:8192
    ds_read_b64_tr_b16 v[210:211], v17 offset:8704
    ds_read_b128 v[228:231], v18 offset:41600
    ds_read_b64_tr_b16 v[212:213], v17 offset:12288
    ds_read_b64_tr_b16 v[214:215], v17 offset:12800
    ds_read_b128 v[232:235], v18 offset:41664
    ds_read_b64_tr_b16 v[216:217], v17 offset:16384
    ds_read_b64_tr_b16 v[218:219], v17 offset:16896
    ds_read_b128 v[236:239], v18 offset:41728
    s_waitcnt lgkmcnt(12)
    v_mfma_f32_16x16x32_bf16 v[80:83], v[200:203], v[220:223], 0
    s_waitcnt lgkmcnt(9)
    v_mfma_f32_16x16x32_bf16 v[80:83], v[204:207], v[224:227], v[80:83]
    s_waitcnt lgkmcnt(6)
    v_mfma_f32_16x16x32_bf16 v[80:83], v[208:211], v[228:231], v[80:83]
    s_waitcnt lgkmcnt(3)
    v_mfma_f32_16x16x32_bf16 v[80:83], v[212:215], v[232:235], v[80:83]
    s_waitcnt lgkmcnt(0)
    v_mfma_f32_16x16x32_bf16 v[80:83], v[216:219], v[236:239], v[80:83]
    s_nop 7
    v_perm_b32 v80, v80, v83, s73
    v_perm_b32 v81, v81, v83, s77
    v_perm_b32 v82, v82, v83, s78
    v_mov_b32 v83, s42
    buffer_store_dwordx4 v[80:83], v15, s[4:7], s96 offen sc1
    s_nop 1
    s_cmp_ge_u32 s2, 240
    s_cbranch_scc1 .Lod2_1
    s_lshl_b32 s88, s3, 12
    s_add_u32 m0, s88, 45056
    s_nop 0
    buffer_load_dwordx4 v36, s[20:23], s65 offen sc1 nt lds
    s_add_u32 m0, m0, 1024
    s_nop 0
    buffer_load_dwordx4 v36, s[24:27], s65 offen sc1 nt lds
    s_add_u32 m0, m0, 1024
    s_add_u32 s65, s65, 512
    buffer_load_dwordx4 v36, s[20:23], s65 offen sc1 nt lds
    s_add_u32 m0, m0, 1024
    s_nop 0
    buffer_load_dwordx4 v36, s[24:27], s65 offen sc1 nt lds
    s_branch .Lrid_2
.Lod2_1:
    s_sub_u32 s88, 3, s3
    s_lshl_b32 s88, s88, 10
    s_add_u32 m0, s88, 45056
    s_nop 0
    buffer_load_dwordx4 v39, s[16:19], s67 offen sc1 nt lds
    s_add_u32 s67, s67, 512
    s_add_u32 m0, m0, 4096
    s_nop 0
    buffer_load_dwordx4 v39, s[16:19], s67 offen sc1 nt lds
    s_cmp_lt_u32 s3, 2
    s_cselect_b32 s88, 0, 512
    s_add_u32 s67, s67, s88
    s_lshl3_add_u32 m0, s88, m0
    s_nop 0
    buffer_load_dwordx4 v39, s[16:19], s67 offen sc1 nt lds
    buffer_load_dwordx4 v39, s[16:19], s67 offen sc1 nt lds
.Lrid_2:
    s_sub_u32 s88, 3, s3
    s_lshl_b32 s88, s88, 10
    s_add_u32 m0, s88, 67584
    s_nop 0
    buffer_load_dwordx4 v38, s[16:19], s66 offen sc1 nt lds
    s_add_u32 s66, s66, 512
    s_add_u32 m0, m0, 4096
    s_nop 0
    buffer_load_dwordx4 v38, s[16:19], s66 offen sc1 nt lds
    s_cmp_lt_u32 s3, 2
    s_cselect_b32 s88, 0, 512
    s_add_u32 s66, s66, s88
    s_lshl3_add_u32 m0, s88, m0
    s_nop 0
    buffer_load_dwordx4 v38, s[16:19], s66 offen sc1 nt lds
    s_mul_i32 s72, s3, 3072
    v_add_u32 v76, s72, v19
    s_waitcnt vmcnt(14)
    ds_read_b64_tr_b16 v[64:65], v76 offset:20480
    ds_read_b64_tr_b16 v[66:67], v76 offset:20992
    ds_read_b64_tr_b16 v[68:69], v76 offset:21504
    ds_read_b64_tr_b16 v[70:71], v76 offset:22016
    ds_read_b64_tr_b16 v[72:73], v76 offset:22528
    ds_read_b64_tr_b16 v[74:75], v76 offset:23040
    s_waitcnt lgkmcnt(4)
    buffer_store_dwordx4 v[64:67], v20, s[4:7], s97 offen sc1
    buffer_store_dwordx4 v[64:67], v160, s[4:7], s97 offen offset:64 sc1
    s_waitcnt lgkmcnt(2)
    buffer_store_dwordx4 v[68:71], v21, s[4:7], s97 offen sc1
    buffer_store_dwordx4 v[68:71], v161, s[4:7], s97 offen offset:64 sc1
    s_waitcnt lgkmcnt(0)
    buffer_store_dwordx4 v[72:75], v22, s[4:7], s97 offen sc1
    buffer_store_dwordx4 v[72:75], v162, s[4:7], s97 offen offset:64 sc1
    s_waitcnt vmcnt(19)
    v_lshlrev_b32 v40, 16, v24
    v_and_b32 v41, 0xffff0000, v24
    v_lshlrev_b32 v42, 16, v25
    v_and_b32 v43, 0xffff0000, v25
    v_lshlrev_b32 v44, 16, v26
    v_and_b32 v45, 0xffff0000, v26
    v_lshlrev_b32 v46, 16, v27
    v_and_b32 v47, 0xffff0000, v27
    s_waitcnt vmcnt(18)
    v_lshlrev_b32 v48, 16, v28
    v_and_b32 v49, 0xffff0000, v28
    v_lshlrev_b32 v50, 16, v29
    v_and_b32 v51, 0xffff0000, v29
    v_lshlrev_b32 v52, 16, v30
    v_and_b32 v53, 0xffff0000, v30
    v_lshlrev_b32 v54, 16, v31
    v_and_b32 v55, 0xffff0000, v31
    s_waitcnt vmcnt(17)
    v_lshlrev_b32 v56, 16, v32
    v_and_b32 v57, 0xffff0000, v32
    v_lshlrev_b32 v58, 16, v33
    v_and_b32 v59, 0xffff0000, v33
    v_lshlrev_b32 v60, 16, v34
    v_and_b32 v61, 0xffff0000, v34
    v_lshlrev_b32 v62, 16, v35
    v_and_b32 v63, 0xffff0000, v35
    v_pk_add_f32 v[76:77], v[40:41], v[42:43]
    v_pk_mul_f32 v[78:79], v[40:41], v[40:41]
    v_pk_fma_f32 v[78:79], v[42:43], v[42:43], v[78:79]
    v_pk_add_f32 v[76:77], v[76:77], v[44:45]
    v_pk_fma_f32 v[78:79], v[44:45], v[44:45], v[78:79]
    v_pk_add_f32 v[76:77], v[76:77], v[46:47]
    v_pk_fma_f32 v[78:79], v[46:47], v[46:47], v[78:79]
    v_pk_add_f32 v[76:77], v[76:77], v[48:49]
    v_pk_fma_f32 v[78:79], v[48:49], v[48:49], v[78:79]
    v_pk_add_f32 v[76:77], v[76:77], v[50:51]
    v_pk_fma_f32 v[78:79], v[50:51], v[50:51], v[78:79]
    v_pk_add_f32 v[76:77], v[76:77], v[52:53]
    v_pk_fma_f32 v[78:79], v[52:53], v[52:53], v[78:79]
    v_pk_add_f32 v[76:77], v[76:77], v[54:55]
    v_pk_fma_f32 v[78:79], v[54:55], v[54:55], v[78:79]
    v_pk_add_f32 v[76:77], v[76:77], v[56:57]
    v_pk_fma_f32 v[78:79], v[56:57], v[56:57], v[78:79]
    v_pk_add_f32 v[76:77], v[76:77], v[58:59]
    v_pk_fma_f32 v[78:79], v[58:59], v[58:59], v[78:79]
    v_pk_add_f32 v[76:77], v[76:77], v[60:61]
    v_pk_fma_f32 v[78:79], v[60:61], v[60:61], v[78:79]
    v_pk_add_f32 v[76:77], v[76:77], v[62:63]
    v_pk_fma_f32 v[78:79], v[62:63], v[62:63], v[78:79]
    v_add_f32 v76, v76, v77
    v_add_f32 v77, v78, v79
    s_nop 0
    v_add_f32_dpp v76, v76, v76 row_ror:8 row_mask:0xf bank_mask:0xf
    v_add_f32_dpp v77, v77, v77 row_ror:8 row_mask:0xf bank_mask:0xf
    v_mov_b32 v78, v76
    s_nop 1
    v_permlane16_swap_b32 v76, v78
    v_add_f32 v76, v76, v78
    v_mov_b32 v78, v76
    s_nop 1
    v_permlane32_swap_b32 v76, v78
    v_add_f32 v76, v76, v78
    v_mov_b32 v79, v77
    s_nop 1
    v_permlane16_swap_b32 v77, v79
    v_add_f32 v77, v77, v79
    v_mov_b32 v79, v77
    s_nop 1
    v_permlane32_swap_b32 v77, v79
    v_add_f32 v77, v77, v79
    v_lshlrev_b32 v78, 1, v7
    v_add_u32 v78, 40960, v78
    s_lshl_b32 s72, s3, 3
    v_add_u32 v79, s72, v78
    ds_write_b64 v79, v[76:77]
    s_waitcnt lgkmcnt(0)
    s_barrier
    s_mul_i32 s86, s40, 163840
    s_lshr_b32 s72, s41, 2
    s_mul_i32 s72, s72, 40960
    s_add_u32 s86, s86, s72
    s_and_b32 s72, s41, 1
    s_lshl_b32 s72, s72, 7
    s_add_u32 s86, s86, s72
    s_and_b32 s72, s41, 2
    s_lshl_b32 s72, s72, 9
    s_add_u32 s86, s86, s72
    s_mul_i32 s72, s3, 10240
    s_add_u32 s86, s86, s72
    s_add_u32 s86, s86, 11796480
    ds_read_b128 v[88:91], v78
    ds_read_b128 v[92:95], v78 offset:16
    s_waitcnt lgkmcnt(1)
    v_pk_add_f32 v[88:89], v[88:89], v[90:91]
    s_waitcnt lgkmcnt(0)
    v_pk_add_f32 v[92:93], v[92:93], v[94:95]
    v_pk_add_f32 v[88:89], v[88:89], v[92:93]
    v_and_b32 v92, 4, v6
    v_add_u32 v92, v92, v6
    v_lshl_add_u32 v92, v92, 8, v7
    v_cmp_gt_u32 vcc, 32, v3
    s_nop 1
    v_cndmask_b32 v93, v2, v92, vcc
    v_mul_f32 v90, 0x3acccccd, v88
    v_mul_f32 v89, 0x3acccccd, v89
    v_fma_f32 v89, -v90, v90, v89
    v_max_f32 v89, 0, v89
    v_add_f32 v89, 0x3727c5ac, v89
    v_rsq_f32 v88, v89
    s_nop 0
    v_mul_f32 v89, -v90, v88
    v_pk_fma_f32 v[40:41], v[40:41], v[88:89], v[88:89] op_sel:[0,0,1] op_sel_hi:[1,0,1]
    v_pk_fma_f32 v[42:43], v[42:43], v[88:89], v[88:89] op_sel:[0,0,1] op_sel_hi:[1,0,1]
    v_pk_fma_f32 v[44:45], v[44:45], v[88:89], v[88:89] op_sel:[0,0,1] op_sel_hi:[1,0,1]
    v_pk_fma_f32 v[46:47], v[46:47], v[88:89], v[88:89] op_sel:[0,0,1] op_sel_hi:[1,0,1]
    v_pk_fma_f32 v[48:49], v[48:49], v[88:89], v[88:89] op_sel:[0,0,1] op_sel_hi:[1,0,1]
    v_pk_fma_f32 v[50:51], v[50:51], v[88:89], v[88:89] op_sel:[0,0,1] op_sel_hi:[1,0,1]
    v_pk_fma_f32 v[52:53], v[52:53], v[88:89], v[88:89] op_sel:[0,0,1] op_sel_hi:[1,0,1]
    v_pk_fma_f32 v[54:55], v[54:55], v[88:89], v[88:89] op_sel:[0,0,1] op_sel_hi:[1,0,1]
    v_pk_fma_f32 v[56:57], v[56:57], v[88:89], v[88:89] op_sel:[0,0,1] op_sel_hi:[1,0,1]
    v_pk_fma_f32 v[58:59], v[58:59], v[88:89], v[88:89] op_sel:[0,0,1] op_sel_hi:[1,0,1]
    v_pk_fma_f32 v[60:61], v[60:61], v[88:89], v[88:89] op_sel:[0,0,1] op_sel_hi:[1,0,1]
    v_pk_fma_f32 v[62:63], v[62:63], v[88:89], v[88:89] op_sel:[0,0,1] op_sel_hi:[1,0,1]
    v_mov_b32 v15, v92
    v_mov_b32 v10, v93
    s_nop 1
    s_mov_b64 exec, 0
    s_cmp_eq_u32 s3, 0
    s_cbranch_scc1 .Lchain0
    s_cmp_eq_u32 s3, 1
    s_cbranch_scc1 .Lchain1
    s_cmp_eq_u32 s3, 2
    s_cbranch_scc1 .Lchain2
    s_branch .Lchain3
.Lwarm_ret:
.Lchain3:
    s_mov_b64 exec, -1
    s_mul_i32 s74, s3, 2560
    s_add_u32 s74, s74, 65536
    s_add_u32 s75, s74, 10752
    v_cmp_gt_u32 vcc, 32, v3
    v_add_u32 v93, 7680, v1
    s_nop 0
    v_cndmask_b32 v93, v93, v1, vcc
    v_cndmask_b32 v94, 1.0, 0, vcc
    s_lshl_b32 s76, s40, 7
    v_and_b32 v95, 15, v3
    v_lshlrev_b32 v95, 2, v95
    s_mov_b32 s60, 0xaaaaaaaa
    s_mov_b32 s61, s60
    s_mov_b32 s62, 0xcccccccc
    s_mov_b32 s63, s62
    s_mul_i32 s72, s3, 1280
    s_add_u32 s72, s72, 61440
    v_lshl_add_u32 v92, v3, 2, s72
    v_mov_b32 v161, 0
    v_lshl_add_u32 v17, v6, 5, s72
    s_movk_i32 s79, 8192
    s_mov_b32 s77, 0x04000c0c
    s_mov_b32 s78, 0x0706000c
    s_mov_b32 s73, 0
.Lpoll_3:
    s_add_u32 s73, s73, 1
    buffer_load_dwordx4 v[64:67], v1, s[4:7], s74 offen sc1
    buffer_load_dwordx4 v[68:71], v1, s[4:7], s74 offen offset:1024 sc1
    buffer_load_dwordx4 v[72:75], v93, s[4:7], s74 offen offset:2048 sc1
    buffer_load_dwordx4 v[76:79], v1, s[4:7], s75 offen sc1
    buffer_load_dwordx4 v[80:83], v1, s[4:7], s75 offen offset:1024 sc1
    buffer_load_dword v86, v95, s[4:7], s76 offen offset:1024 sc1
    s_waitcnt vmcnt(0)
    v_and_b32 v87, -8, v86
    v_xor_b32 v88, s42, v67
    v_xor_b32 v89, s42, v71
    v_xor_b32 v90, s42, v75
    v_or3_b32 v88, v88, v89, v90
    v_xor_b32 v89, s42, v79
    v_xor_b32 v90, s42, v83
    v_or3_b32 v88, v88, v89, v90
    v_xor_b32 v89, s42, v87
    v_or_b32 v88, v88, v89
    v_cmp_ne_u32 vcc, 0, v88
    s_cmp_ge_u32 s73, 20000
    s_cbranch_scc1 .Lpollx_4
    s_cmp_lg_u64 vcc, 0
    s_cbranch_scc1 .Lpoll_3
.Lpollx_4:
    s_barrier
    s_and_b32 s72, s2, 0xfc
    s_mul_i32 s72, s72, 28
    s_lshl2_add_u32 s72, s2, s72
    s_add_u32 s72, s72, 8192
    buffer_store_dword v5, v12, s[4:7], s72 offen sc1
    ds_read_b64_tr_b16 a[0:1], v250 offset:0
    ds_read_b64_tr_b16 a[2:3], v250 offset:512
    ds_read_b64_tr_b16 a[4:5], v250 offset:64
    ds_read_b64_tr_b16 a[6:7], v250 offset:576
    ds_read_b64_tr_b16 a[8:9], v250 offset:2048
    ds_read_b64_tr_b16 a[10:11], v250 offset:2560
    ds_read_b64_tr_b16 a[12:13], v250 offset:2112
    ds_read_b64_tr_b16 a[14:15], v250 offset:2624
    ds_read_b64_tr_b16 a[16:17], v251 offset:22528
    ds_read_b64_tr_b16 a[18:19], v251 offset:23040
    ds_read_b64_tr_b16 a[20:21], v251 offset:26624
    ds_read_b64_tr_b16 a[22:23], v251 offset:27136
    ds_read_b64_tr_b16 a[24:25], v251 offset:30720
    ds_read_b64_tr_b16 a[26:27], v251 offset:31232
    ds_read_b64_tr_b16 a[28:29], v251 offset:0
    ds_read_b64_tr_b16 a[30:31], v251 offset:512
    ds_read_b64_tr_b16 a[32:33], v251 offset:4096
    ds_read_b64_tr_b16 a[34:35], v251 offset:4608
    ds_read_b64_tr_b16 a[36:37], v251 offset:8192
    ds_read_b64_tr_b16 a[38:39], v251 offset:8704
    s_waitcnt lgkmcnt(15)
    buffer_store_dwordx4 a[0:3], v240, s[4:7], s58 offen sc1
    buffer_store_dwordx4 a[4:7], v241, s[4:7], s58 offen sc1
    s_waitcnt lgkmcnt(14)
    buffer_store_dwordx4 a[8:11], v242, s[4:7], s58 offen sc1
    s_waitcnt lgkmcnt(12)
    buffer_store_dwordx4 a[12:15], v243, s[4:7], s58 offen sc1
    s_waitcnt lgkmcnt(10)
    buffer_store_dwordx4 a[16:19], v244, s[4:7], s54 offen sc1
    s_waitcnt lgkmcnt(8)
.Lchain0:
.Lisl0:
    s_cbranch_execz .Lisl1
    buffer_store_dwordx4 a[20:23], v245, s[4:7], s54 offen sc1
    s_waitcnt lgkmcnt(6)
    buffer_store_dwordx4 a[24:27], v246, s[4:7], s54 offen sc1
    s_cmp_lt_u32 s2, 240
    s_cbranch_scc1 .Lod2p_5
    s_waitcnt lgkmcnt(4)
    buffer_store_dwordx4 a[28:31], v247, s[4:7], s56 offen sc1
    s_waitcnt lgkmcnt(2)
    buffer_store_dwordx4 a[32:35], v248, s[4:7], s56 offen sc1
    s_waitcnt lgkmcnt(0)
    buffer_store_dwordx4 a[36:39], v249, s[4:7], s56 offen sc1
.Lod2p_5:
    v_perm_b32 v67, v64, v65, s77
    v_perm_b32 v71, v68, v69, s77
    v_perm_b32 v75, v72, v73, s77
    v_perm_b32 v79, v76, v77, s77
    v_perm_b32 v83, v80, v81, s77
    v_perm_b32 v67, v67, v66, s78
    v_perm_b32 v71, v71, v70, s78
    v_perm_b32 v75, v75, v74, s78
    v_perm_b32 v79, v79, v78, s78
    v_perm_b32 v83, v83, v82, s78
    v_cndmask_b32 v144, v65, v64, s[60:61]
    v_cndmask_b32 v145, v67, v66, s[60:61]
    v_cndmask_b32 v64, v64, v65, s[60:61]
    v_cndmask_b32 v66, v66, v67, s[60:61]
    v_cndmask_b32 v146, v69, v68, s[60:61]
    v_cndmask_b32 v147, v71, v70, s[60:61]
    v_cndmask_b32 v68, v68, v69, s[60:61]
    v_cndmask_b32 v70, v70, v71, s[60:61]
    v_cndmask_b32 v148, v73, v72, s[60:61]
    v_cndmask_b32 v149, v75, v74, s[60:61]
    v_cndmask_b32 v72, v72, v73, s[60:61]
    v_cndmask_b32 v74, v74, v75, s[60:61]
    v_cndmask_b32 v150, v77, v76, s[60:61]
    v_cndmask_b32 v151, v79, v78, s[60:61]
    v_cndmask_b32 v76, v76, v77, s[60:61]
    v_cndmask_b32 v78, v78, v79, s[60:61]
    v_cndmask_b32 v152, v81, v80, s[60:61]
    v_cndmask_b32 v153, v83, v82, s[60:61]
    v_cndmask_b32 v80, v80, v81, s[60:61]
    v_cndmask_b32 v82, v82, v83, s[60:61]
    v_add_f32_dpp v64, v144, v64 quad_perm:[1,0,3,2] row_mask:0xf bank_mask:0xf
    v_add_f32_dpp v66, v145, v66 quad_perm:[1,0,3,2] row_mask:0xf bank_mask:0xf
    v_add_f32_dpp v68, v146, v68 quad_perm:[1,0,3,2] row_mask:0xf bank_mask:0xf
    v_add_f32_dpp v70, v147, v70 quad_perm:[1,0,3,2] row_mask:0xf bank_mask:0xf
    v_add_f32_dpp v72, v148, v72 quad_perm:[1,0,3,2] row_mask:0xf bank_mask:0xf
    v_add_f32_dpp v74, v149, v74 quad_perm:[1,0,3,2] row_mask:0xf bank_mask:0xf
    v_add_f32_dpp v76, v150, v76 quad_perm:[1,0,3,2] row_mask:0xf bank_mask:0xf
    v_add_f32_dpp v78, v151, v78 quad_perm:[1,0,3,2] row_mask:0xf bank_mask:0xf
    v_add_f32_dpp v80, v152, v80 quad_perm:[1,0,3,2] row_mask:0xf bank_mask:0xf
    v_add_f32_dpp v82, v153, v82 quad_perm:[1,0,3,2] row_mask:0xf bank_mask:0xf
    v_cndmask_b32 v65, v66, v64, s[62:63]
    v_cndmask_b32 v64, v64, v66, s[62:63]
    v_cndmask_b32 v69, v70, v68, s[62:63]
    v_cndmask_b32 v68, v68, v70, s[62:63]
    v_cndmask_b32 v73, v74, v72, s[62:63]
    v_cndmask_b32 v72, v72, v74, s[62:63]
    v_cndmask_b32 v77, v78, v76, s[62:63]
    v_cndmask_b32 v76, v76, v78, s[62:63]
    v_cndmask_b32 v81, v82, v80, s[62:63]
    v_cndmask_b32 v80, v80, v82, s[62:63]
    v_add_f32_dpp v156, v65, v64 quad_perm:[2,3,0,1] row_mask:0xf bank_mask:0xf
    v_add_f32_dpp v157, v69, v68 quad_perm:[2,3,0,1] row_mask:0xf bank_mask:0xf
    v_add_f32_dpp v158, v73, v72 quad_perm:[2,3,0,1] row_mask:0xf bank_mask:0xf
    v_add_f32_dpp v159, v77, v76 quad_perm:[2,3,0,1] row_mask:0xf bank_mask:0xf
    v_add_f32_dpp v160, v81, v80 quad_perm:[2,3,0,1] row_mask:0xf bank_mask:0xf
    v_cvt_pk_bf16_f32 v89, v156, v157
    v_lshlrev_b32 v156, 16, v89
    v_and_b32 v157, 0xffff0000, v89
    v_cvt_pk_bf16_f32 v89, v158, v159
    v_lshlrev_b32 v158, 16, v89
    v_and_b32 v159, 0xffff0000, v89
    v_cvt_pk_bf16_f32 v89, v160, v161
    v_lshlrev_b32 v160, 16, v89
    v_and_b32 v161, 0xffff0000, v89
    v_add_f32 v158, v94, v158
    v_add_f32 v159, 1.0, v159
    v_add_f32 v160, 1.0, v160
    v_cvt_pk_bf16_f32 v89, v158, v159
    v_lshlrev_b32 v158, 16, v89
    v_and_b32 v159, 0xffff0000, v89
    v_cvt_pk_bf16_f32 v89, v160, v161
    v_lshlrev_b32 v160, 16, v89
    v_and_b32 v161, 0xffff0000, v89
    ds_write_b32 v92, v156 offset:0
    ds_write_b32 v92, v157 offset:256
    ds_write_b32 v92, v158 offset:512
    ds_write_b32 v92, v159 offset:768
    ds_write_b32 v92, v160 offset:1024
    ds_read_b128 v[96:99], v17 offset:640
    ds_read_b128 v[100:103], v17 offset:656
    ds_read_b128 v[104:107], v17 offset:0
    ds_read_b128 v[108:111], v17 offset:16
    ds_read_b128 v[112:115], v17 offset:896
    ds_read_b128 v[116:119], v17 offset:912
    ds_read_b128 v[120:123], v17 offset:256
    ds_read_b128 v[124:127], v17 offset:272
    ds_read_b128 v[128:131], v17 offset:1152
    ds_read_b128 v[132:135], v17 offset:1168
    ds_read_b128 v[136:139], v17 offset:512
    ds_read_b128 v[140:143], v17 offset:528
    s_waitcnt lgkmcnt(9)
    v_pk_fma_f32 v[40:41], v[40:41], v[96:97], v[104:105]
    v_cvt_pk_bf16_f32 v24, v40, v41
    v_pk_fma_f32 v[42:43], v[42:43], v[98:99], v[106:107]
    v_cvt_pk_bf16_f32 v25, v42, v43
    s_waitcnt lgkmcnt(8)
    v_pk_fma_f32 v[44:45], v[44:45], v[100:101], v[108:109]
    v_cvt_pk_bf16_f32 v26, v44, v45
    v_pk_fma_f32 v[46:47], v[46:47], v[102:103], v[110:111]
    v_cvt_pk_bf16_f32 v27, v46, v47
    buffer_store_dwordx4 v[24:27], v15, s[4:7], s86 offen sc1
    s_add_u32 s86, s86, 4096
    s_waitcnt lgkmcnt(5)
    v_pk_fma_f32 v[48:49], v[48:49], v[112:113], v[120:121]
    v_cvt_pk_bf16_f32 v28, v48, v49
    v_pk_fma_f32 v[50:51], v[50:51], v[114:115], v[122:123]
    v_cvt_pk_bf16_f32 v29, v50, v51
    s_waitcnt lgkmcnt(4)
    v_pk_fma_f32 v[52:53], v[52:53], v[116:117], v[124:125]
    v_cvt_pk_bf16_f32 v30, v52, v53
    v_pk_fma_f32 v[54:55], v[54:55], v[118:119], v[126:127]
    v_cvt_pk_bf16_f32 v31, v54, v55
    buffer_store_dwordx4 v[28:31], v15, s[4:7], s86 offen sc1
    s_add_u32 s86, s86, 4096
    s_waitcnt lgkmcnt(1)
    v_pk_fma_f32 v[56:57], v[56:57], v[128:129], v[136:137]
    v_cvt_pk_bf16_f32 v32, v56, v57
    v_pk_fma_f32 v[58:59], v[58:59], v[130:131], v[138:139]
    v_cvt_pk_bf16_f32 v33, v58, v59
    s_waitcnt lgkmcnt(0)
    v_pk_fma_f32 v[60:61], v[60:61], v[132:133], v[140:141]
    v_cvt_pk_bf16_f32 v34, v60, v61
    v_pk_fma_f32 v[62:63], v[62:63], v[134:135], v[142:143]
    v_cvt_pk_bf16_f32 v35, v62, v63
    buffer_store_dwordx4 v[32:35], v10, s[4:7], s86 offen sc1
    v_cmp_ne_u32 vcc, s51, v86
    s_nop 0
    s_cmp_eq_u64 vcc, 0
    s_cselect_b32 s43, 1, 0
    s_cmp_lg_u32 s43, 0
    s_cselect_b32 s72, 1073741824, 0
    v_or_b32 v0, s72, v4
    s_cselect_b32 s72, 0, 1073741824
    v_or_b32 v4, s72, v4
    s_lshl_b32 s52, s40, 13
    s_add_u32 s52, s52, 262144
    s_add_u32 s53, s52, 4096
    s_mul_i32 s74, s3, 2560
    s_add_u32 s74, s74, 96256
    s_add_u32 s75, s74, 10752
    v_cmp_gt_u32 vcc, 32, v3
    v_add_u32 v93, 7680, v1
    s_nop 0
    v_cndmask_b32 v93, v93, v1, vcc
    v_cndmask_b32 v94, 1.0, 0, vcc
    v_min_u32 v95, 624, v1
    s_lshr_b32 s76, s3, 1
    s_mul_i32 s76, s76, 30720
    s_and_b32 s72, s3, 1
    s_lshl1_add_u32 s72, s46, s72
    s_mul_i32 s72, s72, 640
    s_add_u32 s76, s76, s72
    s_add_u32 s76, s76, 86016
    s_movk_i32 s79, 8192
    s_mov_b32 s77, 0x04000c0c
    s_mov_b32 s78, 0x0706000c
    s_mov_b32 s60, s74
    s_mov_b32 s61, s75
    s_mov_b32 s62, s76
    buffer_load_dwordx4 v[64:67], v1, s[4:7], s60 offen sc1
    buffer_load_dwordx4 v[68:71], v1, s[4:7], s60 offen offset:1024 sc1
    buffer_load_dwordx4 v[72:75], v93, s[4:7], s60 offen offset:2048 sc1
    buffer_load_dwordx4 v[76:79], v1, s[4:7], s61 offen sc1
    buffer_load_dwordx4 v[80:83], v1, s[4:7], s61 offen offset:1024 sc1
    buffer_load_dwordx4 v[84:87], v95, s[4:7], s62 offen sc1
    s_barrier
    s_mul_i32 s72, s3, 2560
    s_add_u32 m0, s72, 67584
    s_movk_i32 s72, 1120
    v_add_u32 v8, 0, v3
    v_mul_u32_u24 v9, 205, v8
    v_lshrrev_b32 v9, 11, v9
    v_mad_u32_u24 v8, v9, s72, v1
    buffer_load_dwordx4 v8, s[8:11], s90 offen offset:0 lds
    v_add_u32 v8, 64, v3
    v_mul_u32_u24 v9, 205, v8
    v_lshrrev_b32 v9, 11, v9
    v_mad_u32_u24 v8, v9, s72, v1
    buffer_load_dwordx4 v8, s[8:11], s90 offen offset:1024 lds
    v_add_u32 v8, 128, v3
    v_mul_u32_u24 v9, 205, v8
    v_lshrrev_b32 v9, 11, v9
    v_mad_u32_u24 v8, v9, s72, v1
    s_mov_b32 exec_hi, 0
    buffer_load_dwordx4 v8, s[8:11], s90 offen offset:2048 lds
    s_mov_b32 exec_hi, -1
    s_waitcnt vmcnt(9)
    buffer_store_dword v5, v4, s[4:7], s52 offen offset:0
    buffer_store_dword v5, v0, s[4:7], s52 offen offset:0 sc1
    s_waitcnt vmcnt(10)
    v_xor_b32 v88, s42, v67
    s_waitcnt vmcnt(9)
    v_xor_b32 v89, s42, v71
    s_waitcnt vmcnt(8)
    v_xor_b32 v90, s42, v75
    v_or3_b32 v88, v88, v89, v90
    s_waitcnt vmcnt(7)
    v_xor_b32 v89, s42, v79
    s_waitcnt vmcnt(6)
    v_xor_b32 v90, s42, v83
    v_or3_b32 v88, v88, v89, v90
    s_waitcnt vmcnt(5)
    v_xor_b32 v89, s42, v87
    v_or_b32 v88, v88, v89
    v_cmp_ne_u32 vcc, 0, v88
    s_nop 0
    s_cmp_lg_u64 vcc, 0
    s_cbranch_scc1 .Lrcs_7
.Lrcb_6:
    v_perm_b32 v67, v64, v65, s77
    v_perm_b32 v71, v68, v69, s77
    v_perm_b32 v75, v72, v73, s77
    v_perm_b32 v79, v76, v77, s77
    v_perm_b32 v83, v80, v81, s77
    v_perm_b32 v87, v84, v85, s77
    v_perm_b32 v67, v67, v66, s78
    v_perm_b32 v71, v71, v70, s78
    v_perm_b32 v75, v75, v74, s78
    v_perm_b32 v79, v79, v78, s78
    v_perm_b32 v83, v83, v82, s78
    v_perm_b32 v87, v87, v86, s78
    v_add_f32_dpp v64, v64, v64 quad_perm:[1,0,3,2] row_mask:0xf bank_mask:0xf
    v_add_f32_dpp v65, v65, v65 quad_perm:[1,0,3,2] row_mask:0xf bank_mask:0xf
    v_add_f32_dpp v66, v66, v66 quad_perm:[1,0,3,2] row_mask:0xf bank_mask:0xf
    v_add_f32_dpp v67, v67, v67 quad_perm:[1,0,3,2] row_mask:0xf bank_mask:0xf
    v_add_f32_dpp v68, v68, v68 quad_perm:[1,0,3,2] row_mask:0xf bank_mask:0xf
    v_add_f32_dpp v69, v69, v69 quad_perm:[1,0,3,2] row_mask:0xf bank_mask:0xf
    v_add_f32_dpp v70, v70, v70 quad_perm:[1,0,3,2] row_mask:0xf bank_mask:0xf
    v_add_f32_dpp v71, v71, v71 quad_perm:[1,0,3,2] row_mask:0xf bank_mask:0xf
    v_add_f32_dpp v72, v72, v72 quad_perm:[1,0,3,2] row_mask:0xf bank_mask:0xf
    v_add_f32_dpp v73, v73, v73 quad_perm:[1,0,3,2] row_mask:0xf bank_mask:0xf
    v_add_f32_dpp v74, v74, v74 quad_perm:[1,0,3,2] row_mask:0xf bank_mask:0xf
    v_add_f32_dpp v75, v75, v75 quad_perm:[1,0,3,2] row_mask:0xf bank_mask:0xf
    v_add_f32_dpp v76, v76, v76 quad_perm:[1,0,3,2] row_mask:0xf bank_mask:0xf
    v_add_f32_dpp v77, v77, v77 quad_perm:[1,0,3,2] row_mask:0xf bank_mask:0xf
    v_add_f32_dpp v78, v78, v78 quad_perm:[1,0,3,2] row_mask:0xf bank_mask:0xf
    v_add_f32_dpp v79, v79, v79 quad_perm:[1,0,3,2] row_mask:0xf bank_mask:0xf
    v_add_f32_dpp v80, v80, v80 quad_perm:[1,0,3,2] row_mask:0xf bank_mask:0xf
    v_add_f32_dpp v81, v81, v81 quad_perm:[1,0,3,2] row_mask:0xf bank_mask:0xf
    v_add_f32_dpp v82, v82, v82 quad_perm:[1,0,3,2] row_mask:0xf bank_mask:0xf
    v_add_f32_dpp v83, v83, v83 quad_perm:[1,0,3,2] row_mask:0xf bank_mask:0xf
    v_add_f32_dpp v84, v84, v84 quad_perm:[1,0,3,2] row_mask:0xf bank_mask:0xf
    v_add_f32_dpp v85, v85, v85 quad_perm:[1,0,3,2] row_mask:0xf bank_mask:0xf
    v_add_f32_dpp v86, v86, v86 quad_perm:[1,0,3,2] row_mask:0xf bank_mask:0xf
    v_add_f32_dpp v87, v87, v87 quad_perm:[1,0,3,2] row_mask:0xf bank_mask:0xf
    v_add_f32_dpp v64, v64, v64 quad_perm:[2,3,0,1] row_mask:0xf bank_mask:0xf
    v_add_f32_dpp v65, v65, v65 quad_perm:[2,3,0,1] row_mask:0xf bank_mask:0xf
    v_add_f32_dpp v66, v66, v66 quad_perm:[2,3,0,1] row_mask:0xf bank_mask:0xf
    v_add_f32_dpp v67, v67, v67 quad_perm:[2,3,0,1] row_mask:0xf bank_mask:0xf
    v_add_f32_dpp v68, v68, v68 quad_perm:[2,3,0,1] row_mask:0xf bank_mask:0xf
    v_add_f32_dpp v69, v69, v69 quad_perm:[2,3,0,1] row_mask:0xf bank_mask:0xf
    v_add_f32_dpp v70, v70, v70 quad_perm:[2,3,0,1] row_mask:0xf bank_mask:0xf
    v_add_f32_dpp v71, v71, v71 quad_perm:[2,3,0,1] row_mask:0xf bank_mask:0xf
    v_add_f32_dpp v72, v72, v72 quad_perm:[2,3,0,1] row_mask:0xf bank_mask:0xf
    v_add_f32_dpp v73, v73, v73 quad_perm:[2,3,0,1] row_mask:0xf bank_mask:0xf
    v_add_f32_dpp v74, v74, v74 quad_perm:[2,3,0,1] row_mask:0xf bank_mask:0xf
    v_add_f32_dpp v75, v75, v75 quad_perm:[2,3,0,1] row_mask:0xf bank_mask:0xf
    v_add_f32_dpp v76, v76, v76 quad_perm:[2,3,0,1] row_mask:0xf bank_mask:0xf
    v_add_f32_dpp v77, v77, v77 quad_perm:[2,3,0,1] row_mask:0xf bank_mask:0xf
    v_add_f32_dpp v78, v78, v78 quad_perm:[2,3,0,1] row_mask:0xf bank_mask:0xf
    v_add_f32_dpp v79, v79, v79 quad_perm:[2,3,0,1] row_mask:0xf bank_mask:0xf
    v_add_f32_dpp v80, v80, v80 quad_perm:[2,3,0,1] row_mask:0xf bank_mask:0xf
    v_add_f32_dpp v81, v81, v81 quad_perm:[2,3,0,1] row_mask:0xf bank_mask:0xf
    v_add_f32_dpp v82, v82, v82 quad_perm:[2,3,0,1] row_mask:0xf bank_mask:0xf
    v_add_f32_dpp v83, v83, v83 quad_perm:[2,3,0,1] row_mask:0xf bank_mask:0xf
    v_add_f32_dpp v84, v84, v84 quad_perm:[2,3,0,1] row_mask:0xf bank_mask:0xf
    v_add_f32_dpp v85, v85, v85 quad_perm:[2,3,0,1] row_mask:0xf bank_mask:0xf
    v_add_f32_dpp v86, v86, v86 quad_perm:[2,3,0,1] row_mask:0xf bank_mask:0xf
    v_add_f32_dpp v87, v87, v87 quad_perm:[2,3,0,1] row_mask:0xf bank_mask:0xf
    v_lshrrev_b32 v88, 2, v3
    v_lshlrev_b32 v88, 3, v88
    s_mul_i32 s72, s3, 80
    s_add_u32 s72, s72, 80384
    v_add_u32 v91, s72, v88
    v_mov_b32 v92, 80896
    v_cmp_gt_u32 vcc, 40, v3
    s_nop 1
    v_cndmask_b32 v91, v92, v91, vcc
    s_mul_i32 s72, s3, 320
    s_add_u32 s72, s72, 77824
    v_add_u32 v88, s72, v88
    v_add_u32 v90, 960, v88
    v_cmp_gt_u32 vcc, 32, v3
    s_nop 1
    v_cndmask_b32 v90, v90, v88, vcc
    v_cvt_pk_bf16_f32 v64, v64, v65
    v_cvt_pk_bf16_f32 v65, v66, v67
    ds_write_b64 v88, v[64:65] offset:0
    v_cvt_pk_bf16_f32 v68, v68, v69
    v_cvt_pk_bf16_f32 v69, v70, v71
    ds_write_b64 v88, v[68:69] offset:128
    v_cvt_pk_bf16_f32 v89, v72, v73
    v_lshlrev_b32 v72, 16, v89
    v_and_b32 v73, 0xffff0000, v89
    v_cvt_pk_bf16_f32 v89, v74, v75
    v_lshlrev_b32 v74, 16, v89
    v_and_b32 v75, 0xffff0000, v89
    v_add_f32 v72, v94, v72
    v_add_f32 v73, v94, v73
    v_add_f32 v74, v94, v74
    v_add_f32 v75, v94, v75
    v_cvt_pk_bf16_f32 v72, v72, v73
    v_cvt_pk_bf16_f32 v73, v74, v75
    ds_write_b64 v90, v[72:73] offset:256
    v_cvt_pk_bf16_f32 v89, v76, v77
    v_lshlrev_b32 v76, 16, v89
    v_and_b32 v77, 0xffff0000, v89
    v_cvt_pk_bf16_f32 v89, v78, v79
    v_lshlrev_b32 v78, 16, v89
    v_and_b32 v79, 0xffff0000, v89
    v_add_f32 v76, 1.0, v76
    v_add_f32 v77, 1.0, v77
    v_add_f32 v78, 1.0, v78
    v_add_f32 v79, 1.0, v79
    v_cvt_pk_bf16_f32 v76, v76, v77
    v_cvt_pk_bf16_f32 v77, v78, v79
    ds_write_b64 v88, v[76:77] offset:1344
    v_cvt_pk_bf16_f32 v89, v80, v81
    v_lshlrev_b32 v80, 16, v89
    v_and_b32 v81, 0xffff0000, v89
    v_cvt_pk_bf16_f32 v89, v82, v83
    v_lshlrev_b32 v82, 16, v89
    v_and_b32 v83, 0xffff0000, v89
    v_add_f32 v80, 1.0, v80
    v_add_f32 v81, 1.0, v81
    v_add_f32 v82, 1.0, v82
    v_add_f32 v83, 1.0, v83
    v_cvt_pk_bf16_f32 v80, v80, v81
    v_cvt_pk_bf16_f32 v81, v82, v83
    ds_write_b64 v88, v[80:81] offset:1472
    v_cvt_pk_bf16_f32 v84, v84, v85
    v_cvt_pk_bf16_f32 v85, v86, v87
    ds_write_b64 v91, v[84:85]
    v_lshlrev_b32 v33, 2, v3
    v_and_b32 v33, 60, v33
    s_add_u32 s74, s52, 0
    s_lshl_b32 s72, s3, 6
    s_add_u32 s74, s74, s72
    v_and_b32 v40, 0xfc, v3
    v_mul_u32_u24 v40, 28, v40
    v_lshl_add_u32 v31, v3, 2, v40
    s_lshl_b32 s75, s3, 11
    s_add_u32 s75, s75, 8192
    s_mov_b32 s73, 0
.Lpoll_8:
    s_add_u32 s73, s73, 1
    buffer_load_dword v40, v31, s[4:7], s75 offen sc1
    buffer_load_dword v44, v33, s[4:7], s74 offen sc1
    s_waitcnt vmcnt(0)
    v_xor_b32 v45, s42, v40
    v_xor_b32 v46, s42, v44
    v_or_b32 v45, v45, v46
    v_cmp_ne_u32 vcc, 0, v45
    s_cmp_ge_u32 s73, 20000
    s_cbranch_scc1 .Lpollx_9
    s_cmp_lg_u64 vcc, 0
    s_cbranch_scc1 .Lpoll_8
.Lpollx_9:
    buffer_load_dwordx4 v[96:99], v1, s[4:7], s89 offen offset:0 sc1
    buffer_load_dwordx4 v[100:103], v1, s[4:7], s89 offen offset:1024 sc1
    buffer_load_dwordx4 v[104:107], v1, s[4:7], s89 offen offset:2048 sc1
    buffer_load_dwordx4 v[108:111], v1, s[4:7], s89 offen offset:3072 sc1
    s_barrier
    s_add_u32 s87, s71, 0
    s_add_u32 m0, s70, 81920
    s_nop 0
    buffer_load_dwordx4 v1, s[4:7], s87 offen offset:0 sc1 lds
    buffer_load_dwordx4 v1, s[4:7], s87 offen offset:1024 sc1 lds
    buffer_load_dwordx4 v1, s[4:7], s87 offen offset:2048 sc1 lds
    buffer_load_dwordx4 v1, s[4:7], s87 offen offset:3072 sc1 lds
    s_add_u32 s87, s87, 4096
    s_add_u32 m0, m0, 4096
    s_nop 0
    buffer_load_dwordx4 v1, s[4:7], s87 offen offset:0 sc1 lds
    s_add_u32 s89, s89, 4096
    buffer_load_dwordx4 v[112:115], v1, s[4:7], s89 offen offset:0 sc1
    buffer_load_dwordx4 v[116:119], v1, s[4:7], s89 offen offset:1024 sc1
    s_add_u32 s87, s71, 20480
    s_add_u32 m0, s70, 102400
    s_nop 0
    buffer_load_dwordx4 v1, s[4:7], s87 offen offset:0 sc1 lds
    buffer_load_dwordx4 v1, s[4:7], s87 offen offset:1024 sc1 lds
    buffer_load_dwordx4 v1, s[4:7], s87 offen offset:2048 sc1 lds
    buffer_load_dwordx4 v1, s[4:7], s87 offen offset:3072 sc1 lds
    s_add_u32 s87, s87, 4096
    s_add_u32 m0, m0, 4096
    s_nop 0
    buffer_load_dwordx4 v1, s[4:7], s87 offen offset:0 sc1 lds
    buffer_load_dwordx4 v[120:123], v1, s[4:7], s89 offen offset:2048 sc1
    buffer_load_dwordx4 v[124:127], v1, s[4:7], s89 offen offset:3072 sc1
    s_add_u32 s89, s89, 4096
    buffer_load_dwordx4 v[128:131], v1, s[4:7], s89 offen offset:0 sc1
    buffer_load_dwordx4 v[132:135], v1, s[4:7], s89 offen offset:1024 sc1
    v_lshlrev_b32 v10, 2, v3
    v_add_u32 v8, 81920, v1
    v_add_u32 v9, 143360, v1
    v_and_b32 v21, 0xfc, v3
    v_mul_u32_u24 v21, 28, v21
    v_lshl_add_u32 v30, v3, 2, v21
    s_lshl_b32 s75, s3, 11
    s_add_u32 s75, s75, 8192
    s_add_u32 s75, s75, 8192
    s_mul_i32 s80, s40, 393216
    s_mul_i32 s72, s3, 40960
    s_add_u32 s80, s80, s72
    s_mul_i32 s72, s41, 1280
    s_add_u32 s80, s80, s72
    s_add_u32 s80, s80, 25427968
    s_lshl4_add_u32 s96, s40, s41
    s_mul_i32 s97, s96, 22528
    s_add_u32 s97, s97, 19660800
    s_mul_i32 s81, s3, 5632
    s_add_u32 s82, s97, s81
    s_add_u32 s83, s82, 2560
    s_min_u32 s93, s40, 2
    s_lshl_b32 s93, s93, 4
    s_sub_u32 s93, s96, s93
    s_lshl_b32 s93, s93, 7
    s_add_u32 s93, s93, 32768
    s_cmp_ge_u32 s40, 2
    s_cselect_b32 s72, 2048, 0
    v_and_b32 v19, 3, v3
    v_lshlrev_b32 v19, 2, v19
    v_bfe_u32 v18, v3, 2, 1
    v_mad_u32_u24 v19, v18, s72, v19
    s_cmp_ge_u32 s40, 1
    s_cselect_b32 s72, 0, 1073741824
    s_cselect_b32 s94, 360448, 0
    v_add_u32 v17, s72, v1
    s_sub_u32 s94, s97, s94
    s_cmp_ge_u32 s40, 2
    s_cselect_b32 s72, 0, 1073741824
    s_cselect_b32 s95, 720896, 0
    v_add_u32 v18, s72, v1
    s_sub_u32 s95, s97, s95
    s_cmp_lg_u32 s2, 0
    s_cbranch_scc1 .Lep_10
    v_mov_b32 v13, s50
    buffer_store_dword v13, v12, s[4:7], 0 offen sc1
.Lep_10:
    v_mov_b32 v23, v12
    s_waitcnt vmcnt(11)
    s_waitcnt lgkmcnt(0)
    s_barrier
    ds_read_b128 a[224:227], v8 offset:0
    ds_read_b128 a[228:231], v8 offset:1024
    ds_read_b128 a[232:235], v8 offset:2048
    ds_read_b128 a[236:239], v8 offset:3072
    ds_read_b128 a[240:243], v8 offset:4096
    ds_read_b128 a[244:247], v8 offset:5120
    s_waitcnt lgkmcnt(5)
    v_mfma_f32_16x16x32_bf16 v[32:35], a[224:227], v[96:99], 0
    s_add_u32 s87, s71, 40960
    s_add_u32 m0, s70, 122880
    ds_read_b128 a[248:251], v8 offset:6144
    buffer_load_dwordx4 v1, s[4:7], s87 offen offset:0 sc1 lds
    buffer_load_dwordx4 v[136:139], v1, s[4:7], s89 offen offset:2048 sc1
    v_mfma_f32_16x16x32_bf16 v[36:39], a[224:227], v[100:103], 0
    s_waitcnt lgkmcnt(5)
    s_barrier
    s_and_b32 s72, s2, 0xfc
    s_mul_i32 s72, s72, 28
    s_lshl2_add_u32 s72, s2, s72
    s_add_u32 s72, s72, 16384
    buffer_store_dword v5, v23, s[4:7], s72 offen sc1
    v_mfma_f32_16x16x32_bf16 v[40:43], a[228:231], v[96:99], 0
    ds_read_b128 a[252:255], v8 offset:7168
    v_mfma_f32_16x16x32_bf16 v[44:47], a[228:231], v[100:103], 0
    s_waitcnt lgkmcnt(5)
    v_mfma_f32_16x16x32_bf16 v[48:51], a[232:235], v[96:99], 0
    ds_read_b128 a[224:227], v8 offset:8192
    buffer_load_dwordx4 v[140:143], v1, s[4:7], s89 offen offset:3072 sc1
    v_mfma_f32_16x16x32_bf16 v[52:55], a[232:235], v[100:103], 0
    s_waitcnt lgkmcnt(5)
    v_mfma_f32_16x16x32_bf16 v[56:59], a[236:239], v[96:99], 0
    ds_read_b128 a[228:231], v8 offset:9216
    buffer_load_dwordx4 v1, s[4:7], s87 offen offset:1024 sc1 lds
    v_mfma_f32_16x16x32_bf16 v[60:63], a[236:239], v[100:103], 0
    s_waitcnt lgkmcnt(5)
    v_mfma_f32_16x16x32_bf16 v[64:67], a[240:243], v[96:99], 0
    ds_read_b128 a[232:235], v8 offset:10240
    v_mfma_f32_16x16x32_bf16 v[68:71], a[240:243], v[100:103], 0
    s_waitcnt lgkmcnt(5)
    v_mfma_f32_16x16x32_bf16 v[32:35], a[244:247], v[104:107], v[32:35]
    s_add_u32 s89, s89, 4096
    ds_read_b128 a[236:239], v8 offset:11264
    buffer_load_dwordx4 v[144:147], v1, s[4:7], s89 offen offset:0 sc1
    v_mfma_f32_16x16x32_bf16 v[36:39], a[244:247], v[108:111], v[36:39]
    s_waitcnt lgkmcnt(5)
    v_mfma_f32_16x16x32_bf16 v[40:43], a[248:251], v[104:107], v[40:43]
    ds_read_b128 a[240:243], v8 offset:12288
    v_mfma_f32_16x16x32_bf16 v[44:47], a[248:251], v[108:111], v[44:47]
    s_waitcnt lgkmcnt(5)
    v_mfma_f32_16x16x32_bf16 v[48:51], a[252:255], v[104:107], v[48:51]
    ds_read_b128 a[244:247], v8 offset:13312
    buffer_load_dwordx4 v1, s[4:7], s87 offen offset:2048 sc1 lds
    v_mfma_f32_16x16x32_bf16 v[52:55], a[252:255], v[108:111], v[52:55]
    s_waitcnt lgkmcnt(5)
    v_mfma_f32_16x16x32_bf16 v[56:59], a[224:227], v[104:107], v[56:59]
    ds_read_b128 a[248:251], v8 offset:14336
    buffer_load_dwordx4 v[148:151], v1, s[4:7], s89 offen offset:1024 sc1
    v_mfma_f32_16x16x32_bf16 v[60:63], a[224:227], v[108:111], v[60:63]
    s_waitcnt lgkmcnt(5)
    v_mfma_f32_16x16x32_bf16 v[64:67], a[228:231], v[104:107], v[64:67]
    ds_read_b128 a[252:255], v8 offset:15360
    v_mfma_f32_16x16x32_bf16 v[68:71], a[228:231], v[108:111], v[68:71]
    s_waitcnt vmcnt(18) lgkmcnt(5)
    v_mfma_f32_16x16x32_bf16 v[32:35], a[232:235], v[112:115], v[32:35]
    s_waitcnt vmcnt(17)
    ds_read_b128 a[224:227], v8 offset:16384
    v_mfma_f32_16x16x32_bf16 v[36:39], a[232:235], v[116:119], v[36:39]
    s_waitcnt lgkmcnt(5)
    v_mfma_f32_16x16x32_bf16 v[40:43], a[236:239], v[112:115], v[40:43]
    ds_read_b128 a[228:231], v8 offset:17408
    buffer_load_dwordx4 v1, s[4:7], s87 offen offset:3072 sc1 lds
    buffer_load_dwordx4 v[152:155], v1, s[4:7], s89 offen offset:2048 sc1
    v_mfma_f32_16x16x32_bf16 v[44:47], a[236:239], v[116:119], v[44:47]
    s_waitcnt lgkmcnt(5)
    v_mfma_f32_16x16x32_bf16 v[48:51], a[240:243], v[112:115], v[48:51]
    ds_read_b128 a[232:235], v8 offset:18432
    v_mfma_f32_16x16x32_bf16 v[52:55], a[240:243], v[116:119], v[52:55]
    s_waitcnt lgkmcnt(5)
    v_mfma_f32_16x16x32_bf16 v[56:59], a[244:247], v[112:115], v[56:59]
    ds_read_b128 a[236:239], v8 offset:19456
    v_mfma_f32_16x16x32_bf16 v[60:63], a[244:247], v[116:119], v[60:63]
    s_waitcnt lgkmcnt(5)
    v_mfma_f32_16x16x32_bf16 v[64:67], a[248:251], v[112:115], v[64:67]
    s_waitcnt vmcnt(14)
    s_barrier
    ds_read_b128 a[240:243], v8 offset:20480
    buffer_load_dwordx4 v[156:159], v1, s[4:7], s89 offen offset:3072 sc1
    v_mfma_f32_16x16x32_bf16 v[68:71], a[248:251], v[116:119], v[68:71]
    s_waitcnt vmcnt(14) lgkmcnt(5)
    v_mfma_f32_16x16x32_bf16 v[32:35], a[252:255], v[120:123], v[32:35]
    s_waitcnt vmcnt(13)
    s_add_u32 s87, s87, 4096
    s_add_u32 m0, m0, 4096
    ds_read_b128 a[244:247], v8 offset:21504
    buffer_load_dwordx4 v1, s[4:7], s87 offen offset:0 sc1 lds
    v_mfma_f32_16x16x32_bf16 v[36:39], a[252:255], v[124:127], v[36:39]
    s_waitcnt lgkmcnt(5)
    v_mfma_f32_16x16x32_bf16 v[40:43], a[224:227], v[120:123], v[40:43]
    ds_read_b128 a[248:251], v8 offset:22528
    v_mfma_f32_16x16x32_bf16 v[44:47], a[224:227], v[124:127], v[44:47]
    s_waitcnt lgkmcnt(5)
    v_mfma_f32_16x16x32_bf16 v[48:51], a[228:231], v[120:123], v[48:51]
    s_add_u32 s89, s89, 4096
    ds_read_b128 a[252:255], v8 offset:23552
    buffer_load_dwordx4 v[160:163], v1, s[4:7], s89 offen offset:0 sc1
    v_mfma_f32_16x16x32_bf16 v[52:55], a[228:231], v[124:127], v[52:55]
    s_waitcnt lgkmcnt(5)
    v_mfma_f32_16x16x32_bf16 v[56:59], a[232:235], v[120:123], v[56:59]
    ds_read_b128 a[224:227], v8 offset:24576
    v_mfma_f32_16x16x32_bf16 v[60:63], a[232:235], v[124:127], v[60:63]
    s_waitcnt lgkmcnt(5)
    v_mfma_f32_16x16x32_bf16 v[64:67], a[236:239], v[120:123], v[64:67]
    s_add_u32 s87, s71, 61440
    s_add_u32 m0, s70, 143360
    ds_read_b128 a[228:231], v8 offset:25600
    buffer_load_dwordx4 v1, s[4:7], s87 offen offset:0 sc1 lds
    v_mfma_f32_16x16x32_bf16 v[68:71], a[236:239], v[124:127], v[68:71]
    s_waitcnt vmcnt(15) lgkmcnt(5)
    v_mfma_f32_16x16x32_bf16 v[32:35], a[240:243], v[128:131], v[32:35]
    s_waitcnt vmcnt(14)
    ds_read_b128 a[232:235], v8 offset:26624
    buffer_load_dwordx4 v[164:167], v1, s[4:7], s89 offen offset:1024 sc1
    v_mfma_f32_16x16x32_bf16 v[36:39], a[240:243], v[132:135], v[36:39]
    s_waitcnt lgkmcnt(5)
    v_mfma_f32_16x16x32_bf16 v[40:43], a[244:247], v[128:131], v[40:43]
    ds_read_b128 a[236:239], v8 offset:27648
    v_mfma_f32_16x16x32_bf16 v[44:47], a[244:247], v[132:135], v[44:47]
    s_waitcnt lgkmcnt(5)
    v_mfma_f32_16x16x32_bf16 v[48:51], a[248:251], v[128:131], v[48:51]
    ds_read_b128 a[240:243], v8 offset:28672
    buffer_load_dwordx4 v[168:171], v1, s[4:7], s89 offen offset:2048 sc1
    v_mfma_f32_16x16x32_bf16 v[52:55], a[248:251], v[132:135], v[52:55]
    s_waitcnt lgkmcnt(5)
    v_mfma_f32_16x16x32_bf16 v[56:59], a[252:255], v[128:131], v[56:59]
    ds_read_b128 a[244:247], v8 offset:29696
    buffer_load_dwordx4 v1, s[4:7], s87 offen offset:1024 sc1 lds
    v_mfma_f32_16x16x32_bf16 v[60:63], a[252:255], v[132:135], v[60:63]
    s_waitcnt lgkmcnt(5)
    v_mfma_f32_16x16x32_bf16 v[64:67], a[224:227], v[128:131], v[64:67]
    ds_read_b128 a[248:251], v8 offset:30720
    v_mfma_f32_16x16x32_bf16 v[68:71], a[224:227], v[132:135], v[68:71]
    s_waitcnt vmcnt(15) lgkmcnt(5)
    v_mfma_f32_16x16x32_bf16 v[32:35], a[228:231], v[136:139], v[32:35]
    s_waitcnt vmcnt(13)
    ds_read_b128 a[252:255], v8 offset:31744
    buffer_load_dwordx4 v[172:175], v1, s[4:7], s89 offen offset:3072 sc1
    v_mfma_f32_16x16x32_bf16 v[36:39], a[228:231], v[140:143], v[36:39]
    s_waitcnt lgkmcnt(5)
    v_mfma_f32_16x16x32_bf16 v[40:43], a[232:235], v[136:139], v[40:43]
.Lisl1:
    s_cbranch_execz .Lisl2
    ds_read_b128 a[224:227], v8 offset:32768
    v_mfma_f32_16x16x32_bf16 v[44:47], a[232:235], v[140:143], v[44:47]
    s_waitcnt lgkmcnt(5)
    v_mfma_f32_16x16x32_bf16 v[48:51], a[236:239], v[136:139], v[48:51]
    ds_read_b128 a[228:231], v8 offset:33792
    buffer_load_dwordx4 v1, s[4:7], s87 offen offset:2048 sc1 lds
    v_mfma_f32_16x16x32_bf16 v[52:55], a[236:239], v[140:143], v[52:55]
    s_waitcnt lgkmcnt(5)
    v_mfma_f32_16x16x32_bf16 v[56:59], a[240:243], v[136:139], v[56:59]
    s_add_u32 s89, s89, 4096
    ds_read_b128 a[232:235], v8 offset:34816
    buffer_load_dwordx4 v[176:179], v1, s[4:7], s89 offen offset:0 sc1
    v_mfma_f32_16x16x32_bf16 v[60:63], a[240:243], v[140:143], v[60:63]
    s_waitcnt lgkmcnt(5)
    v_mfma_f32_16x16x32_bf16 v[64:67], a[244:247], v[136:139], v[64:67]
    ds_read_b128 a[236:239], v8 offset:35840
    v_mfma_f32_16x16x32_bf16 v[68:71], a[244:247], v[140:143], v[68:71]
    s_waitcnt vmcnt(14) lgkmcnt(5)
    v_mfma_f32_16x16x32_bf16 v[32:35], a[248:251], v[144:147], v[32:35]
    s_waitcnt vmcnt(12)
    ds_read_b128 a[240:243], v8 offset:36864
    v_mfma_f32_16x16x32_bf16 v[36:39], a[248:251], v[148:151], v[36:39]
    s_waitcnt lgkmcnt(5)
    v_mfma_f32_16x16x32_bf16 v[40:43], a[252:255], v[144:147], v[40:43]
    ds_read_b128 a[244:247], v8 offset:37888
    buffer_load_dwordx4 v1, s[4:7], s87 offen offset:3072 sc1 lds
    buffer_load_dwordx4 v[180:183], v1, s[4:7], s89 offen offset:1024 sc1
    v_mfma_f32_16x16x32_bf16 v[44:47], a[252:255], v[148:151], v[44:47]
    s_waitcnt lgkmcnt(5)
    v_mfma_f32_16x16x32_bf16 v[48:51], a[224:227], v[144:147], v[48:51]
    ds_read_b128 a[248:251], v8 offset:38912
    v_mfma_f32_16x16x32_bf16 v[52:55], a[224:227], v[148:151], v[52:55]
    s_waitcnt lgkmcnt(5)
    v_mfma_f32_16x16x32_bf16 v[56:59], a[228:231], v[144:147], v[56:59]
    ds_read_b128 a[252:255], v8 offset:39936
    v_mfma_f32_16x16x32_bf16 v[60:63], a[228:231], v[148:151], v[60:63]
    s_waitcnt lgkmcnt(5)
    v_mfma_f32_16x16x32_bf16 v[64:67], a[232:235], v[144:147], v[64:67]
    s_waitcnt vmcnt(10)
    s_barrier
    ds_read_b128 a[224:227], v8 offset:40960
    buffer_load_dwordx4 v[184:187], v1, s[4:7], s89 offen offset:2048 sc1
    v_mfma_f32_16x16x32_bf16 v[68:71], a[232:235], v[148:151], v[68:71]
    s_waitcnt lgkmcnt(5)
    v_mfma_f32_16x16x32_bf16 v[32:35], a[236:239], v[152:155], v[32:35]
    s_add_u32 s87, s87, 4096
    s_add_u32 m0, m0, 4096
    ds_read_b128 a[228:231], v8 offset:41984
    buffer_load_dwordx4 v1, s[4:7], s87 offen offset:0 sc1 lds
    v_mfma_f32_16x16x32_bf16 v[36:39], a[236:239], v[156:159], v[36:39]
    s_waitcnt lgkmcnt(5)
    v_mfma_f32_16x16x32_bf16 v[40:43], a[240:243], v[152:155], v[40:43]
    ds_read_b128 a[232:235], v8 offset:43008
    v_mfma_f32_16x16x32_bf16 v[44:47], a[240:243], v[156:159], v[44:47]
    s_waitcnt lgkmcnt(5)
    v_mfma_f32_16x16x32_bf16 v[48:51], a[244:247], v[152:155], v[48:51]
    ds_read_b128 a[236:239], v8 offset:44032
    buffer_load_dwordx4 v[188:191], v1, s[4:7], s89 offen offset:3072 sc1
    v_mfma_f32_16x16x32_bf16 v[52:55], a[244:247], v[156:159], v[52:55]
    s_waitcnt lgkmcnt(5)
    v_mfma_f32_16x16x32_bf16 v[56:59], a[248:251], v[152:155], v[56:59]
    ds_read_b128 a[240:243], v8 offset:45056
    v_mfma_f32_16x16x32_bf16 v[60:63], a[248:251], v[156:159], v[60:63]
    s_waitcnt lgkmcnt(5)
    v_mfma_f32_16x16x32_bf16 v[64:67], a[252:255], v[152:155], v[64:67]
    s_add_u32 s87, s71, 81920
    s_add_u32 m0, s70, 0
    ds_read_b128 a[244:247], v8 offset:46080
    buffer_load_dwordx4 v1, s[4:7], s87 offen offset:0 sc1 lds
    v_mfma_f32_16x16x32_bf16 v[68:71], a[252:255], v[156:159], v[68:71]
    s_waitcnt vmcnt(13) lgkmcnt(5)
    v_mfma_f32_16x16x32_bf16 v[32:35], a[224:227], v[160:163], v[32:35]
    s_waitcnt vmcnt(11)
    s_add_u32 s89, s89, 4096
    ds_read_b128 a[248:251], v8 offset:47104
    buffer_load_dwordx4 v[192:195], v1, s[4:7], s89 offen offset:0 sc1
    v_mfma_f32_16x16x32_bf16 v[36:39], a[224:227], v[164:167], v[36:39]
    s_waitcnt lgkmcnt(5)
    v_mfma_f32_16x16x32_bf16 v[40:43], a[228:231], v[160:163], v[40:43]
    ds_read_b128 a[252:255], v8 offset:48128
    v_mfma_f32_16x16x32_bf16 v[44:47], a[228:231], v[164:167], v[44:47]
    s_waitcnt lgkmcnt(5)
    v_mfma_f32_16x16x32_bf16 v[48:51], a[232:235], v[160:163], v[48:51]
    ds_read_b128 a[224:227], v8 offset:49152
    v_mfma_f32_16x16x32_bf16 v[52:55], a[232:235], v[164:167], v[52:55]
    s_waitcnt lgkmcnt(5)
    v_mfma_f32_16x16x32_bf16 v[56:59], a[236:239], v[160:163], v[56:59]
    ds_read_b128 a[228:231], v8 offset:50176
    buffer_load_dwordx4 v1, s[4:7], s87 offen offset:1024 sc1 lds
    buffer_load_dwordx4 v[196:199], v1, s[4:7], s89 offen offset:1024 sc1
    v_mfma_f32_16x16x32_bf16 v[60:63], a[236:239], v[164:167], v[60:63]
    s_waitcnt lgkmcnt(5)
    v_mfma_f32_16x16x32_bf16 v[64:67], a[240:243], v[160:163], v[64:67]
    ds_read_b128 a[232:235], v8 offset:51200
    v_mfma_f32_16x16x32_bf16 v[68:71], a[240:243], v[164:167], v[68:71]
    s_waitcnt vmcnt(13) lgkmcnt(5)
    v_mfma_f32_16x16x32_bf16 v[32:35], a[244:247], v[168:171], v[32:35]
    s_waitcnt vmcnt(11)
    ds_read_b128 a[236:239], v8 offset:52224
    buffer_load_dwordx4 v[200:203], v1, s[4:7], s89 offen offset:2048 sc1
    v_mfma_f32_16x16x32_bf16 v[36:39], a[244:247], v[172:175], v[36:39]
    s_waitcnt lgkmcnt(5)
    v_mfma_f32_16x16x32_bf16 v[40:43], a[248:251], v[168:171], v[40:43]
    ds_read_b128 a[240:243], v8 offset:53248
    v_mfma_f32_16x16x32_bf16 v[44:47], a[248:251], v[172:175], v[44:47]
    s_waitcnt lgkmcnt(5)
    v_mfma_f32_16x16x32_bf16 v[48:51], a[252:255], v[168:171], v[48:51]
    ds_read_b128 a[244:247], v8 offset:54272
    buffer_load_dwordx4 v1, s[4:7], s87 offen offset:2048 sc1 lds
    v_mfma_f32_16x16x32_bf16 v[52:55], a[252:255], v[172:175], v[52:55]
    s_waitcnt lgkmcnt(5)
    v_mfma_f32_16x16x32_bf16 v[56:59], a[224:227], v[168:171], v[56:59]
    ds_read_b128 a[248:251], v8 offset:55296
    buffer_load_dwordx4 v[204:207], v1, s[4:7], s89 offen offset:3072 sc1
    v_mfma_f32_16x16x32_bf16 v[60:63], a[224:227], v[172:175], v[60:63]
    s_waitcnt lgkmcnt(5)
    v_mfma_f32_16x16x32_bf16 v[64:67], a[228:231], v[168:171], v[64:67]
    ds_read_b128 a[252:255], v8 offset:56320
    v_mfma_f32_16x16x32_bf16 v[68:71], a[228:231], v[172:175], v[68:71]
    s_waitcnt vmcnt(12) lgkmcnt(5)
    v_mfma_f32_16x16x32_bf16 v[32:35], a[232:235], v[176:179], v[32:35]
    s_waitcnt vmcnt(10)
    ds_read_b128 a[224:227], v8 offset:57344
    v_mfma_f32_16x16x32_bf16 v[36:39], a[232:235], v[180:183], v[36:39]
    s_waitcnt lgkmcnt(5)
    v_mfma_f32_16x16x32_bf16 v[40:43], a[236:239], v[176:179], v[40:43]
    ds_read_b128 a[228:231], v8 offset:58368
    buffer_load_dwordx4 v1, s[4:7], s87 offen offset:3072 sc1 lds
    s_add_u32 s89, s89, 4096
    buffer_load_dwordx4 v[208:211], v1, s[4:7], s89 offen offset:0 sc1
    v_mfma_f32_16x16x32_bf16 v[44:47], a[236:239], v[180:183], v[44:47]
    s_waitcnt lgkmcnt(5)
    v_mfma_f32_16x16x32_bf16 v[48:51], a[240:243], v[176:179], v[48:51]
    ds_read_b128 a[232:235], v8 offset:59392
    v_mfma_f32_16x16x32_bf16 v[52:55], a[240:243], v[180:183], v[52:55]
    s_waitcnt lgkmcnt(5)
    v_mfma_f32_16x16x32_bf16 v[56:59], a[244:247], v[176:179], v[56:59]
    ds_read_b128 a[236:239], v8 offset:60416
    v_mfma_f32_16x16x32_bf16 v[60:63], a[244:247], v[180:183], v[60:63]
    s_waitcnt lgkmcnt(5)
    v_mfma_f32_16x16x32_bf16 v[64:67], a[248:251], v[176:179], v[64:67]
    s_waitcnt vmcnt(10)
    s_barrier
    ds_read_b128 a[240:243], v9 offset:0
    buffer_load_dwordx4 v[212:215], v1, s[4:7], s89 offen offset:1024 sc1
    v_mfma_f32_16x16x32_bf16 v[68:71], a[248:251], v[180:183], v[68:71]
    s_waitcnt lgkmcnt(5)
    v_mfma_f32_16x16x32_bf16 v[32:35], a[252:255], v[184:187], v[32:35]
    s_waitcnt vmcnt(10)
    s_add_u32 s87, s87, 4096
    s_add_u32 m0, m0, 4096
    ds_read_b128 a[244:247], v9 offset:1024
    buffer_load_dwordx4 v1, s[4:7], s87 offen offset:0 sc1 lds
    v_mfma_f32_16x16x32_bf16 v[36:39], a[252:255], v[188:191], v[36:39]
    s_waitcnt lgkmcnt(5)
    v_mfma_f32_16x16x32_bf16 v[40:43], a[224:227], v[184:187], v[40:43]
    ds_read_b128 a[248:251], v9 offset:2048
    v_mfma_f32_16x16x32_bf16 v[44:47], a[224:227], v[188:191], v[44:47]
    s_waitcnt lgkmcnt(5)
    v_mfma_f32_16x16x32_bf16 v[48:51], a[228:231], v[184:187], v[48:51]
    ds_read_b128 a[252:255], v9 offset:3072
    buffer_load_dwordx4 v[216:219], v1, s[4:7], s89 offen offset:2048 sc1
    v_mfma_f32_16x16x32_bf16 v[52:55], a[228:231], v[188:191], v[52:55]
    s_waitcnt lgkmcnt(5)
    v_mfma_f32_16x16x32_bf16 v[56:59], a[232:235], v[184:187], v[56:59]
    ds_read_b128 a[224:227], v9 offset:4096
    v_mfma_f32_16x16x32_bf16 v[60:63], a[232:235], v[188:191], v[60:63]
    s_waitcnt lgkmcnt(5)
    v_mfma_f32_16x16x32_bf16 v[64:67], a[236:239], v[184:187], v[64:67]
    s_mul_i32 s88, s3, 6
    s_lshl_b32 s88, s88, 10
    s_add_u32 s87, s92, s88
    s_add_u32 s87, s87, 102400
    s_add_u32 m0, s88, 81920
    ds_read_b128 a[228:231], v9 offset:5120
    buffer_load_dwordx4 v1, s[4:7], s87 offen offset:0 sc1 lds
    v_mfma_f32_16x16x32_bf16 v[68:71], a[236:239], v[188:191], v[68:71]
    s_waitcnt vmcnt(11) lgkmcnt(5)
    v_mfma_f32_16x16x32_bf16 v[32:35], a[240:243], v[192:195], v[32:35]
    s_waitcnt vmcnt(9)
    ds_read_b128 a[232:235], v9 offset:6144
    buffer_load_dwordx4 v[220:223], v1, s[4:7], s89 offen offset:3072 sc1
    v_mfma_f32_16x16x32_bf16 v[36:39], a[240:243], v[196:199], v[36:39]
    s_waitcnt lgkmcnt(5)
    v_mfma_f32_16x16x32_bf16 v[40:43], a[244:247], v[192:195], v[40:43]
    ds_read_b128 a[236:239], v9 offset:7168
    v_mfma_f32_16x16x32_bf16 v[44:47], a[244:247], v[196:199], v[44:47]
    s_waitcnt lgkmcnt(5)
    v_mfma_f32_16x16x32_bf16 v[48:51], a[248:251], v[192:195], v[48:51]
    ds_read_b128 a[240:243], v9 offset:8192
    buffer_load_dwordx4 v1, s[4:7], s87 offen offset:1024 sc1 lds
    v_mfma_f32_16x16x32_bf16 v[52:55], a[248:251], v[196:199], v[52:55]
    s_waitcnt lgkmcnt(5)
    v_mfma_f32_16x16x32_bf16 v[56:59], a[252:255], v[192:195], v[56:59]
    s_add_u32 s89, s89, 4096
    ds_read_b128 a[244:247], v9 offset:9216
    buffer_load_dwordx4 v[224:227], v1, s[4:7], s89 offen offset:0 sc1
    v_mfma_f32_16x16x32_bf16 v[60:63], a[252:255], v[196:199], v[60:63]
    s_waitcnt lgkmcnt(5)
    v_mfma_f32_16x16x32_bf16 v[64:67], a[224:227], v[192:195], v[64:67]
    ds_read_b128 a[248:251], v9 offset:10240
    v_mfma_f32_16x16x32_bf16 v[68:71], a[224:227], v[196:199], v[68:71]
    s_waitcnt vmcnt(11) lgkmcnt(5)
    v_mfma_f32_16x16x32_bf16 v[32:35], a[228:231], v[200:203], v[32:35]
    s_waitcnt vmcnt(9)
    ds_read_b128 a[252:255], v9 offset:11264
    buffer_load_dwordx4 v[228:231], v1, s[4:7], s89 offen offset:1024 sc1
    buffer_load_dwordx4 v1, s[4:7], s87 offen offset:2048 sc1 lds
    v_mfma_f32_16x16x32_bf16 v[36:39], a[228:231], v[204:207], v[36:39]
    s_waitcnt lgkmcnt(5)
    v_mfma_f32_16x16x32_bf16 v[40:43], a[232:235], v[200:203], v[40:43]
    ds_read_b128 a[224:227], v9 offset:12288
    v_mfma_f32_16x16x32_bf16 v[44:47], a[232:235], v[204:207], v[44:47]
    s_waitcnt lgkmcnt(5)
    v_mfma_f32_16x16x32_bf16 v[48:51], a[236:239], v[200:203], v[48:51]
    ds_read_b128 a[228:231], v9 offset:13312
    v_mfma_f32_16x16x32_bf16 v[52:55], a[236:239], v[204:207], v[52:55]
    s_waitcnt lgkmcnt(5)
    v_mfma_f32_16x16x32_bf16 v[56:59], a[240:243], v[200:203], v[56:59]
    ds_read_b128 a[232:235], v9 offset:14336
    buffer_load_dwordx4 v[232:235], v1, s[4:7], s89 offen offset:2048 sc1
    v_mfma_f32_16x16x32_bf16 v[60:63], a[240:243], v[204:207], v[60:63]
    s_waitcnt lgkmcnt(5)
    v_mfma_f32_16x16x32_bf16 v[64:67], a[244:247], v[200:203], v[64:67]
    ds_read_b128 a[236:239], v9 offset:15360
    buffer_load_dwordx4 v1, s[4:7], s87 offen offset:3072 sc1 lds
    v_mfma_f32_16x16x32_bf16 v[68:71], a[244:247], v[204:207], v[68:71]
    s_waitcnt vmcnt(11) lgkmcnt(5)
    v_mfma_f32_16x16x32_bf16 v[32:35], a[248:251], v[208:211], v[32:35]
    s_waitcnt vmcnt(10)
    ds_read_b128 a[240:243], v9 offset:16384
    v_mfma_f32_16x16x32_bf16 v[36:39], a[248:251], v[212:215], v[36:39]
    s_waitcnt lgkmcnt(5)
    v_mfma_f32_16x16x32_bf16 v[40:43], a[252:255], v[208:211], v[40:43]
    ds_read_b128 a[244:247], v9 offset:17408
    buffer_load_dwordx4 v[236:239], v1, s[4:7], s89 offen offset:3072 sc1
    v_mfma_f32_16x16x32_bf16 v[44:47], a[252:255], v[212:215], v[44:47]
    s_waitcnt lgkmcnt(5)
    v_mfma_f32_16x16x32_bf16 v[48:51], a[224:227], v[208:211], v[48:51]
    s_add_u32 s87, s87, 4096
    s_add_u32 m0, m0, 4096
    ds_read_b128 a[248:251], v9 offset:18432
    buffer_load_dwordx4 v1, s[4:7], s87 offen offset:0 sc1 lds
    v_mfma_f32_16x16x32_bf16 v[52:55], a[224:227], v[212:215], v[52:55]
    s_waitcnt lgkmcnt(5)
    v_mfma_f32_16x16x32_bf16 v[56:59], a[228:231], v[208:211], v[56:59]
    ds_read_b128 a[252:255], v9 offset:19456
    v_mfma_f32_16x16x32_bf16 v[60:63], a[228:231], v[212:215], v[60:63]
    s_waitcnt lgkmcnt(5)
    v_mfma_f32_16x16x32_bf16 v[64:67], a[232:235], v[208:211], v[64:67]
    s_waitcnt vmcnt(11)
    s_barrier
    ds_read_b128 a[224:227], v1 offset:0
    s_add_u32 s89, s89, 4096
    buffer_load_dwordx4 v[240:243], v1, s[4:7], s89 offen offset:0 sc1
    v_mfma_f32_16x16x32_bf16 v[68:71], a[232:235], v[212:215], v[68:71]
    s_waitcnt vmcnt(11) lgkmcnt(5)
    v_mfma_f32_16x16x32_bf16 v[32:35], a[236:239], v[216:219], v[32:35]
    s_waitcnt vmcnt(9)
    ds_read_b128 a[228:231], v1 offset:1024
    buffer_load_dwordx4 v1, s[4:7], s87 offen offset:1024 sc1 lds
    buffer_load_dword v31, v30, s[4:7], s75 offen sc1
    v_mfma_f32_16x16x32_bf16 v[36:39], a[236:239], v[220:223], v[36:39]
    s_waitcnt lgkmcnt(5)
    v_mfma_f32_16x16x32_bf16 v[40:43], a[240:243], v[216:219], v[40:43]
    ds_read_b128 a[232:235], v1 offset:2048
    v_mfma_f32_16x16x32_bf16 v[44:47], a[240:243], v[220:223], v[44:47]
    s_waitcnt lgkmcnt(5)
    v_mfma_f32_16x16x32_bf16 v[48:51], a[244:247], v[216:219], v[48:51]
    ds_read_b128 a[236:239], v1 offset:3072
    buffer_load_dwordx4 v[244:247], v1, s[4:7], s89 offen offset:1024 sc1
    v_mfma_f32_16x16x32_bf16 v[52:55], a[244:247], v[220:223], v[52:55]
    s_waitcnt lgkmcnt(5)
    v_mfma_f32_16x16x32_bf16 v[56:59], a[248:251], v[216:219], v[56:59]
    ds_read_b128 a[240:243], v1 offset:4096
    v_mfma_f32_16x16x32_bf16 v[60:63], a[248:251], v[220:223], v[60:63]
    s_waitcnt lgkmcnt(5)
    v_mfma_f32_16x16x32_bf16 v[64:67], a[252:255], v[216:219], v[64:67]
    s_mul_i32 s88, s3, 9
    s_lshl_b32 s88, s88, 10
    s_add_u32 s87, s92, s88
    s_add_u32 s87, s87, 126976
    s_add_u32 m0, s88, 106496
    ds_read_b128 a[244:247], v1 offset:5120
    buffer_load_dwordx4 v1, s[4:7], s87 offen offset:0 sc1 lds
    v_mfma_f32_16x16x32_bf16 v[68:71], a[252:255], v[220:223], v[68:71]
    s_waitcnt vmcnt(11) lgkmcnt(5)
    v_mfma_f32_16x16x32_bf16 v[32:35], a[224:227], v[224:227], v[32:35]
    s_waitcnt vmcnt(10)
    ds_read_b128 a[248:251], v1 offset:6144
    buffer_load_dwordx4 v[248:251], v1, s[4:7], s89 offen offset:2048 sc1
    v_mfma_f32_16x16x32_bf16 v[36:39], a[224:227], v[228:231], v[36:39]
    s_waitcnt lgkmcnt(5)
    v_mfma_f32_16x16x32_bf16 v[40:43], a[228:231], v[224:227], v[40:43]
    ds_read_b128 a[252:255], v1 offset:7168
    buffer_load_dwordx4 v1, s[4:7], s87 offen offset:1024 sc1 lds
    v_mfma_f32_16x16x32_bf16 v[44:47], a[228:231], v[228:231], v[44:47]
    s_waitcnt lgkmcnt(5)
    v_mfma_f32_16x16x32_bf16 v[48:51], a[232:235], v[224:227], v[48:51]
    ds_read_b128 a[224:227], v1 offset:8192
    v_mfma_f32_16x16x32_bf16 v[52:55], a[232:235], v[228:231], v[52:55]
    s_waitcnt lgkmcnt(5)
    v_mfma_f32_16x16x32_bf16 v[56:59], a[236:239], v[224:227], v[56:59]
    ds_read_b128 a[228:231], v1 offset:9216
    buffer_load_dwordx4 v[252:255], v1, s[4:7], s89 offen offset:3072 sc1
    buffer_load_dwordx4 v1, s[4:7], s87 offen offset:2048 sc1 lds
    v_mfma_f32_16x16x32_bf16 v[60:63], a[236:239], v[228:231], v[60:63]
    s_waitcnt lgkmcnt(5)
    v_mfma_f32_16x16x32_bf16 v[64:67], a[240:243], v[224:227], v[64:67]
    ds_read_b128 a[232:235], v1 offset:10240
    v_mfma_f32_16x16x32_bf16 v[68:71], a[240:243], v[228:231], v[68:71]
    s_waitcnt vmcnt(12) lgkmcnt(5)
    v_mfma_f32_16x16x32_bf16 v[32:35], a[244:247], v[232:235], v[32:35]
    s_waitcnt vmcnt(10)
    ds_read_b128 a[236:239], v1 offset:11264
    v_mfma_f32_16x16x32_bf16 v[36:39], a[244:247], v[236:239], v[36:39]
    s_waitcnt lgkmcnt(5)
    v_mfma_f32_16x16x32_bf16 v[40:43], a[248:251], v[232:235], v[40:43]
    ds_read_b128 a[240:243], v1 offset:12288
    buffer_load_dwordx4 v1, s[4:7], s87 offen offset:3072 sc1 lds
    v_mfma_f32_16x16x32_bf16 v[44:47], a[248:251], v[236:239], v[44:47]
    s_waitcnt lgkmcnt(5)
    v_mfma_f32_16x16x32_bf16 v[48:51], a[252:255], v[232:235], v[48:51]
    ds_read_b128 a[244:247], v1 offset:13312
    v_mfma_f32_16x16x32_bf16 v[52:55], a[252:255], v[236:239], v[52:55]
    s_waitcnt lgkmcnt(5)
    v_mfma_f32_16x16x32_bf16 v[56:59], a[224:227], v[232:235], v[56:59]
    s_add_u32 s87, s87, 4096
    s_add_u32 m0, m0, 4096
    ds_read_b128 a[248:251], v1 offset:14336
    buffer_load_dwordx4 v1, s[4:7], s87 offen offset:0 sc1 lds
    v_mfma_f32_16x16x32_bf16 v[60:63], a[224:227], v[236:239], v[60:63]
    s_waitcnt lgkmcnt(5)
    v_mfma_f32_16x16x32_bf16 v[64:67], a[228:231], v[232:235], v[64:67]
    ds_read_b128 a[252:255], v1 offset:15360
    v_mfma_f32_16x16x32_bf16 v[68:71], a[228:231], v[236:239], v[68:71]
    s_waitcnt vmcnt(10) lgkmcnt(5)
    v_mfma_f32_16x16x32_bf16 v[32:35], a[232:235], v[240:243], v[32:35]
    s_waitcnt vmcnt(7)
    ds_read_b128 a[224:227], v1 offset:16384
    v_mfma_f32_16x16x32_bf16 v[36:39], a[232:235], v[244:247], v[36:39]
    s_waitcnt lgkmcnt(5)
    v_mfma_f32_16x16x32_bf16 v[40:43], a[236:239], v[240:243], v[40:43]
    ds_read_b128 a[228:231], v1 offset:17408
    buffer_load_dwordx4 v1, s[4:7], s87 offen offset:1024 sc1 lds
    v_mfma_f32_16x16x32_bf16 v[44:47], a[236:239], v[244:247], v[44:47]
    s_waitcnt lgkmcnt(5)
    v_mfma_f32_16x16x32_bf16 v[48:51], a[240:243], v[240:243], v[48:51]
    ds_read_b128 a[232:235], v1 offset:18432
    v_mfma_f32_16x16x32_bf16 v[52:55], a[240:243], v[244:247], v[52:55]
    s_waitcnt lgkmcnt(5)
    v_mfma_f32_16x16x32_bf16 v[56:59], a[244:247], v[240:243], v[56:59]
    ds_read_b128 a[236:239], v1 offset:19456
    buffer_load_dwordx4 v1, s[4:7], s87 offen offset:2048 sc1 lds
    v_cmp_ne_u32 vcc, s42, v31
    s_nop 0
    s_cmp_lg_u64 vcc, 0
    s_cbranch_scc1 .Lrcs_12
.Lrcb_11:
    v_mfma_f32_16x16x32_bf16 v[60:63], a[244:247], v[244:247], v[60:63]
    s_waitcnt lgkmcnt(5)
    v_mfma_f32_16x16x32_bf16 v[64:67], a[248:251], v[240:243], v[64:67]
    s_barrier
    ds_read_b128 a[240:243], v8 offset:2048
    v_mfma_f32_16x16x32_bf16 v[68:71], a[248:251], v[244:247], v[68:71]
    s_waitcnt vmcnt(7) lgkmcnt(5)
    v_and_b32 v20, 31, v3
    v_lshrrev_b32 v21, 5, v3
    v_mfma_f32_16x16x32_bf16 v[32:35], a[252:255], v[248:251], v[32:35]
    s_waitcnt vmcnt(5)
    ds_read_b128 a[244:247], v8 offset:0
    v_mul_u32_u24 v20, 48, v20
    v_mfma_f32_16x16x32_bf16 v[36:39], a[252:255], v[252:255], v[36:39]
    s_waitcnt lgkmcnt(5)
    v_add_u32 v20, s81, v20
    v_lshl_add_u32 v22, v21, 4, v20
    v_mfma_f32_16x16x32_bf16 v[40:43], a[224:227], v[248:251], v[40:43]
    ds_read_b128 a[248:251], v8 offset:1024
    buffer_load_dwordx4 v1, s[4:7], s87 offen offset:3072 sc1 lds
    v_mul_u32_u24 v21, 1536, v21
    v_mfma_f32_16x16x32_bf16 v[44:47], a[224:227], v[252:255], v[44:47]
    s_waitcnt lgkmcnt(5)
    v_add_u32 v21, v20, v21
    v_add_u32 v28, s81, v1
    v_mfma_f32_16x16x32_bf16 v[48:51], a[228:231], v[248:251], v[48:51]
    ds_read_b128 a[252:255], v8 offset:5120
    v_lshlrev_b32 v6, 3, v3
    v_mfma_f32_16x16x32_bf16 v[52:55], a[228:231], v[252:255], v[52:55]
    s_waitcnt lgkmcnt(5)
    v_add_u32 v29, s81, v6
    v_mov_b32 v12, 0x3f80
    v_mfma_f32_16x16x32_bf16 v[56:59], a[232:235], v[248:251], v[56:59]
    s_add_u32 s87, s87, 4096
    s_add_u32 m0, m0, 4096
    ds_read_b128 a[224:227], v8 offset:3072
    buffer_load_dwordx4 v1, s[4:7], s87 offen offset:0 sc1 lds
    v_mov_b32 v13, 0
    v_mfma_f32_16x16x32_bf16 v[60:63], a[232:235], v[252:255], v[60:63]
    s_waitcnt lgkmcnt(5)
    ds_write_b64 v21, v[12:13] offset:47656
    v_mfma_f32_16x16x32_bf16 v[64:67], a[236:239], v[248:251], v[64:67]
    ds_read_b128 a[228:231], v8 offset:4096
    v_mfma_f32_16x16x32_bf16 v[68:71], a[236:239], v[252:255], v[68:71]
    s_waitcnt lgkmcnt(6)
    v_mfma_f32_16x16x32_bf16 v[88:91], a[240:243], v[96:99], 0
    ds_read_b128 a[232:235], v8 offset:8192
    v_mfma_f32_16x16x32_bf16 v[92:95], a[240:243], v[100:103], 0
    s_waitcnt lgkmcnt(6)
    v_mfma_f32_16x16x32_bf16 v[72:75], a[244:247], v[96:99], 0
    ds_read_b128 a[236:239], v8 offset:6144
    v_cvt_pk_bf16_f32 v48, v48, v49
    v_cvt_pk_bf16_f32 v49, v50, v51
    v_cvt_pk_bf16_f32 v50, v52, v53
    v_cvt_pk_bf16_f32 v51, v54, v55
    v_mfma_f32_16x16x32_bf16 v[76:79], a[244:247], v[100:103], 0
    s_waitcnt lgkmcnt(6)
    v_permlane16_swap_b32 v48, v50
    v_permlane16_swap_b32 v49, v51
    v_cvt_pk_bf16_f32 v56, v56, v57
    v_mfma_f32_16x16x32_bf16 v[80:83], a[248:251], v[96:99], 0
    ds_read_b128 a[240:243], v8 offset:7168
    ds_write_b64 v21, v[50:51] offset:47648
    v_cvt_pk_bf16_f32 v57, v58, v59
    v_mfma_f32_16x16x32_bf16 v[84:87], a[248:251], v[100:103], 0
    s_waitcnt lgkmcnt(7)
    v_cvt_pk_bf16_f32 v58, v60, v61
    v_cvt_pk_bf16_f32 v59, v62, v63
    s_nop 0
    v_permlane16_swap_b32 v56, v58
    v_cvt_pk_bf16_f32 v64, v64, v65
    v_mfma_f32_16x16x32_bf16 v[88:91], a[252:255], v[104:107], v[88:91]
    ds_read_b128 a[244:247], v8 offset:11264
    v_permlane16_swap_b32 v57, v59
    v_cvt_pk_bf16_f32 v65, v66, v67
    v_cvt_pk_bf16_f32 v66, v68, v69
    v_mfma_f32_16x16x32_bf16 v[92:95], a[252:255], v[108:111], v[92:95]
    s_waitcnt lgkmcnt(7)
    ds_write_b128 v22, v[56:59] offset:47616
    v_mfma_f32_16x16x32_bf16 v[72:75], a[224:227], v[104:107], v[72:75]
    ds_read_b128 a[248:251], v8 offset:9216
    v_permlane16_swap_b32 v64, v66
    v_cvt_pk_bf16_f32 v67, v70, v71
    v_cvt_pk_bf16_f32 v32, v32, v33
    v_mfma_f32_16x16x32_bf16 v[76:79], a[224:227], v[108:111], v[76:79]
    s_waitcnt lgkmcnt(7)
    v_permlane16_swap_b32 v65, v67
    v_cvt_pk_bf16_f32 v33, v34, v35
    v_cvt_pk_bf16_f32 v34, v36, v37
    v_cvt_pk_bf16_f32 v35, v38, v39
    v_mfma_f32_16x16x32_bf16 v[80:83], a[228:231], v[104:107], v[80:83]
    ds_read_b128 a[252:255], v8 offset:10240
    v_permlane16_swap_b32 v32, v34
    v_permlane16_swap_b32 v33, v35
    v_mfma_f32_16x16x32_bf16 v[84:87], a[228:231], v[108:111], v[84:87]
    s_waitcnt lgkmcnt(7)
    ds_write_b128 v22, v[64:67] offset:49152
    v_mfma_f32_16x16x32_bf16 v[88:91], a[232:235], v[112:115], v[88:91]
    ds_read_b128 a[224:227], v8 offset:14336
    ds_read_b128 v[52:55], v28 offset:47616
    ds_read_b128 v[60:63], v28 offset:48640
    ds_read_b128 v[68:71], v28 offset:49664
    v_cvt_pk_bf16_f32 v40, v40, v41
    v_mfma_f32_16x16x32_bf16 v[92:95], a[232:235], v[116:119], v[92:95]
    s_waitcnt lgkmcnt(11)
    buffer_store_dwordx2 v[48:49], v6, s[4:7], s82 offen offset:2048 sc1
    v_cvt_pk_bf16_f32 v41, v42, v43
    v_cvt_pk_bf16_f32 v42, v44, v45
    v_mfma_f32_16x16x32_bf16 v[72:75], a[236:239], v[112:115], v[72:75]
    ds_read_b128 a[228:231], v8 offset:12288
    buffer_store_dwordx4 v[32:35], v1, s[4:7], s82 offen offset:0 sc1
    v_cvt_pk_bf16_f32 v43, v46, v47
    v_mfma_f32_16x16x32_bf16 v[76:79], a[236:239], v[116:119], v[76:79]
    s_waitcnt lgkmcnt(11)
    v_permlane16_swap_b32 v40, v42
    v_permlane16_swap_b32 v41, v43
    v_mfma_f32_16x16x32_bf16 v[80:83], a[240:243], v[112:115], v[80:83]
    ds_read_b128 a[232:235], v8 offset:13312
    buffer_store_dwordx4 v[40:43], v1, s[4:7], s82 offen offset:1024 sc1
    v_mfma_f32_16x16x32_bf16 v[84:87], a[240:243], v[116:119], v[84:87]
    s_waitcnt lgkmcnt(10)
    s_waitcnt lgkmcnt(4)
    buffer_store_dwordx4 v[52:55], v1, s[4:7], s83 offen offset:0 sc1
    v_mfma_f32_16x16x32_bf16 v[88:91], a[244:247], v[120:123], v[88:91]
    ds_read_b128 a[236:239], v8 offset:17408
    s_waitcnt lgkmcnt(4)
    buffer_store_dwordx4 v[60:63], v1, s[4:7], s83 offen offset:1024 sc1
    v_mfma_f32_16x16x32_bf16 v[92:95], a[244:247], v[124:127], v[92:95]
    s_waitcnt lgkmcnt(3)
    buffer_store_dwordx4 v[68:71], v1, s[4:7], s83 offen offset:2048 sc1
    v_mfma_f32_16x16x32_bf16 v[72:75], a[248:251], v[120:123], v[72:75]
    ds_read_b128 a[240:243], v8 offset:15360
    v_mfma_f32_16x16x32_bf16 v[76:79], a[248:251], v[124:127], v[76:79]
    ds_write_b64 v29, v[48:49] offset:47104
    v_mfma_f32_16x16x32_bf16 v[80:83], a[252:255], v[120:123], v[80:83]
    ds_read_b128 a[244:247], v8 offset:16384
    v_mfma_f32_16x16x32_bf16 v[84:87], a[252:255], v[124:127], v[84:87]
    ds_write_b128 v28, v[32:35] offset:45056
    v_mfma_f32_16x16x32_bf16 v[88:91], a[224:227], v[128:131], v[88:91]
    ds_read_b128 a[248:251], v8 offset:20480
    v_mfma_f32_16x16x32_bf16 v[92:95], a[224:227], v[132:135], v[92:95]
    s_waitcnt lgkmcnt(7)
    ds_write_b128 v28, v[40:43] offset:46080
    v_mfma_f32_16x16x32_bf16 v[72:75], a[228:231], v[128:131], v[72:75]
    ds_read_b128 a[252:255], v8 offset:18432
    v_and_b32 v64, 31, v3
    v_mfma_f32_16x16x32_bf16 v[76:79], a[228:231], v[132:135], v[76:79]
    s_waitcnt lgkmcnt(8)
    v_lshrrev_b32 v65, 5, v3
    v_bfe_u32 v66, v3, 2, 2
    v_mfma_f32_16x16x32_bf16 v[80:83], a[232:235], v[128:131], v[80:83]
    ds_read_b128 a[224:227], v8 offset:19456
    v_lshl_add_u32 v66, v65, 2, v66
    v_mfma_f32_16x16x32_bf16 v[84:87], a[232:235], v[132:135], v[84:87]
    s_waitcnt lgkmcnt(8)
    v_mul_u32_u24 v30, 48, v66
    v_and_b32 v66, 3, v3
    v_mfma_f32_16x16x32_bf16 v[88:91], a[236:239], v[136:139], v[88:91]
    ds_read_b128 a[228:231], v8 offset:23552
    buffer_load_dwordx4 a[0:3], v1, s[4:7], s84 offen offset:0 sc1
    v_mfma_f32_16x16x32_bf16 v[92:95], a[236:239], v[140:143], v[92:95]
    s_waitcnt lgkmcnt(8)
    v_min_u32 v67, 1, v66
    v_add_u32 v67, 4, v67
    v_mfma_f32_16x16x32_bf16 v[72:75], a[240:243], v[136:139], v[72:75]
    ds_read_b128 a[232:235], v8 offset:21504
    v_and_b32 v68, 16, v3
    v_mfma_f32_16x16x32_bf16 v[76:79], a[240:243], v[140:143], v[76:79]
    s_waitcnt lgkmcnt(7)
    v_cmp_eq_u32 vcc, 0, v68
    v_cmp_gt_u32 s[48:49], 32, v3
    v_mfma_f32_16x16x32_bf16 v[80:83], a[244:247], v[136:139], v[80:83]
    ds_read_b128 a[236:239], v8 offset:22528
    buffer_load_dwordx4 a[4:7], v1, s[4:7], s84 offen offset:1024 sc1
    v_mfma_f32_16x16x32_bf16 v[84:87], a[244:247], v[140:143], v[84:87]
    s_waitcnt lgkmcnt(6)
    v_cndmask_b32 v66, v67, v66, vcc
    v_lshl_add_u32 v30, v66, 3, v30
    v_mfma_f32_16x16x32_bf16 v[88:91], a[248:251], v[144:147], v[88:91]
    s_waitcnt vmcnt(8)
    s_barrier
    ds_read_b128 a[240:243], v8 offset:26624
    v_mfma_f32_16x16x32_bf16 v[92:95], a[248:251], v[148:151], v[92:95]
    s_waitcnt lgkmcnt(5)
    v_add_u32 v30, s81, v30
    v_lshlrev_b32 v31, 2, v65
    v_mfma_f32_16x16x32_bf16 v[72:75], a[252:255], v[144:147], v[72:75]
    ds_read_b128 a[244:247], v8 offset:29696
    v_sub_u32 v31, v64, v31
    v_mfma_f32_16x16x32_bf16 v[76:79], a[252:255], v[148:151], v[76:79]
    s_waitcnt lgkmcnt(5)
    v_mov_b32 v69, 0xf149f2ca
    v_cmp_le_i32 s[60:61], 0, v31
    v_mfma_f32_16x16x32_bf16 v[80:83], a[224:227], v[144:147], v[80:83]
    ds_read_b128 a[248:251], v8 offset:32768
    buffer_load_dwordx4 a[8:11], v1, s[4:7], s84 offen offset:2048 sc1
    v_mfma_f32_16x16x32_bf16 v[84:87], a[224:227], v[148:151], v[84:87]
    s_waitcnt lgkmcnt(5)
    v_cmp_le_i32 s[62:63], 1, v31
    v_cmp_le_i32 s[64:65], 2, v31
    v_mfma_f32_16x16x32_bf16 v[88:91], a[228:231], v[152:155], v[88:91]
    ds_read_b128 a[252:255], v8 offset:35840
    v_cmp_le_i32 s[66:67], 3, v31
    v_mfma_f32_16x16x32_bf16 v[92:95], a[228:231], v[156:159], v[92:95]
    s_waitcnt lgkmcnt(5)
    v_cndmask_b32 v32, v69, 0, s[60:61]
    v_cndmask_b32 v48, 0, v69, s[60:61]
    v_mfma_f32_16x16x32_bf16 v[72:75], a[232:235], v[152:155], v[72:75]
    ds_read_b128 a[224:227], v8 offset:38912
    buffer_load_dwordx4 a[12:15], v1, s[4:7], s84 offen offset:3072 sc1
    v_mfma_f32_16x16x32_bf16 v[76:79], a[232:235], v[156:159], v[76:79]
    s_waitcnt lgkmcnt(5)
    v_cndmask_b32 v33, v69, 0, s[62:63]
    v_cndmask_b32 v49, 0, v69, s[62:63]
    v_mfma_f32_16x16x32_bf16 v[80:83], a[236:239], v[152:155], v[80:83]
    ds_read_b128 a[228:231], v8 offset:41984
    v_cndmask_b32 v34, v69, 0, s[64:65]
    v_mfma_f32_16x16x32_bf16 v[84:87], a[236:239], v[156:159], v[84:87]
    s_waitcnt lgkmcnt(5)
    v_cndmask_b32 v50, 0, v69, s[64:65]
    v_cndmask_b32 v35, v69, 0, s[66:67]
    v_mfma_f32_16x16x32_bf16 v[88:91], a[240:243], v[160:163], v[88:91]
    ds_read_b128 a[232:235], v8 offset:45056
    v_cndmask_b32 v51, 0, v69, s[66:67]
    v_mfma_f32_16x16x32_bf16 v[92:95], a[240:243], v[164:167], v[92:95]
    s_waitcnt lgkmcnt(5)
    v_cmp_le_i32 s[60:61], 8, v31
    v_cmp_le_i32 s[62:63], 9, v31
    v_mfma_f32_16x16x32_bf16 v[88:91], a[244:247], v[168:171], v[88:91]
    s_add_u32 s84, s84, 4096
    ds_read_b128 a[236:239], v8 offset:48128
    buffer_load_dwordx4 a[16:19], v1, s[4:7], s84 offen offset:0 sc1
    v_mfma_f32_16x16x32_bf16 v[92:95], a[244:247], v[172:175], v[92:95]
    s_waitcnt lgkmcnt(5)
    v_cmp_le_i32 s[64:65], 10, v31
    v_cmp_le_i32 s[66:67], 11, v31
    v_mfma_f32_16x16x32_bf16 v[88:91], a[248:251], v[176:179], v[88:91]
.Lisl2:
    s_cbranch_execz .Lwarm_ret
    ds_read_b128 a[240:243], v8 offset:51200
    v_cndmask_b32 v36, v69, 0, s[60:61]
    v_mfma_f32_16x16x32_bf16 v[92:95], a[248:251], v[180:183], v[92:95]
    s_waitcnt lgkmcnt(5)
    v_cndmask_b32 v52, 0, v69, s[60:61]
    v_cndmask_b32 v37, v69, 0, s[62:63]
    v_mfma_f32_16x16x32_bf16 v[88:91], a[252:255], v[184:187], v[88:91]
    ds_read_b128 a[244:247], v8 offset:54272
    v_cndmask_b32 v53, 0, v69, s[62:63]
    v_mfma_f32_16x16x32_bf16 v[92:95], a[252:255], v[188:191], v[92:95]
    s_waitcnt lgkmcnt(5)
    v_cndmask_b32 v38, v69, 0, s[64:65]
    v_cndmask_b32 v54, 0, v69, s[64:65]
    v_mfma_f32_16x16x32_bf16 v[88:91], a[224:227], v[192:195], v[88:91]
    ds_read_b128 a[248:251], v8 offset:57344
    buffer_load_dwordx4 a[20:23], v1, s[4:7], s84 offen offset:1024 sc1
    v_mfma_f32_16x16x32_bf16 v[92:95], a[224:227], v[196:199], v[92:95]
    s_waitcnt lgkmcnt(5)
    v_cndmask_b32 v39, v69, 0, s[66:67]
    v_cndmask_b32 v55, 0, v69, s[66:67]
    v_mfma_f32_16x16x32_bf16 v[88:91], a[228:231], v[200:203], v[88:91]
    ds_read_b128 a[252:255], v8 offset:60416
    v_cmp_le_i32 s[60:61], 16, v31
    v_mfma_f32_16x16x32_bf16 v[92:95], a[228:231], v[204:207], v[92:95]
    s_waitcnt lgkmcnt(5)
    v_cmp_le_i32 s[62:63], 17, v31
    v_cmp_le_i32 s[64:65], 18, v31
    v_mfma_f32_16x16x32_bf16 v[88:91], a[232:235], v[208:211], v[88:91]
    ds_read_b128 a[224:227], v8 offset:24576
    buffer_load_dwordx4 a[24:27], v1, s[4:7], s84 offen offset:2048 sc1
    v_mfma_f32_16x16x32_bf16 v[92:95], a[232:235], v[212:215], v[92:95]
    s_waitcnt lgkmcnt(5)
    v_cmp_le_i32 s[66:67], 19, v31
    v_cndmask_b32 v40, v69, 0, s[60:61]
    v_mfma_f32_16x16x32_bf16 v[88:91], a[236:239], v[216:219], v[88:91]
    ds_read_b128 a[228:231], v8 offset:27648
    v_cndmask_b32 v56, 0, v69, s[60:61]
    v_mfma_f32_16x16x32_bf16 v[92:95], a[236:239], v[220:223], v[92:95]
    s_waitcnt lgkmcnt(5)
    v_cndmask_b32 v41, v69, 0, s[62:63]
    v_cndmask_b32 v57, 0, v69, s[62:63]
    v_mfma_f32_16x16x32_bf16 v[88:91], a[240:243], v[224:227], v[88:91]
    ds_read_b128 a[232:235], v8 offset:30720
    v_cndmask_b32 v42, v69, 0, s[64:65]
    v_mfma_f32_16x16x32_bf16 v[92:95], a[240:243], v[228:231], v[92:95]
    s_waitcnt lgkmcnt(5)
    v_cndmask_b32 v58, 0, v69, s[64:65]
    v_cndmask_b32 v43, v69, 0, s[66:67]
    v_mfma_f32_16x16x32_bf16 v[88:91], a[244:247], v[232:235], v[88:91]
    ds_read_b128 a[236:239], v8 offset:33792
    buffer_load_dwordx4 a[28:31], v1, s[4:7], s84 offen offset:3072 sc1
    v_mfma_f32_16x16x32_bf16 v[92:95], a[244:247], v[236:239], v[92:95]
    s_waitcnt lgkmcnt(5)
    v_cndmask_b32 v59, 0, v69, s[66:67]
    v_cmp_le_i32 s[60:61], 24, v31
    v_mfma_f32_16x16x32_bf16 v[88:91], a[248:251], v[240:243], v[88:91]
    ds_read_b128 a[240:243], v8 offset:36864
    v_cmp_le_i32 s[62:63], 25, v31
    v_mfma_f32_16x16x32_bf16 v[92:95], a[248:251], v[244:247], v[92:95]
    s_waitcnt lgkmcnt(5)
    v_cmp_le_i32 s[64:65], 26, v31
    v_cmp_le_i32 s[66:67], 27, v31
    v_mfma_f32_16x16x32_bf16 v[88:91], a[252:255], v[248:251], v[88:91]
    ds_read_b128 a[244:247], v8 offset:39936
    v_cndmask_b32 v44, v69, 0, s[60:61]
    v_mfma_f32_16x16x32_bf16 v[92:95], a[252:255], v[252:255], v[92:95]
    s_waitcnt lgkmcnt(5)
    v_cndmask_b32 v60, 0, v69, s[60:61]
    v_cndmask_b32 v45, v69, 0, s[62:63]
    v_mfma_f32_16x16x32_bf16 v[72:75], a[224:227], v[160:163], v[72:75]
    s_add_u32 s84, s84, 4096
    ds_read_b128 a[248:251], v8 offset:43008
    buffer_load_dwordx4 a[32:35], v1, s[4:7], s84 offen offset:0 sc1
    v_mfma_f32_16x16x32_bf16 v[76:79], a[224:227], v[164:167], v[76:79]
    s_waitcnt lgkmcnt(5)
    v_cndmask_b32 v61, 0, v69, s[62:63]
    v_cndmask_b32 v46, v69, 0, s[64:65]
    v_mfma_f32_16x16x32_bf16 v[72:75], a[228:231], v[168:171], v[72:75]
    ds_read_b128 a[252:255], v8 offset:46080
    v_cndmask_b32 v62, 0, v69, s[64:65]
    v_mfma_f32_16x16x32_bf16 v[76:79], a[228:231], v[172:175], v[76:79]
    s_waitcnt lgkmcnt(5)
    v_cndmask_b32 v47, v69, 0, s[66:67]
    v_cndmask_b32 v63, 0, v69, s[66:67]
    v_mfma_f32_16x16x32_bf16 v[72:75], a[232:235], v[176:179], v[72:75]
    ds_read_b128 a[224:227], v8 offset:49152
    buffer_load_dwordx4 a[36:39], v1, s[4:7], s84 offen offset:1024 sc1
    v_mfma_f32_16x16x32_bf16 v[76:79], a[232:235], v[180:183], v[76:79]
    s_waitcnt lgkmcnt(5)
    v_mul_f32 v88, 0x3ea52b5c, v88
    v_mul_f32 v89, 0x3ea52b5c, v89
    v_mfma_f32_16x16x32_bf16 v[72:75], a[236:239], v[184:187], v[72:75]
    ds_read_b128 a[228:231], v8 offset:52224
    v_mul_f32 v90, 0x3ea52b5c, v90
    v_mfma_f32_16x16x32_bf16 v[76:79], a[236:239], v[188:191], v[76:79]
    s_waitcnt lgkmcnt(5)
    v_mul_f32 v91, 0x3ea52b5c, v91
    v_mul_f32 v92, 0x3ea52b5c, v92
    v_mfma_f32_16x16x32_bf16 v[72:75], a[240:243], v[192:195], v[72:75]
    ds_read_b128 a[232:235], v8 offset:55296
    v_mul_f32 v93, 0x3ea52b5c, v93
    v_mfma_f32_16x16x32_bf16 v[76:79], a[240:243], v[196:199], v[76:79]
    s_waitcnt lgkmcnt(5)
    v_mul_f32 v94, 0x3ea52b5c, v94
    v_mul_f32 v95, 0x3ea52b5c, v95
    v_mfma_f32_16x16x32_bf16 v[72:75], a[244:247], v[200:203], v[72:75]
    ds_read_b128 a[236:239], v8 offset:58368
    buffer_load_dwordx4 a[40:43], v1, s[4:7], s84 offen offset:2048 sc1
    v_mfma_f32_16x16x32_bf16 v[76:79], a[244:247], v[204:207], v[76:79]
    s_waitcnt lgkmcnt(5)
    v_cvt_pk_bf16_f32 v88, v88, v89
    v_cvt_pk_bf16_f32 v89, v90, v91
    v_mfma_f32_16x16x32_bf16 v[72:75], a[248:251], v[208:211], v[72:75]
    ds_read_b128 a[240:243], v8 offset:25600
    v_cvt_pk_bf16_f32 v90, v92, v93
    v_mfma_f32_16x16x32_bf16 v[76:79], a[248:251], v[212:215], v[76:79]
    s_waitcnt lgkmcnt(5)
    v_permlane16_swap_b32 v88, v90
    v_mfma_f32_16x16x32_bf16 v[72:75], a[252:255], v[216:219], v[72:75]
    ds_read_b128 a[244:247], v8 offset:28672
    buffer_load_dwordx4 a[44:47], v1, s[4:7], s84 offen offset:3072 sc1
    v_mfma_f32_16x16x32_bf16 v[76:79], a[252:255], v[220:223], v[76:79]
    s_waitcnt lgkmcnt(5)
    v_cvt_pk_bf16_f32 v91, v94, v95
    v_mfma_f32_16x16x32_bf16 v[72:75], a[224:227], v[224:227], v[72:75]
    ds_read_b128 a[248:251], v8 offset:31744
    v_mfma_f32_16x16x32_bf16 v[76:79], a[224:227], v[228:231], v[76:79]
    s_waitcnt lgkmcnt(5)
    v_permlane16_swap_b32 v89, v91
    v_mfma_f32_16x16x32_bf16 v[72:75], a[228:231], v[232:235], v[72:75]
    ds_read_b128 a[252:255], v8 offset:34816
    v_mfma_f32_16x16x32_bf16 v[76:79], a[228:231], v[236:239], v[76:79]
    s_waitcnt lgkmcnt(5)
    v_mfma_f32_16x16x32_bf16 v[72:75], a[232:235], v[240:243], v[72:75]
    s_add_u32 s84, s84, 4096
    ds_read_b128 a[224:227], v8 offset:37888
    buffer_load_dwordx4 a[48:51], v1, s[4:7], s84 offen offset:0 sc1
    v_mfma_f32_16x16x32_bf16 v[76:79], a[232:235], v[244:247], v[76:79]
    s_waitcnt lgkmcnt(5)
    v_mfma_f32_16x16x32_bf16 v[72:75], a[236:239], v[248:251], v[72:75]
    ds_read_b128 a[228:231], v8 offset:40960
    s_lshl_b32 s72, s96, 7
    s_lshl_b32 s73, s41, 4
    s_sub_u32 s72, s72, s73
    s_add_u32 s72, s72, 32768
    v_and_b32 v7, v4, v0
    s_waitcnt vmcnt(13)
    buffer_store_dword v5, v7, s[4:7], s72 offen sc1
    v_mfma_f32_16x16x32_bf16 v[76:79], a[236:239], v[252:255], v[76:79]
    s_waitcnt lgkmcnt(5)
    v_mfma_f32_16x16x32_bf16 v[80:83], a[240:243], v[160:163], v[80:83]
    ds_read_b128 a[232:235], v8 offset:44032
    v_mfma_f32_16x16x32_bf16 v[84:87], a[240:243], v[164:167], v[84:87]
    s_waitcnt lgkmcnt(5)
    v_mfma_f32_16x16x32_bf16 v[80:83], a[244:247], v[168:171], v[80:83]
    ds_read_b128 a[236:239], v8 offset:47104
    buffer_load_dwordx4 a[52:55], v1, s[4:7], s84 offen offset:1024 sc1
    v_mfma_f32_16x16x32_bf16 v[84:87], a[244:247], v[172:175], v[84:87]
    s_waitcnt lgkmcnt(5)
    v_mfma_f32_16x16x32_bf16 v[80:83], a[248:251], v[176:179], v[80:83]
    ds_read_b128 a[240:243], v8 offset:50176
    v_mfma_f32_16x16x32_bf16 v[84:87], a[248:251], v[180:183], v[84:87]
    s_waitcnt lgkmcnt(5)
    v_mul_f32 v72, 0x3ea52b5c, v72
    v_mul_f32 v73, 0x3ea52b5c, v73
    v_mfma_f32_16x16x32_bf16 v[80:83], a[252:255], v[184:187], v[80:83]
    ds_read_b128 a[244:247], v8 offset:53248
    buffer_load_dwordx4 a[56:59], v1, s[4:7], s84 offen offset:2048 sc1
    v_mfma_f32_16x16x32_bf16 v[84:87], a[252:255], v[188:191], v[84:87]
    s_waitcnt lgkmcnt(5)
    v_mul_f32 v74, 0x3ea52b5c, v74
    v_mul_f32 v75, 0x3ea52b5c, v75
    v_mfma_f32_16x16x32_bf16 v[80:83], a[224:227], v[192:195], v[80:83]
    ds_read_b128 a[248:251], v8 offset:56320
    v_mul_f32 v76, 0x3ea52b5c, v76
    v_mfma_f32_16x16x32_bf16 v[84:87], a[224:227], v[196:199], v[84:87]
    s_waitcnt lgkmcnt(5)
    v_mul_f32 v77, 0x3ea52b5c, v77
    v_mul_f32 v78, 0x3ea52b5c, v78
    v_mfma_f32_16x16x32_bf16 v[80:83], a[228:231], v[200:203], v[80:83]
    ds_read_b128 a[252:255], v8 offset:59392
    v_mul_f32 v79, 0x3ea52b5c, v79
    v_mfma_f32_16x16x32_bf16 v[84:87], a[228:231], v[204:207], v[84:87]
    s_waitcnt lgkmcnt(5)
    v_cvt_pk_bf16_f32 v12, v72, v73
    v_cvt_pk_bf16_f32 v13, v74, v75
    v_mfma_f32_16x16x32_bf16 v[80:83], a[232:235], v[208:211], v[80:83]
    buffer_load_dwordx4 a[60:63], v1, s[4:7], s84 offen offset:3072 sc1
    v_cvt_pk_bf16_f32 v14, v76, v77
    v_mfma_f32_16x16x32_bf16 v[84:87], a[232:235], v[212:215], v[84:87]
    s_waitcnt lgkmcnt(4)
    v_permlane16_swap_b32 v12, v14
    v_mfma_f32_16x16x32_bf16 v[80:83], a[236:239], v[216:219], v[80:83]
    v_cvt_pk_bf16_f32 v15, v78, v79
    v_mfma_f32_16x16x32_bf16 v[84:87], a[236:239], v[220:223], v[84:87]
    s_waitcnt lgkmcnt(3)
    v_permlane16_swap_b32 v13, v15
    v_mfma_f32_16x16x32_bf16 v[80:83], a[240:243], v[224:227], v[80:83]
    v_mfma_f32_16x16x32_bf16 v[84:87], a[240:243], v[228:231], v[84:87]
    s_waitcnt lgkmcnt(2)
    v_mfma_f32_16x16x32_bf16 v[80:83], a[244:247], v[232:235], v[80:83]
    v_mfma_f32_16x16x32_bf16 v[84:87], a[244:247], v[236:239], v[84:87]
    s_waitcnt lgkmcnt(1)
    v_mfma_f32_16x16x32_bf16 v[80:83], a[248:251], v[240:243], v[80:83]
    v_mfma_f32_16x16x32_bf16 v[84:87], a[248:251], v[244:247], v[84:87]
    s_waitcnt lgkmcnt(0)
    v_mfma_f32_16x16x32_bf16 v[80:83], a[252:255], v[248:251], v[80:83]
    v_mfma_f32_16x16x32_bf16 v[84:87], a[252:255], v[252:255], v[84:87]
    v_mov_b32 v253, v17
    v_mov_b32 v254, v18
    v_mov_b32 v255, v19
    ds_read_b128 v[136:139], v28 offset:45056
    ds_read_b64 v[144:145], v29 offset:47104
    ds_read_b128 v[140:143], v28 offset:46080
    v_mov_b32 v146, 0x3f80
    v_mov_b32 v147, 0
    v_mov_b32 v150, 0x3f80
    v_mov_b32 v151, 0
    v_mov_b32 v22, 0
    v_mov_b32 v23, 0
    v_mov_b32 v26, 0
    v_mov_b32 v27, 0
    v_cndmask_b32 v20, 0, v88, s[48:49]
    v_cndmask_b32 v24, v88, 0, s[48:49]
    v_cndmask_b32 v21, 0, v89, s[48:49]
    v_cndmask_b32 v25, v89, 0, s[48:49]
    s_waitcnt lgkmcnt(2)
    v_mfma_f32_32x32x16_bf16 v[64:79], v[136:139], v[12:15], 0
    s_waitcnt lgkmcnt(1)
    v_mfma_f32_32x32x16_bf16 v[64:79], v[144:147], v[20:23], v[64:79]
    v_mul_f32 v80, 0x3ea52b5c, v80
    v_mul_f32 v81, 0x3ea52b5c, v81
    v_mul_f32 v82, 0x3ea52b5c, v82
    v_mul_f32 v83, 0x3ea52b5c, v83
    v_mul_f32 v84, 0x3ea52b5c, v84
    v_mul_f32 v85, 0x3ea52b5c, v85
    v_mul_f32 v86, 0x3ea52b5c, v86
    v_mul_f32 v87, 0x3ea52b5c, v87
    v_cvt_pk_bf16_f32 v16, v80, v81
    v_cvt_pk_bf16_f32 v17, v82, v83
    v_cvt_pk_bf16_f32 v18, v84, v85
    v_cvt_pk_bf16_f32 v19, v86, v87
    s_nop 0
    v_permlane16_swap_b32 v16, v18
    v_permlane16_swap_b32 v17, v19
    s_waitcnt lgkmcnt(0)
    s_nop 0
    v_mfma_f32_32x32x16_bf16 v[80:95], v[140:143], v[16:19], 0
    v_mfma_f32_32x32x16_bf16 v[80:95], v[144:147], v[24:27], v[80:95]
    v_bfe_u32 v6, v3, 4, 1
    v_mul_u32_u24 v6, 20480, v6
    v_and_b32 v7, 15, v3
    v_lshl_add_u32 v6, v7, 4, v6
    v_lshrrev_b32 v7, 5, v3
    v_lshl_add_u32 v8, v7, 8, v6
    v_cndmask_b32 v9, v2, v6, s[48:49]
    v_max3_f32 v64, v64, v65, v66
    v_max3_f32 v64, v64, v67, v68
    v_max3_f32 v64, v64, v69, v70
    v_max3_f32 v64, v64, v71, v72
    v_max3_f32 v64, v64, v73, v74
    v_max3_f32 v64, v64, v75, v76
    v_max3_f32 v64, v64, v77, v78
    v_max_f32 v64, v64, v79
    v_mov_b32 v65, v64
    v_max3_f32 v80, v80, v81, v82
    v_max3_f32 v80, v80, v83, v84
    v_max3_f32 v80, v80, v85, v86
    v_max3_f32 v80, v80, v87, v88
    v_max3_f32 v80, v80, v89, v90
    v_max3_f32 v80, v80, v91, v92
    v_max3_f32 v80, v80, v93, v94
    v_max_f32 v80, v80, v95
    v_mov_b32 v81, v80
    v_permlane32_swap_b32 v64, v65
    s_nop 0
    v_permlane32_swap_b32 v80, v81
    v_max_f32 v64, v64, v65
    v_cvt_pk_bf16_f32 v64, -v64, 0
    v_cndmask_b32 v22, 0, v64, s[48:49]
    v_max_f32 v80, v80, v81
    v_cvt_pk_bf16_f32 v80, -v80, 0
    v_cndmask_b32 v26, 0, v80, s[48:49]
    s_mov_b32 s73, 0
    s_nop 0
.Lpoll_13:
    s_add_u32 s73, s73, 1
    buffer_load_dword v252, v255, s[4:7], s93 offen sc1
    s_waitcnt vmcnt(0)
    v_cmp_ne_u32 vcc, s42, v252
    s_cmp_ge_u32 s73, 20000
    s_cbranch_scc1 .Lpollx_14
    s_cmp_lg_u64 vcc, 0
    s_cbranch_scc1 .Lpoll_13
.Lpollx_14:
    s_mul_i32 s88, s3, 6
    s_min_u32 s88, s88, 16
    s_lshl_b32 s88, s88, 10
    s_add_u32 s87, s94, s88
    s_add_u32 m0, s88, 22528
    s_nop 0
    buffer_load_dwordx4 v253, s[4:7], s87 offen offset:0 sc1 lds
    buffer_load_dwordx4 v253, s[4:7], s87 offen offset:1024 sc1 lds
    buffer_load_dwordx4 v253, s[4:7], s87 offen offset:2048 sc1 lds
    buffer_load_dwordx4 v253, s[4:7], s87 offen offset:3072 sc1 lds
    s_add_u32 s87, s87, 4096
    s_add_u32 m0, m0, 4096
    s_nop 0
    buffer_load_dwordx4 v253, s[4:7], s87 offen offset:0 sc1 lds
    buffer_load_dwordx4 v253, s[4:7], s87 offen offset:1024 sc1 lds
    ds_read_b64_tr_b16 v[152:153], v30 offset:47616
    ds_read_b64_tr_b16 v[154:155], v30 offset:48000
    ds_read_b64_tr_b16 v[156:157], v30 offset:48384
    ds_read_b64_tr_b16 v[158:159], v30 offset:48768
    v_mfma_f32_32x32x16_bf16 v[64:79], v[136:139], v[12:15], v[32:47]
    v_mfma_f32_32x32x16_bf16 v[64:79], v[144:147], v[20:23], v[64:79]
    s_mul_i32 s88, s3, 6
    s_min_u32 s88, s88, 16
    s_lshl_b32 s88, s88, 10
    s_add_u32 s87, s95, s88
    s_add_u32 m0, s88, 0
    s_nop 0
    buffer_load_dwordx4 v254, s[4:7], s87 offen offset:0 sc1 lds
    v_mfma_f32_32x32x16_bf16 v[80:95], v[140:143], v[16:19], v[32:47]
    buffer_load_dwordx4 v254, s[4:7], s87 offen offset:1024 sc1 lds
    s_nop 2
    v_exp_f32 v64, v64
    v_exp_f32 v65, v65
    v_exp_f32 v66, v66
    v_exp_f32 v67, v67
    v_cvt_pk_bf16_f32 v128, v64, v65
    v_exp_f32 v68, v68
    v_exp_f32 v69, v69
    v_cvt_pk_bf16_f32 v129, v66, v67
    v_exp_f32 v70, v70
    v_exp_f32 v71, v71
    v_mfma_f32_32x32x16_bf16 v[80:95], v[144:147], v[24:27], v[80:95]
    s_waitcnt lgkmcnt(2)
    buffer_load_dwordx4 v254, s[4:7], s87 offen offset:2048 sc1 lds
    v_cvt_pk_bf16_f32 v130, v68, v69
    v_cvt_pk_bf16_f32 v131, v70, v71
    v_exp_f32 v72, v72
    v_exp_f32 v73, v73
    v_exp_f32 v74, v74
    v_exp_f32 v75, v75
    v_mfma_f32_32x32x16_bf16 v[96:111], v[152:155], v[128:131], 0
    s_waitcnt lgkmcnt(0)
    ds_read_b64_tr_b16 v[152:153], v30 offset:49152
    ds_read_b64_tr_b16 v[154:155], v30 offset:49536
    buffer_load_dwordx4 v254, s[4:7], s87 offen offset:3072 sc1 lds
    v_cvt_pk_bf16_f32 v132, v72, v73
    v_exp_f32 v76, v76
    v_exp_f32 v77, v77
    v_cvt_pk_bf16_f32 v133, v74, v75
    v_exp_f32 v78, v78
    v_exp_f32 v79, v79
    v_cvt_pk_bf16_f32 v134, v76, v77
    v_cvt_pk_bf16_f32 v135, v78, v79
    v_exp_f32 v80, v80
    v_exp_f32 v81, v81
    v_exp_f32 v82, v82
    v_exp_f32 v83, v83
    v_mfma_f32_32x32x16_bf16 v[96:111], v[156:159], v[132:135], v[96:111]
    s_waitcnt lgkmcnt(0)
    ds_read_b64_tr_b16 v[156:157], v30 offset:49920
    ds_read_b64_tr_b16 v[158:159], v30 offset:50304
    s_add_u32 s87, s87, 4096
    s_add_u32 m0, m0, 4096
    s_nop 0
    buffer_load_dwordx4 v254, s[4:7], s87 offen offset:0 sc1 lds
    v_cvt_pk_bf16_f32 v128, v80, v81
    v_exp_f32 v84, v84
    v_exp_f32 v85, v85
    v_cvt_pk_bf16_f32 v129, v82, v83
    v_exp_f32 v86, v86
    v_exp_f32 v87, v87
    v_cvt_pk_bf16_f32 v130, v84, v85
    v_cvt_pk_bf16_f32 v131, v86, v87
    v_exp_f32 v88, v88
    v_exp_f32 v89, v89
    v_exp_f32 v90, v90
    v_exp_f32 v91, v91
    v_mfma_f32_32x32x16_bf16 v[112:127], v[152:155], v[128:131], 0
    s_waitcnt lgkmcnt(0)
    buffer_load_dwordx4 v254, s[4:7], s87 offen offset:1024 sc1 lds
    v_cvt_pk_bf16_f32 v132, v88, v89
    v_exp_f32 v92, v92
    v_exp_f32 v93, v93
    v_cvt_pk_bf16_f32 v133, v90, v91
    v_exp_f32 v94, v94
    v_exp_f32 v95, v95
    v_cvt_pk_bf16_f32 v134, v92, v93
    v_cvt_pk_bf16_f32 v135, v94, v95
    s_nop 1
    v_mfma_f32_32x32x16_bf16 v[112:127], v[156:159], v[132:135], v[112:127]
    s_lshl2_add_u32 s91, s40, s3
    s_lshl1_add_u32 s91, s91, s47
    s_mul_i32 s92, s91, 20480
    s_mul_i32 s72, s46, 2560
    s_add_u32 s92, s92, s72
    s_add_u32 s92, s92, 11796480
    s_lshl_b32 s93, s91, 10
    s_lshr_b32 s72, s46, 1
    s_lshl_b32 s72, s72, 8
    s_add_u32 s93, s93, s72
    s_and_b32 s72, s46, 1
    s_lshl3_add_u32 s93, s72, s93
    s_add_u32 s93, s93, 131072
    s_mul_i32 s82, s40, 393216
    s_lshl2_add_u32 s72, s41, s3
    s_mul_i32 s72, s72, 768
    s_add_u32 s82, s82, s72
    s_add_u32 s82, s82, 25526272
    s_mul_i32 s94, s40, 393216
    s_mul_i32 s72, s47, 20480
    s_add_u32 s94, s94, s72
    s_mul_i32 s72, s3, 5120
    s_add_u32 s94, s94, s72
    s_add_u32 s94, s94, 25427968
    s_mul_i32 s86, s46, 252160
    s_mul_i32 s72, s3, 62720
    s_add_u32 s86, s86, s72
    s_add_u32 s86, s86, 9437184
    s_lshl_b32 s95, s3, 13
    s_mul_i32 s81, s3, 10240
    buffer_load_dwordx4 v[160:163], v1, s[4:7], s85 offen offset:0 sc1
    buffer_load_dwordx4 v[164:167], v1, s[4:7], s85 offen offset:1024 sc1
    s_waitcnt vmcnt(8)
    s_barrier
    ds_read_b128 v[136:139], v28 offset:39424
    ds_read_b64 v[148:149], v29 offset:41472
    ds_read_b128 v[140:143], v28 offset:40448
    ds_read_b64_tr_b16 v[152:153], v30 offset:41984
    ds_read_b64_tr_b16 v[154:155], v30 offset:42368
    ds_read_b64_tr_b16 v[156:157], v30 offset:42752
    ds_read_b64_tr_b16 v[158:159], v30 offset:43136
    s_waitcnt lgkmcnt(6)
    v_mfma_f32_32x32x16_bf16 v[64:79], v[136:139], v[12:15], 0
    s_waitcnt lgkmcnt(5)
    buffer_load_dwordx4 v[168:171], v1, s[4:7], s85 offen offset:2048 sc1
    v_mfma_f32_32x32x16_bf16 v[64:79], v[148:151], v[20:23], v[64:79]
    s_waitcnt lgkmcnt(4)
    buffer_load_dwordx4 v[172:175], v1, s[4:7], s85 offen offset:3072 sc1
    v_mfma_f32_32x32x16_bf16 v[80:95], v[140:143], v[16:19], 0
    ds_read_b128 v[136:139], v28 offset:33792
    ds_read_b64 v[144:145], v29 offset:35840
    s_nop 6
    v_exp_f32 v64, v64
    v_exp_f32 v65, v65
    v_exp_f32 v66, v66
    v_exp_f32 v67, v67
    v_cvt_pk_bf16_f32 v128, v64, v65
    v_exp_f32 v68, v68
    v_exp_f32 v69, v69
    v_cvt_pk_bf16_f32 v129, v66, v67
    v_exp_f32 v70, v70
    v_exp_f32 v71, v71
    v_mfma_f32_32x32x16_bf16 v[80:95], v[148:151], v[24:27], v[80:95]
    s_waitcnt lgkmcnt(4)
    s_add_u32 s85, s85, 4096
    buffer_load_dwordx4 v[176:179], v1, s[4:7], s85 offen offset:0 sc1
    v_cvt_pk_bf16_f32 v130, v68, v69
    v_cvt_pk_bf16_f32 v131, v70, v71
    v_exp_f32 v72, v72
    v_exp_f32 v73, v73
    v_exp_f32 v74, v74
    v_exp_f32 v75, v75
    v_mfma_f32_32x32x16_bf16 v[96:111], v[152:155], v[128:131], v[96:111]
    s_waitcnt lgkmcnt(1)
    ds_read_b64_tr_b16 v[152:153], v30 offset:43520
    ds_read_b64_tr_b16 v[154:155], v30 offset:43904
    buffer_load_dwordx4 v[180:183], v1, s[4:7], s85 offen offset:1024 sc1
    v_cvt_pk_bf16_f32 v132, v72, v73
    v_exp_f32 v76, v76
    v_exp_f32 v77, v77
    v_cvt_pk_bf16_f32 v133, v74, v75
    v_exp_f32 v78, v78
    v_exp_f32 v79, v79
    v_cvt_pk_bf16_f32 v134, v76, v77
    v_cvt_pk_bf16_f32 v135, v78, v79
    v_mfma_f32_32x32x16_bf16 v[64:79], v[136:139], v[12:15], 0
    ds_read_b128 v[140:143], v28 offset:34816
    v_exp_f32 v80, v80
    v_exp_f32 v81, v81
    v_exp_f32 v82, v82
    v_exp_f32 v83, v83
    v_mfma_f32_32x32x16_bf16 v[96:111], v[156:159], v[132:135], v[96:111]
    s_waitcnt lgkmcnt(3)
    ds_read_b64_tr_b16 v[156:157], v30 offset:44288
    ds_read_b64_tr_b16 v[158:159], v30 offset:44672
    buffer_load_dwordx4 v[184:187], v1, s[4:7], s85 offen offset:2048 sc1
    v_cvt_pk_bf16_f32 v128, v80, v81
    v_exp_f32 v84, v84
    v_exp_f32 v85, v85
    v_cvt_pk_bf16_f32 v129, v82, v83
    v_exp_f32 v86, v86
    v_exp_f32 v87, v87
    v_mfma_f32_32x32x16_bf16 v[64:79], v[144:147], v[20:23], v[64:79]
    s_waitcnt lgkmcnt(3)
    v_cvt_pk_bf16_f32 v130, v84, v85
    v_cvt_pk_bf16_f32 v131, v86, v87
    v_exp_f32 v88, v88
    v_exp_f32 v89, v89
    v_exp_f32 v90, v90
    v_exp_f32 v91, v91
    v_mfma_f32_32x32x16_bf16 v[112:127], v[152:155], v[128:131], v[112:127]
    s_waitcnt lgkmcnt(2)
    ds_read_b64_tr_b16 v[152:153], v30 offset:36352
    ds_read_b64_tr_b16 v[154:155], v30 offset:36736
    buffer_load_dwordx4 v[188:191], v1, s[4:7], s85 offen offset:3072 sc1
    v_cvt_pk_bf16_f32 v132, v88, v89
    v_exp_f32 v92, v92
    v_exp_f32 v93, v93
    v_cvt_pk_bf16_f32 v133, v90, v91
    v_exp_f32 v94, v94
    v_exp_f32 v95, v95
    v_cvt_pk_bf16_f32 v134, v92, v93
    v_cvt_pk_bf16_f32 v135, v94, v95
    v_mfma_f32_32x32x16_bf16 v[80:95], v[140:143], v[16:19], 0
    s_waitcnt lgkmcnt(2)
    ds_read_b128 v[136:139], v28 offset:28160
    ds_read_b64 v[148:149], v29 offset:30208
    s_add_u32 s85, s85, 4096
    buffer_load_dwordx4 v[192:195], v1, s[4:7], s85 offen offset:0 sc1
    v_exp_f32 v64, v64
    v_exp_f32 v65, v65
    v_exp_f32 v66, v66
    v_exp_f32 v67, v67
    v_mfma_f32_32x32x16_bf16 v[112:127], v[156:159], v[132:135], v[112:127]
    ds_read_b64_tr_b16 v[156:157], v30 offset:37120
    ds_read_b64_tr_b16 v[158:159], v30 offset:37504
    v_cvt_pk_bf16_f32 v128, v64, v65
    v_exp_f32 v68, v68
    v_exp_f32 v69, v69
    v_cvt_pk_bf16_f32 v129, v66, v67
    v_exp_f32 v70, v70
    v_exp_f32 v71, v71
    v_mfma_f32_32x32x16_bf16 v[80:95], v[144:147], v[24:27], v[80:95]
    s_waitcnt lgkmcnt(4)
    buffer_load_dwordx4 v[196:199], v1, s[4:7], s85 offen offset:1024 sc1
    v_cvt_pk_bf16_f32 v130, v68, v69
    v_cvt_pk_bf16_f32 v131, v70, v71
    v_exp_f32 v72, v72
    v_exp_f32 v73, v73
    v_exp_f32 v74, v74
    v_exp_f32 v75, v75
    v_mfma_f32_32x32x16_bf16 v[96:111], v[152:155], v[128:131], v[96:111]
    s_waitcnt lgkmcnt(3)
    ds_read_b64_tr_b16 v[152:153], v30 offset:37888
    ds_read_b64_tr_b16 v[154:155], v30 offset:38272
    v_cvt_pk_bf16_f32 v132, v72, v73
    v_exp_f32 v76, v76
    v_exp_f32 v77, v77
    v_cvt_pk_bf16_f32 v133, v74, v75
    v_exp_f32 v78, v78
    v_exp_f32 v79, v79
    v_cvt_pk_bf16_f32 v134, v76, v77
    v_cvt_pk_bf16_f32 v135, v78, v79
    v_mfma_f32_32x32x16_bf16 v[64:79], v[136:139], v[12:15], 0
    s_waitcnt lgkmcnt(2)
    ds_read_b128 v[140:143], v28 offset:29184
    buffer_load_dwordx4 v[200:203], v1, s[4:7], s85 offen offset:2048 sc1
    v_exp_f32 v80, v80
    v_exp_f32 v81, v81
    v_exp_f32 v82, v82
    v_exp_f32 v83, v83
    v_mfma_f32_32x32x16_bf16 v[96:111], v[156:159], v[132:135], v[96:111]
    ds_read_b64_tr_b16 v[156:157], v30 offset:38656
    ds_read_b64_tr_b16 v[158:159], v30 offset:39040
    buffer_load_dwordx4 v[204:207], v1, s[4:7], s85 offen offset:3072 sc1
    v_cvt_pk_bf16_f32 v128, v80, v81
    v_exp_f32 v84, v84
    v_exp_f32 v85, v85
    v_cvt_pk_bf16_f32 v129, v82, v83
    v_exp_f32 v86, v86
    v_exp_f32 v87, v87
    v_mfma_f32_32x32x16_bf16 v[64:79], v[148:151], v[20:23], v[64:79]
    s_waitcnt lgkmcnt(3)
    v_cvt_pk_bf16_f32 v130, v84, v85
    v_cvt_pk_bf16_f32 v131, v86, v87
    v_exp_f32 v88, v88
    v_exp_f32 v89, v89
    v_exp_f32 v90, v90
    v_exp_f32 v91, v91
    v_mfma_f32_32x32x16_bf16 v[112:127], v[152:155], v[128:131], v[112:127]
    s_waitcnt lgkmcnt(2)
    ds_read_b64_tr_b16 v[152:153], v30 offset:30720
    ds_read_b64_tr_b16 v[154:155], v30 offset:31104
    s_add_u32 s85, s85, 4096
    buffer_load_dwordx4 v[208:211], v1, s[4:7], s85 offen offset:0 sc1
    v_cvt_pk_bf16_f32 v132, v88, v89
    v_exp_f32 v92, v92
    v_exp_f32 v93, v93
    v_cvt_pk_bf16_f32 v133, v90, v91
    v_exp_f32 v94, v94
    v_exp_f32 v95, v95
    v_cvt_pk_bf16_f32 v134, v92, v93
    v_cvt_pk_bf16_f32 v135, v94, v95
    v_mfma_f32_32x32x16_bf16 v[80:95], v[140:143], v[16:19], 0
    s_waitcnt lgkmcnt(2)
    ds_read_b128 v[136:139], v28 offset:22528
    ds_read_b64 v[144:145], v29 offset:24576
    v_exp_f32 v64, v64
    v_exp_f32 v65, v65
    v_exp_f32 v66, v66
    v_exp_f32 v67, v67
    v_mfma_f32_32x32x16_bf16 v[112:127], v[156:159], v[132:135], v[112:127]
    ds_read_b64_tr_b16 v[156:157], v30 offset:31488
    ds_read_b64_tr_b16 v[158:159], v30 offset:31872
    buffer_load_dwordx4 v[212:215], v1, s[4:7], s85 offen offset:1024 sc1
    v_cvt_pk_bf16_f32 v128, v64, v65
    v_exp_f32 v68, v68
    v_exp_f32 v69, v69
    v_cvt_pk_bf16_f32 v129, v66, v67
    v_exp_f32 v70, v70
    v_exp_f32 v71, v71
    v_mfma_f32_32x32x16_bf16 v[80:95], v[148:151], v[24:27], v[80:95]
    s_waitcnt lgkmcnt(4)
    buffer_load_dwordx4 v[216:219], v1, s[4:7], s85 offen offset:2048 sc1
    v_cvt_pk_bf16_f32 v130, v68, v69
    v_cvt_pk_bf16_f32 v131, v70, v71
    v_exp_f32 v72, v72
    v_exp_f32 v73, v73
    v_exp_f32 v74, v74
    v_exp_f32 v75, v75
    v_mfma_f32_32x32x16_bf16 v[96:111], v[152:155], v[128:131], v[96:111]
    s_waitcnt lgkmcnt(3)
    ds_read_b64_tr_b16 v[152:153], v30 offset:32256
    ds_read_b64_tr_b16 v[154:155], v30 offset:32640
    v_cvt_pk_bf16_f32 v132, v72, v73
    v_exp_f32 v76, v76
    v_exp_f32 v77, v77
    v_cvt_pk_bf16_f32 v133, v74, v75
    v_exp_f32 v78, v78
    v_exp_f32 v79, v79
    v_cvt_pk_bf16_f32 v134, v76, v77
    v_cvt_pk_bf16_f32 v135, v78, v79
.Lchain1:
.Lisl3:
    s_cbranch_execz .Lisl4
    v_mfma_f32_32x32x16_bf16 v[64:79], v[136:139], v[12:15], 0
    s_waitcnt lgkmcnt(2)
    ds_read_b128 v[140:143], v28 offset:23552
    buffer_load_dwordx4 v[220:223], v1, s[4:7], s85 offen offset:3072 sc1
    v_exp_f32 v80, v80
    v_exp_f32 v81, v81
    v_exp_f32 v82, v82
    v_exp_f32 v83, v83
    v_mfma_f32_32x32x16_bf16 v[96:111], v[156:159], v[132:135], v[96:111]
    ds_read_b64_tr_b16 v[156:157], v30 offset:33024
    ds_read_b64_tr_b16 v[158:159], v30 offset:33408
    s_add_u32 s85, s85, 4096
    buffer_load_dwordx4 v[224:227], v1, s[4:7], s85 offen offset:0 sc1
    v_cvt_pk_bf16_f32 v128, v80, v81
    v_exp_f32 v84, v84
    v_exp_f32 v85, v85
    v_cvt_pk_bf16_f32 v129, v82, v83
    v_exp_f32 v86, v86
    v_exp_f32 v87, v87
    v_mfma_f32_32x32x16_bf16 v[64:79], v[144:147], v[20:23], v[64:79]
    s_waitcnt lgkmcnt(3)
    v_cvt_pk_bf16_f32 v130, v84, v85
    v_cvt_pk_bf16_f32 v131, v86, v87
    v_exp_f32 v88, v88
    v_exp_f32 v89, v89
    v_exp_f32 v90, v90
    v_exp_f32 v91, v91
    v_mfma_f32_32x32x16_bf16 v[112:127], v[152:155], v[128:131], v[112:127]
    s_waitcnt lgkmcnt(2)
    ds_read_b64_tr_b16 v[152:153], v30 offset:25088
    ds_read_b64_tr_b16 v[154:155], v30 offset:25472
    buffer_load_dwordx4 v[228:231], v1, s[4:7], s85 offen offset:1024 sc1
    v_cvt_pk_bf16_f32 v132, v88, v89
    v_exp_f32 v92, v92
    v_exp_f32 v93, v93
    v_cvt_pk_bf16_f32 v133, v90, v91
    v_exp_f32 v94, v94
    v_exp_f32 v95, v95
    v_cvt_pk_bf16_f32 v134, v92, v93
    v_cvt_pk_bf16_f32 v135, v94, v95
    v_mfma_f32_32x32x16_bf16 v[80:95], v[140:143], v[16:19], 0
    s_waitcnt lgkmcnt(2)
    s_waitcnt vmcnt(18)
    s_barrier
    ds_read_b128 v[136:139], v28 offset:16896
    ds_read_b64 v[148:149], v29 offset:18944
    v_exp_f32 v64, v64
    v_exp_f32 v65, v65
    v_exp_f32 v66, v66
    v_exp_f32 v67, v67
    v_mfma_f32_32x32x16_bf16 v[112:127], v[156:159], v[132:135], v[112:127]
    ds_read_b64_tr_b16 v[156:157], v30 offset:25856
    ds_read_b64_tr_b16 v[158:159], v30 offset:26240
    buffer_load_dwordx4 v[232:235], v1, s[4:7], s85 offen offset:2048 sc1
    v_cvt_pk_bf16_f32 v128, v64, v65
    v_exp_f32 v68, v68
    v_exp_f32 v69, v69
    v_cvt_pk_bf16_f32 v129, v66, v67
    v_exp_f32 v70, v70
    v_exp_f32 v71, v71
    v_mfma_f32_32x32x16_bf16 v[80:95], v[144:147], v[24:27], v[80:95]
    s_waitcnt lgkmcnt(4)
    buffer_load_dwordx4 v[236:239], v1, s[4:7], s85 offen offset:3072 sc1
    v_cvt_pk_bf16_f32 v130, v68, v69
    v_cvt_pk_bf16_f32 v131, v70, v71
    v_exp_f32 v72, v72
    v_exp_f32 v73, v73
    v_exp_f32 v74, v74
    v_exp_f32 v75, v75
    v_mfma_f32_32x32x16_bf16 v[96:111], v[152:155], v[128:131], v[96:111]
    s_waitcnt lgkmcnt(3)
    ds_read_b64_tr_b16 v[152:153], v30 offset:26624
    ds_read_b64_tr_b16 v[154:155], v30 offset:27008
    v_cvt_pk_bf16_f32 v132, v72, v73
    v_exp_f32 v76, v76
    v_exp_f32 v77, v77
    v_cvt_pk_bf16_f32 v133, v74, v75
    v_exp_f32 v78, v78
    v_exp_f32 v79, v79
    v_cvt_pk_bf16_f32 v134, v76, v77
    v_cvt_pk_bf16_f32 v135, v78, v79
    v_mfma_f32_32x32x16_bf16 v[64:79], v[136:139], v[12:15], 0
    s_waitcnt lgkmcnt(2)
    s_add_u32 s85, s85, 4096
    ds_read_b128 v[140:143], v28 offset:17920
    buffer_load_dwordx4 v[240:243], v1, s[4:7], s85 offen offset:0 sc1
    v_exp_f32 v80, v80
    v_exp_f32 v81, v81
    v_exp_f32 v82, v82
    v_exp_f32 v83, v83
    v_mfma_f32_32x32x16_bf16 v[96:111], v[156:159], v[132:135], v[96:111]
    ds_read_b64_tr_b16 v[156:157], v30 offset:27392
    ds_read_b64_tr_b16 v[158:159], v30 offset:27776
    v_cvt_pk_bf16_f32 v128, v80, v81
    v_exp_f32 v84, v84
    v_exp_f32 v85, v85
    v_cvt_pk_bf16_f32 v129, v82, v83
    v_exp_f32 v86, v86
    v_exp_f32 v87, v87
    v_mfma_f32_32x32x16_bf16 v[64:79], v[148:151], v[20:23], v[64:79]
    s_waitcnt lgkmcnt(3)
    buffer_load_dwordx4 v[244:247], v1, s[4:7], s85 offen offset:1024 sc1
    v_cvt_pk_bf16_f32 v130, v84, v85
    v_cvt_pk_bf16_f32 v131, v86, v87
    v_exp_f32 v88, v88
    v_exp_f32 v89, v89
    v_exp_f32 v90, v90
    v_exp_f32 v91, v91
    v_mfma_f32_32x32x16_bf16 v[112:127], v[152:155], v[128:131], v[112:127]
    s_waitcnt lgkmcnt(2)
    ds_read_b64_tr_b16 v[152:153], v30 offset:19456
    ds_read_b64_tr_b16 v[154:155], v30 offset:19840
    buffer_load_dwordx4 v[248:251], v1, s[4:7], s85 offen offset:2048 sc1
    v_cvt_pk_bf16_f32 v132, v88, v89
    v_exp_f32 v92, v92
    v_exp_f32 v93, v93
    v_cvt_pk_bf16_f32 v133, v90, v91
    v_exp_f32 v94, v94
    v_exp_f32 v95, v95
    v_cvt_pk_bf16_f32 v134, v92, v93
    v_cvt_pk_bf16_f32 v135, v94, v95
    v_mfma_f32_32x32x16_bf16 v[80:95], v[140:143], v[16:19], 0
    s_waitcnt lgkmcnt(2)
    ds_read_b128 v[136:139], v28 offset:11264
    ds_read_b64 v[144:145], v29 offset:13312
    v_exp_f32 v64, v64
    v_exp_f32 v65, v65
    v_exp_f32 v66, v66
    v_exp_f32 v67, v67
    v_mfma_f32_32x32x16_bf16 v[112:127], v[156:159], v[132:135], v[112:127]
    ds_read_b64_tr_b16 v[156:157], v30 offset:20224
    ds_read_b64_tr_b16 v[158:159], v30 offset:20608
    buffer_load_dwordx4 v[252:255], v1, s[4:7], s85 offen offset:3072 sc1
    v_cvt_pk_bf16_f32 v128, v64, v65
    v_exp_f32 v68, v68
    v_exp_f32 v69, v69
    v_cvt_pk_bf16_f32 v129, v66, v67
    v_exp_f32 v70, v70
    v_exp_f32 v71, v71
    v_mfma_f32_32x32x16_bf16 v[80:95], v[148:151], v[24:27], v[80:95]
    s_waitcnt lgkmcnt(4)
    v_cvt_pk_bf16_f32 v130, v68, v69
    v_cvt_pk_bf16_f32 v131, v70, v71
    v_exp_f32 v72, v72
    v_exp_f32 v73, v73
    v_exp_f32 v74, v74
    v_exp_f32 v75, v75
    v_mfma_f32_32x32x16_bf16 v[96:111], v[152:155], v[128:131], v[96:111]
    s_waitcnt lgkmcnt(3)
    ds_read_b64_tr_b16 v[152:153], v30 offset:20992
    ds_read_b64_tr_b16 v[154:155], v30 offset:21376
    s_add_u32 s85, s85, 4096
    buffer_load_dwordx4 a[252:255], v1, s[4:7], s85 offen offset:0 sc1
    v_cvt_pk_bf16_f32 v132, v72, v73
    v_exp_f32 v76, v76
    v_exp_f32 v77, v77
    v_cvt_pk_bf16_f32 v133, v74, v75
    v_exp_f32 v78, v78
    v_exp_f32 v79, v79
    v_cvt_pk_bf16_f32 v134, v76, v77
    v_cvt_pk_bf16_f32 v135, v78, v79
    v_mfma_f32_32x32x16_bf16 v[64:79], v[136:139], v[12:15], 0
    s_waitcnt lgkmcnt(2)
    s_add_u32 s84, s84, 4096
    ds_read_b128 v[140:143], v28 offset:12288
    buffer_load_dwordx4 a[64:67], v1, s[4:7], s84 offen offset:0 sc1
    v_exp_f32 v80, v80
    v_exp_f32 v81, v81
    v_exp_f32 v82, v82
    v_exp_f32 v83, v83
    v_mfma_f32_32x32x16_bf16 v[96:111], v[156:159], v[132:135], v[96:111]
    ds_read_b64_tr_b16 v[156:157], v30 offset:21760
    ds_read_b64_tr_b16 v[158:159], v30 offset:22144
    v_cvt_pk_bf16_f32 v128, v80, v81
    v_exp_f32 v84, v84
    v_exp_f32 v85, v85
    v_cvt_pk_bf16_f32 v129, v82, v83
    v_exp_f32 v86, v86
    v_exp_f32 v87, v87
    v_mfma_f32_32x32x16_bf16 v[64:79], v[144:147], v[20:23], v[64:79]
    s_waitcnt lgkmcnt(3)
    buffer_load_dwordx4 a[68:71], v1, s[4:7], s84 offen offset:1024 sc1
    v_cvt_pk_bf16_f32 v130, v84, v85
    v_cvt_pk_bf16_f32 v131, v86, v87
    v_exp_f32 v88, v88
    v_exp_f32 v89, v89
    v_exp_f32 v90, v90
    v_exp_f32 v91, v91
    v_mfma_f32_32x32x16_bf16 v[112:127], v[152:155], v[128:131], v[112:127]
    s_waitcnt lgkmcnt(2)
    ds_read_b64_tr_b16 v[152:153], v30 offset:13824
    ds_read_b64_tr_b16 v[154:155], v30 offset:14208
    buffer_load_dwordx4 a[72:75], v1, s[4:7], s84 offen offset:2048 sc1
    v_cvt_pk_bf16_f32 v132, v88, v89
    v_exp_f32 v92, v92
    v_exp_f32 v93, v93
    v_cvt_pk_bf16_f32 v133, v90, v91
    v_exp_f32 v94, v94
    v_exp_f32 v95, v95
    v_cvt_pk_bf16_f32 v134, v92, v93
    v_cvt_pk_bf16_f32 v135, v94, v95
    v_mfma_f32_32x32x16_bf16 v[80:95], v[140:143], v[16:19], 0
    s_waitcnt lgkmcnt(2)
    ds_read_b128 v[136:139], v28 offset:5632
    ds_read_b64 v[148:149], v29 offset:7680
    v_exp_f32 v64, v64
    v_exp_f32 v65, v65
    v_exp_f32 v66, v66
    v_exp_f32 v67, v67
    v_mfma_f32_32x32x16_bf16 v[112:127], v[156:159], v[132:135], v[112:127]
    ds_read_b64_tr_b16 v[156:157], v30 offset:14592
    ds_read_b64_tr_b16 v[158:159], v30 offset:14976
    buffer_load_dwordx4 a[76:79], v1, s[4:7], s84 offen offset:3072 sc1
    v_cvt_pk_bf16_f32 v128, v64, v65
    v_exp_f32 v68, v68
    v_exp_f32 v69, v69
    v_cvt_pk_bf16_f32 v129, v66, v67
    v_exp_f32 v70, v70
    v_exp_f32 v71, v71
    v_mfma_f32_32x32x16_bf16 v[80:95], v[144:147], v[24:27], v[80:95]
    s_waitcnt lgkmcnt(4)
    v_cvt_pk_bf16_f32 v130, v68, v69
    v_cvt_pk_bf16_f32 v131, v70, v71
    v_exp_f32 v72, v72
    v_exp_f32 v73, v73
    v_exp_f32 v74, v74
    v_exp_f32 v75, v75
    v_mfma_f32_32x32x16_bf16 v[96:111], v[152:155], v[128:131], v[96:111]
    s_waitcnt lgkmcnt(3)
    ds_read_b64_tr_b16 v[152:153], v30 offset:15360
    ds_read_b64_tr_b16 v[154:155], v30 offset:15744
    s_add_u32 s84, s84, 4096
    buffer_load_dwordx4 a[80:83], v1, s[4:7], s84 offen offset:0 sc1
    v_cvt_pk_bf16_f32 v132, v72, v73
    v_exp_f32 v76, v76
    v_exp_f32 v77, v77
    v_cvt_pk_bf16_f32 v133, v74, v75
    v_exp_f32 v78, v78
    v_exp_f32 v79, v79
    v_cvt_pk_bf16_f32 v134, v76, v77
    v_cvt_pk_bf16_f32 v135, v78, v79
    v_mfma_f32_32x32x16_bf16 v[64:79], v[136:139], v[12:15], 0
    s_waitcnt lgkmcnt(2)
    ds_read_b128 v[140:143], v28 offset:6656
    buffer_load_dwordx4 a[84:87], v1, s[4:7], s84 offen offset:1024 sc1
    v_exp_f32 v80, v80
    v_exp_f32 v81, v81
    v_exp_f32 v82, v82
    v_exp_f32 v83, v83
    v_mfma_f32_32x32x16_bf16 v[96:111], v[156:159], v[132:135], v[96:111]
    ds_read_b64_tr_b16 v[156:157], v30 offset:16128
    ds_read_b64_tr_b16 v[158:159], v30 offset:16512
    v_cvt_pk_bf16_f32 v128, v80, v81
    v_exp_f32 v84, v84
    v_exp_f32 v85, v85
    v_cvt_pk_bf16_f32 v129, v82, v83
    v_exp_f32 v86, v86
    v_exp_f32 v87, v87
    v_mfma_f32_32x32x16_bf16 v[64:79], v[148:151], v[20:23], v[64:79]
    s_waitcnt lgkmcnt(3)
    buffer_load_dwordx4 a[88:91], v1, s[4:7], s84 offen offset:2048 sc1
    v_cvt_pk_bf16_f32 v130, v84, v85
    v_cvt_pk_bf16_f32 v131, v86, v87
    v_exp_f32 v88, v88
    v_exp_f32 v89, v89
    v_exp_f32 v90, v90
    v_exp_f32 v91, v91
    v_mfma_f32_32x32x16_bf16 v[112:127], v[152:155], v[128:131], v[112:127]
    s_waitcnt lgkmcnt(2)
    ds_read_b64_tr_b16 v[152:153], v30 offset:8192
    ds_read_b64_tr_b16 v[154:155], v30 offset:8576
    v_cvt_pk_bf16_f32 v132, v88, v89
    v_exp_f32 v92, v92
    v_exp_f32 v93, v93
    v_cvt_pk_bf16_f32 v133, v90, v91
    v_exp_f32 v94, v94
    v_exp_f32 v95, v95
    v_cvt_pk_bf16_f32 v134, v92, v93
    v_cvt_pk_bf16_f32 v135, v94, v95
    v_mfma_f32_32x32x16_bf16 v[80:95], v[140:143], v[16:19], 0
    s_waitcnt lgkmcnt(2)
    ds_read_b128 v[136:139], v28 offset:0
    ds_read_b64 v[144:145], v29 offset:2048
    buffer_load_dwordx4 a[92:95], v1, s[4:7], s84 offen offset:3072 sc1
    v_exp_f32 v64, v64
    v_exp_f32 v65, v65
    v_exp_f32 v66, v66
    v_exp_f32 v67, v67
    v_mfma_f32_32x32x16_bf16 v[112:127], v[156:159], v[132:135], v[112:127]
    ds_read_b64_tr_b16 v[156:157], v30 offset:8960
    ds_read_b64_tr_b16 v[158:159], v30 offset:9344
    s_add_u32 s84, s84, 4096
    buffer_load_dwordx4 a[96:99], v1, s[4:7], s84 offen offset:0 sc1
    v_cvt_pk_bf16_f32 v128, v64, v65
    v_exp_f32 v68, v68
    v_exp_f32 v69, v69
    v_cvt_pk_bf16_f32 v129, v66, v67
    v_exp_f32 v70, v70
    v_exp_f32 v71, v71
    v_mfma_f32_32x32x16_bf16 v[80:95], v[148:151], v[24:27], v[80:95]
    s_waitcnt lgkmcnt(4)
    v_cvt_pk_bf16_f32 v130, v68, v69
    v_cvt_pk_bf16_f32 v131, v70, v71
    v_exp_f32 v72, v72
    v_exp_f32 v73, v73
    v_exp_f32 v74, v74
    v_exp_f32 v75, v75
    v_mfma_f32_32x32x16_bf16 v[96:111], v[152:155], v[128:131], v[96:111]
    s_waitcnt lgkmcnt(3)
    ds_read_b64_tr_b16 v[152:153], v30 offset:9728
    ds_read_b64_tr_b16 v[154:155], v30 offset:10112
    buffer_load_dwordx4 a[100:103], v1, s[4:7], s84 offen offset:1024 sc1
    v_cvt_pk_bf16_f32 v132, v72, v73
    v_exp_f32 v76, v76
    v_exp_f32 v77, v77
    v_cvt_pk_bf16_f32 v133, v74, v75
    v_exp_f32 v78, v78
    v_exp_f32 v79, v79
    v_cvt_pk_bf16_f32 v134, v76, v77
    v_cvt_pk_bf16_f32 v135, v78, v79
    v_mfma_f32_32x32x16_bf16 v[64:79], v[136:139], v[12:15], v[48:63]
    s_waitcnt lgkmcnt(2)
    ds_read_b128 v[140:143], v28 offset:1024
    v_exp_f32 v80, v80
    v_exp_f32 v81, v81
    v_exp_f32 v82, v82
    v_exp_f32 v83, v83
    v_mfma_f32_32x32x16_bf16 v[96:111], v[156:159], v[132:135], v[96:111]
    ds_read_b64_tr_b16 v[156:157], v30 offset:10496
    ds_read_b64_tr_b16 v[158:159], v30 offset:10880
    buffer_load_dwordx4 a[104:107], v1, s[4:7], s84 offen offset:2048 sc1
    v_cvt_pk_bf16_f32 v128, v80, v81
    v_exp_f32 v84, v84
    v_exp_f32 v85, v85
    v_cvt_pk_bf16_f32 v129, v82, v83
    v_exp_f32 v86, v86
    v_exp_f32 v87, v87
    v_mfma_f32_32x32x16_bf16 v[64:79], v[144:147], v[20:23], v[64:79]
    s_waitcnt lgkmcnt(3)
    buffer_load_dwordx4 a[108:111], v1, s[4:7], s84 offen offset:3072 sc1
    v_cvt_pk_bf16_f32 v130, v84, v85
    v_cvt_pk_bf16_f32 v131, v86, v87
    v_exp_f32 v88, v88
    v_exp_f32 v89, v89
    v_exp_f32 v90, v90
    v_exp_f32 v91, v91
    v_mfma_f32_32x32x16_bf16 v[112:127], v[152:155], v[128:131], v[112:127]
    s_waitcnt lgkmcnt(2)
    ds_read_b64_tr_b16 v[152:153], v30 offset:2560
    ds_read_b64_tr_b16 v[154:155], v30 offset:2944
    v_cvt_pk_bf16_f32 v132, v88, v89
    v_exp_f32 v92, v92
    v_exp_f32 v93, v93
    v_cvt_pk_bf16_f32 v133, v90, v91
    v_exp_f32 v94, v94
    v_exp_f32 v95, v95
    v_cvt_pk_bf16_f32 v134, v92, v93
    v_cvt_pk_bf16_f32 v135, v94, v95
    v_mfma_f32_32x32x16_bf16 v[80:95], v[140:143], v[16:19], v[48:63]
    s_waitcnt lgkmcnt(2)
    s_add_u32 s84, s84, 4096
    buffer_load_dwordx4 a[112:115], v1, s[4:7], s84 offen offset:0 sc1
    v_exp_f32 v64, v64
    v_exp_f32 v65, v65
    v_exp_f32 v66, v66
    v_exp_f32 v67, v67
    v_mfma_f32_32x32x16_bf16 v[112:127], v[156:159], v[132:135], v[112:127]
    ds_read_b64_tr_b16 v[156:157], v30 offset:3328
    ds_read_b64_tr_b16 v[158:159], v30 offset:3712
    v_cvt_pk_bf16_f32 v128, v64, v65
    v_exp_f32 v68, v68
    v_exp_f32 v69, v69
    v_cvt_pk_bf16_f32 v129, v66, v67
    v_exp_f32 v70, v70
    v_exp_f32 v71, v71
    v_mfma_f32_32x32x16_bf16 v[80:95], v[144:147], v[24:27], v[80:95]
    s_waitcnt lgkmcnt(2)
    v_cvt_pk_bf16_f32 v130, v68, v69
    v_cvt_pk_bf16_f32 v131, v70, v71
    v_exp_f32 v72, v72
    v_exp_f32 v73, v73
    v_exp_f32 v74, v74
    v_exp_f32 v75, v75
    v_mfma_f32_32x32x16_bf16 v[96:111], v[152:155], v[128:131], v[96:111]
    s_waitcnt lgkmcnt(0)
    ds_read_b64_tr_b16 v[152:153], v30 offset:4096
    ds_read_b64_tr_b16 v[154:155], v30 offset:4480
    v_cvt_pk_bf16_f32 v132, v72, v73
    v_exp_f32 v76, v76
    v_exp_f32 v77, v77
    v_cvt_pk_bf16_f32 v133, v74, v75
    v_exp_f32 v78, v78
    v_exp_f32 v79, v79
    v_cvt_pk_bf16_f32 v134, v76, v77
    v_cvt_pk_bf16_f32 v135, v78, v79
    v_exp_f32 v80, v80
    v_exp_f32 v81, v81
    v_exp_f32 v82, v82
    v_exp_f32 v83, v83
    v_mfma_f32_32x32x16_bf16 v[96:111], v[156:159], v[132:135], v[96:111]
    s_waitcnt lgkmcnt(0)
    ds_read_b64_tr_b16 v[156:157], v30 offset:4864
    ds_read_b64_tr_b16 v[158:159], v30 offset:5248
    v_cvt_pk_bf16_f32 v128, v80, v81
    v_exp_f32 v84, v84
    v_exp_f32 v85, v85
    v_cvt_pk_bf16_f32 v129, v82, v83
    v_exp_f32 v86, v86
    v_exp_f32 v87, v87
    v_cvt_pk_bf16_f32 v130, v84, v85
    v_cvt_pk_bf16_f32 v131, v86, v87
    v_exp_f32 v88, v88
    v_exp_f32 v89, v89
    v_exp_f32 v90, v90
    v_exp_f32 v91, v91
    v_mfma_f32_32x32x16_bf16 v[112:127], v[152:155], v[128:131], v[112:127]
    s_waitcnt lgkmcnt(0)
    v_cvt_pk_bf16_f32 v132, v88, v89
    v_exp_f32 v92, v92
    v_exp_f32 v93, v93
    v_cvt_pk_bf16_f32 v133, v90, v91
    v_exp_f32 v94, v94
    v_exp_f32 v95, v95
    v_cvt_pk_bf16_f32 v134, v92, v93
    v_cvt_pk_bf16_f32 v135, v94, v95
    s_nop 1
    v_mfma_f32_32x32x16_bf16 v[112:127], v[156:159], v[132:135], v[112:127]
    s_mov_b32 s72, 0x12800000
    s_mov_b32 s73, 0x5f800000
    v_cmp_nlt_f32 vcc, s72, v108
    v_cmp_ngt_f32 s[76:77], s73, v108
    s_nop 7
    v_cmp_nlt_f32 s[74:75], s72, v124
    v_cmp_ngt_f32 s[78:79], s73, v124
    s_or_b64 vcc, vcc, s[74:75]
    s_or_b64 s[76:77], s[76:77], s[78:79]
    s_or_b64 vcc, vcc, s[76:77]
    s_cbranch_scc1 .Lfallback
.Lfb_ret:
    v_rcp_f32 v64, v108
    v_rcp_f32 v65, v124
    s_nop 0
    v_pk_mul_f32 v[96:97], v[96:97], v[64:65] op_sel_hi:[1,0]
    v_pk_mul_f32 v[98:99], v[98:99], v[64:65] op_sel_hi:[1,0]
    v_pk_mul_f32 v[100:101], v[100:101], v[64:65] op_sel_hi:[1,0]
    v_pk_mul_f32 v[102:103], v[102:103], v[64:65] op_sel_hi:[1,0]
    v_pk_mul_f32 v[104:105], v[104:105], v[64:65] op_sel_hi:[1,0]
    v_pk_mul_f32 v[106:107], v[106:107], v[64:65] op_sel_hi:[1,0]
    v_cvt_pk_bf16_f32 v68, v96, v97
    v_cvt_pk_bf16_f32 v69, v98, v99
    v_cvt_pk_bf16_f32 v70, v100, v101
    v_cvt_pk_bf16_f32 v71, v102, v103
    v_cvt_pk_bf16_f32 v76, v104, v105
    v_cvt_pk_bf16_f32 v77, v106, v107
    buffer_store_dwordx4 v[68:71], v8, s[4:7], s80 offen offset:0 sc1
    v_pk_mul_f32 v[112:113], v[112:113], v[64:65] op_sel:[0,1]
    v_pk_mul_f32 v[114:115], v[114:115], v[64:65] op_sel:[0,1]
    v_pk_mul_f32 v[116:117], v[116:117], v[64:65] op_sel:[0,1]
    v_pk_mul_f32 v[118:119], v[118:119], v[64:65] op_sel:[0,1]
    v_pk_mul_f32 v[120:121], v[120:121], v[64:65] op_sel:[0,1]
    v_pk_mul_f32 v[122:123], v[122:123], v[64:65] op_sel:[0,1]
    v_cvt_pk_bf16_f32 v72, v112, v113
    v_cvt_pk_bf16_f32 v73, v114, v115
    v_cvt_pk_bf16_f32 v74, v116, v117
    v_cvt_pk_bf16_f32 v75, v118, v119
    v_cvt_pk_bf16_f32 v78, v120, v121
    v_cvt_pk_bf16_f32 v79, v122, v123
    buffer_store_dwordx4 v[72:75], v8, s[4:7], s80 offen offset:512 sc1
    buffer_store_dwordx4 v[76:79], v9, s[4:7], s80 offen offset:1024 sc1
    buffer_load_dwordx4 a[116:119], v1, s[4:7], s84 offen offset:1024 sc1
    buffer_load_dwordx4 a[120:123], v1, s[4:7], s84 offen offset:2048 sc1
    buffer_load_dwordx4 a[124:127], v1, s[4:7], s84 offen offset:3072 sc1
    s_add_u32 s84, s84, 4096
    buffer_load_dwordx4 a[128:131], v1, s[4:7], s84 offen offset:0 sc1
    buffer_load_dwordx4 a[132:135], v1, s[4:7], s84 offen offset:1024 sc1
    buffer_load_dwordx4 a[136:139], v1, s[4:7], s84 offen offset:2048 sc1
    buffer_load_dwordx4 a[140:143], v1, s[4:7], s84 offen offset:3072 sc1
    s_add_u32 s84, s84, 4096
    buffer_load_dwordx4 a[144:147], v1, s[4:7], s84 offen offset:0 sc1
    v_lshrrev_b32 v19, 4, v3
    v_lshlrev_b32 v18, 4, v19
    v_lshlrev_b32 v19, 3, v19
    v_add_u32 v18, 77824, v18
    v_add_u32 v19, 77824, v19
    s_mul_i32 s72, s46, 160
    v_add_u32 v20, s72, v18
    v_add_u32 v21, s72, v19
    ds_read_b128 v[84:87], v18 offset:2560
    ds_read_b128 v[88:91], v18 offset:2624
    ds_read_b64 v[92:93], v19 offset:2688
    ds_read_b128 v[22:25], v20 offset:1280
    ds_read_b128 v[26:29], v20 offset:1344
    ds_read_b64 v[30:31], v21 offset:1408
    v_and_b32 v20, 15, v3
    v_mul_u32_u24 v20, 160, v20
    s_mul_i32 s72, s3, 2560
    s_sub_u32 s72, s72, 10240
    v_add3_u32 v21, v20, s72, v19
    v_add3_u32 v20, v20, s72, v18
    ds_read_b128 v[32:35], v20 offset:0
    ds_read_b128 v[36:39], v20 offset:64
    ds_read_b64 v[40:41], v21 offset:128
    s_waitcnt lgkmcnt(2)
    v_lshlrev_b32 v120, 16, v32
    v_and_b32 v121, 0xffff0000, v32
    v_lshlrev_b32 v122, 16, v33
    v_and_b32 v123, 0xffff0000, v33
    v_lshlrev_b32 v124, 16, v34
    v_and_b32 v125, 0xffff0000, v34
    v_lshlrev_b32 v126, 16, v35
    v_and_b32 v127, 0xffff0000, v35
    s_waitcnt lgkmcnt(1)
    v_lshlrev_b32 v128, 16, v36
    v_and_b32 v129, 0xffff0000, v36
    v_lshlrev_b32 v130, 16, v37
    v_and_b32 v131, 0xffff0000, v37
    v_lshlrev_b32 v132, 16, v38
    v_and_b32 v133, 0xffff0000, v38
    v_lshlrev_b32 v134, 16, v39
    v_and_b32 v135, 0xffff0000, v39
    s_waitcnt lgkmcnt(0)
    v_lshlrev_b32 v136, 16, v40
    v_and_b32 v137, 0xffff0000, v40
    v_lshlrev_b32 v138, 16, v41
    v_and_b32 v139, 0xffff0000, v41
    s_waitcnt vmcnt(8)
    buffer_store_dword v5, v4, s[4:7], s52 offen offset:2048
    buffer_store_dword v5, v0, s[4:7], s52 offen offset:2048 sc1
    v_lshlrev_b32 v140, 16, v84
    v_and_b32 v141, 0xffff0000, v84
    v_lshlrev_b32 v142, 16, v85
    v_and_b32 v143, 0xffff0000, v85
    v_lshlrev_b32 v144, 16, v86
    v_and_b32 v145, 0xffff0000, v86
    v_lshlrev_b32 v146, 16, v87
    v_and_b32 v147, 0xffff0000, v87
    v_lshlrev_b32 v148, 16, v88
    v_and_b32 v149, 0xffff0000, v88
    v_lshlrev_b32 v150, 16, v89
    v_and_b32 v151, 0xffff0000, v89
    v_lshlrev_b32 v152, 16, v90
    v_and_b32 v153, 0xffff0000, v90
    v_lshlrev_b32 v154, 16, v91
    v_and_b32 v155, 0xffff0000, v91
    v_lshlrev_b32 v156, 16, v92
    v_and_b32 v157, 0xffff0000, v92
    v_lshlrev_b32 v158, 16, v93
    v_and_b32 v159, 0xffff0000, v93
    v_lshlrev_b32 v72, 16, v22
    v_and_b32 v73, 0xffff0000, v22
    v_lshlrev_b32 v74, 16, v23
    v_and_b32 v75, 0xffff0000, v23
    v_lshlrev_b32 v76, 16, v24
    v_and_b32 v77, 0xffff0000, v24
    v_lshlrev_b32 v78, 16, v25
    v_and_b32 v79, 0xffff0000, v25
    v_lshlrev_b32 v112, 16, v26
    v_and_b32 v113, 0xffff0000, v26
    v_lshlrev_b32 v114, 16, v27
    v_and_b32 v115, 0xffff0000, v27
    v_lshlrev_b32 v116, 16, v28
    v_and_b32 v117, 0xffff0000, v28
    v_lshlrev_b32 v118, 16, v29
    v_and_b32 v119, 0xffff0000, v29
    v_lshlrev_b32 v12, 16, v30
    v_and_b32 v13, 0xffff0000, v30
    v_lshlrev_b32 v14, 16, v31
    v_and_b32 v15, 0xffff0000, v31
    v_and_b32 v20, 15, v3
    v_lshlrev_b32 v20, 4, v20
    v_bfe_u32 v21, v3, 4, 1
    v_lshl_add_u32 v21, v21, 3, v20
    v_lshrrev_b32 v64, 5, v3
    v_lshl_add_u32 v21, v64, 8, v21
    v_bfe_u32 v64, v3, 4, 1
    v_lshl_add_u32 v20, v64, 2, v20
    v_cndmask_b32 v20, v2, v20, s[48:49]
    s_mul_i32 s76, s3, 15360
    v_add_u32 v9, s76, v1
    s_add_u32 s72, s3, 1
    s_and_b32 s72, s72, 3
    s_mul_i32 s60, s72, 40960
    s_add_u32 s60, s60, s94
    s_mul_i32 s72, s72, 15360
    v_add_u32 v16, s72, v1
    s_add_u32 s72, s3, 2
    s_and_b32 s72, s72, 3
    s_mul_i32 s61, s72, 40960
    s_add_u32 s61, s61, s94
    s_mul_i32 s72, s72, 15360
    v_add_u32 v17, s72, v1
    s_add_u32 s72, s3, 3
    s_and_b32 s72, s72, 3
    s_mul_i32 s62, s72, 40960
    s_add_u32 s62, s62, s94
    s_mul_i32 s72, s72, 15360
    v_add_u32 v18, s72, v1
    s_add_u32 s72, s3, 4
    s_and_b32 s72, s72, 3
    s_mul_i32 s63, s72, 40960
    s_add_u32 s63, s63, s94
    s_add_u32 s74, s52, 2048
    s_lshl_b32 s72, s3, 6
    s_add_u32 s74, s74, s72
    v_and_b32 v65, 60, v10
    s_barrier
    s_mov_b32 s73, 0
.Lpoll_15:
    s_add_u32 s73, s73, 1
    buffer_load_dword v64, v65, s[4:7], s74 offen sc1
    s_waitcnt vmcnt(0)
    v_cmp_ne_u32 vcc, s42, v64
    s_cmp_ge_u32 s73, 20000
    s_cbranch_scc1 .Lpollx_16
    s_cmp_lg_u64 vcc, 0
    s_cbranch_scc1 .Lpoll_15
.Lpollx_16:
    buffer_load_dwordx4 a[224:227], v1, s[4:7], s60 offen offset:0 sc1
    buffer_load_dwordx4 a[228:231], v1, s[4:7], s60 offen offset:1024 sc1
    buffer_load_dwordx4 a[232:235], v1, s[4:7], s60 offen offset:2048 sc1
    buffer_load_dwordx4 a[236:239], v1, s[4:7], s60 offen offset:3072 sc1
    s_add_u32 s60, s60, 4096
    buffer_load_dwordx4 a[240:243], v1, s[4:7], s60 offen offset:0 sc1
    buffer_load_dwordx4 v[80:83], v1, s[4:7], s61 offen offset:0 sc1
    buffer_load_dwordx4 v[84:87], v1, s[4:7], s61 offen offset:1024 sc1
    buffer_load_dwordx4 v[88:91], v1, s[4:7], s61 offen offset:2048 sc1
    buffer_load_dwordx4 v[92:95], v1, s[4:7], s61 offen offset:3072 sc1
    s_add_u32 s61, s61, 4096
    buffer_load_dwordx4 v[96:99], v1, s[4:7], s61 offen offset:0 sc1
    buffer_load_dwordx4 a[244:247], v1, s[4:7], s62 offen offset:0 sc1
    s_waitcnt vmcnt(10)
    v_mfma_f32_16x16x32_bf16 v[32:35], v[160:163], a[224:227], 0
    buffer_load_dwordx4 a[248:251], v1, s[4:7], s62 offen offset:1024 sc1
    v_mfma_f32_16x16x32_bf16 v[36:39], v[164:167], a[224:227], 0
    v_mfma_f32_16x16x32_bf16 v[40:43], v[168:171], a[224:227], 0
    v_mfma_f32_16x16x32_bf16 v[44:47], v[172:175], a[224:227], 0
    buffer_load_dwordx4 v[100:103], v1, s[4:7], s62 offen offset:2048 sc1
    v_mfma_f32_16x16x32_bf16 v[48:51], v[176:179], a[224:227], 0
    s_waitcnt vmcnt(11)
    v_mfma_f32_16x16x32_bf16 v[32:35], v[180:183], a[228:231], v[32:35]
    v_mfma_f32_16x16x32_bf16 v[36:39], v[184:187], a[228:231], v[36:39]
    v_mfma_f32_16x16x32_bf16 v[40:43], v[188:191], a[228:231], v[40:43]
    buffer_load_dwordx4 v[104:107], v1, s[4:7], s62 offen offset:3072 sc1
    v_mfma_f32_16x16x32_bf16 v[44:47], v[192:195], a[228:231], v[44:47]
    v_mfma_f32_16x16x32_bf16 v[48:51], v[196:199], a[228:231], v[48:51]
    s_waitcnt vmcnt(11)
    v_mfma_f32_16x16x32_bf16 v[32:35], v[200:203], a[232:235], v[32:35]
    v_mfma_f32_16x16x32_bf16 v[36:39], v[204:207], a[232:235], v[36:39]
    s_add_u32 s62, s62, 4096
    buffer_load_dwordx4 v[108:111], v1, s[4:7], s62 offen offset:0 sc1
    v_mfma_f32_16x16x32_bf16 v[40:43], v[208:211], a[232:235], v[40:43]
    v_mfma_f32_16x16x32_bf16 v[44:47], v[212:215], a[232:235], v[44:47]
    v_mfma_f32_16x16x32_bf16 v[48:51], v[216:219], a[232:235], v[48:51]
    s_waitcnt vmcnt(11)
    v_mfma_f32_16x16x32_bf16 v[32:35], v[220:223], a[236:239], v[32:35]
    v_mfma_f32_16x16x32_bf16 v[36:39], v[224:227], a[236:239], v[36:39]
    v_mfma_f32_16x16x32_bf16 v[40:43], v[228:231], a[236:239], v[40:43]
.Lisl4:
    s_cbranch_execz .Lisl5
    v_mfma_f32_16x16x32_bf16 v[44:47], v[232:235], a[236:239], v[44:47]
    v_mfma_f32_16x16x32_bf16 v[48:51], v[236:239], a[236:239], v[48:51]
    s_waitcnt vmcnt(10)
    v_mfma_f32_16x16x32_bf16 v[32:35], v[240:243], a[240:243], v[32:35]
    v_mfma_f32_16x16x32_bf16 v[36:39], v[244:247], a[240:243], v[36:39]
    v_mfma_f32_16x16x32_bf16 v[40:43], v[248:251], a[240:243], v[40:43]
    v_mfma_f32_16x16x32_bf16 v[44:47], v[252:255], a[240:243], v[44:47]
    v_mfma_f32_16x16x32_bf16 v[48:51], a[252:255], a[240:243], v[48:51]
    s_waitcnt vmcnt(9)
    v_mfma_f32_16x16x32_bf16 v[52:55], v[160:163], v[80:83], 0
    s_waitcnt vmcnt(8)
    buffer_load_dwordx4 a[224:227], v1, s[4:7], s63 offen offset:0 sc1
    v_mfma_f32_16x16x32_bf16 v[52:55], v[180:183], v[84:87], v[52:55]
    s_waitcnt vmcnt(8)
    v_mfma_f32_16x16x32_bf16 v[52:55], v[200:203], v[88:91], v[52:55]
    s_waitcnt vmcnt(7)
    ds_write_b128 v16, v[32:35] offset:0
    v_mfma_f32_16x16x32_bf16 v[52:55], v[220:223], v[92:95], v[52:55]
    s_waitcnt vmcnt(6)
    buffer_load_dwordx4 a[228:231], v1, s[4:7], s63 offen offset:1024 sc1
    v_mfma_f32_16x16x32_bf16 v[52:55], v[240:243], v[96:99], v[52:55]
    v_mfma_f32_16x16x32_bf16 v[56:59], v[164:167], v[80:83], 0
    ds_write_b128 v16, v[36:39] offset:1024
    buffer_load_dwordx4 a[148:151], v1, s[4:7], s84 offen offset:1024 sc1
    v_mfma_f32_16x16x32_bf16 v[56:59], v[184:187], v[84:87], v[56:59]
    buffer_load_dwordx4 a[232:235], v1, s[4:7], s63 offen offset:2048 sc1
    v_mfma_f32_16x16x32_bf16 v[56:59], v[204:207], v[88:91], v[56:59]
    v_mfma_f32_16x16x32_bf16 v[56:59], v[224:227], v[92:95], v[56:59]
    ds_write_b128 v16, v[40:43] offset:2048
    v_mfma_f32_16x16x32_bf16 v[56:59], v[244:247], v[96:99], v[56:59]
    buffer_load_dwordx4 a[152:155], v1, s[4:7], s84 offen offset:2048 sc1
    v_mfma_f32_16x16x32_bf16 v[60:63], v[168:171], v[80:83], 0
    v_mfma_f32_16x16x32_bf16 v[60:63], v[188:191], v[84:87], v[60:63]
    ds_write_b128 v16, v[44:47] offset:3072
    v_mfma_f32_16x16x32_bf16 v[60:63], v[208:211], v[88:91], v[60:63]
    buffer_load_dwordx4 a[236:239], v1, s[4:7], s63 offen offset:3072 sc1
    v_mfma_f32_16x16x32_bf16 v[60:63], v[228:231], v[92:95], v[60:63]
    buffer_load_dwordx4 a[156:159], v1, s[4:7], s84 offen offset:3072 sc1
    v_mfma_f32_16x16x32_bf16 v[60:63], v[248:251], v[96:99], v[60:63]
    ds_write_b128 v16, v[48:51] offset:4096
    v_mfma_f32_16x16x32_bf16 v[64:67], v[172:175], v[80:83], 0
    s_add_u32 s63, s63, 4096
    buffer_load_dwordx4 a[240:243], v1, s[4:7], s63 offen offset:0 sc1
    v_mfma_f32_16x16x32_bf16 v[64:67], v[192:195], v[84:87], v[64:67]
    v_mfma_f32_16x16x32_bf16 v[64:67], v[212:215], v[88:91], v[64:67]
    s_add_u32 s84, s84, 4096
    ds_write_b128 v17, v[52:55] offset:5120
    buffer_load_dwordx4 a[160:163], v1, s[4:7], s84 offen offset:0 sc1
    v_mfma_f32_16x16x32_bf16 v[64:67], v[232:235], v[92:95], v[64:67]
    v_mfma_f32_16x16x32_bf16 v[64:67], v[252:255], v[96:99], v[64:67]
    v_mfma_f32_16x16x32_bf16 v[68:71], v[176:179], v[80:83], 0
    v_mfma_f32_16x16x32_bf16 v[68:71], v[196:199], v[84:87], v[68:71]
    ds_write_b128 v17, v[56:59] offset:6144
    buffer_load_dwordx4 a[164:167], v1, s[4:7], s84 offen offset:1024 sc1
    v_mfma_f32_16x16x32_bf16 v[68:71], v[216:219], v[88:91], v[68:71]
    v_mfma_f32_16x16x32_bf16 v[68:71], v[236:239], v[92:95], v[68:71]
    v_mfma_f32_16x16x32_bf16 v[68:71], a[252:255], v[96:99], v[68:71]
    s_waitcnt vmcnt(14)
    v_mfma_f32_16x16x32_bf16 v[32:35], v[160:163], a[244:247], 0
    s_waitcnt vmcnt(13)
    ds_write_b128 v17, v[60:63] offset:7168
    buffer_load_dwordx4 a[168:171], v1, s[4:7], s84 offen offset:2048 sc1
    v_mfma_f32_16x16x32_bf16 v[32:35], v[180:183], a[248:251], v[32:35]
    s_waitcnt vmcnt(13)
    v_mfma_f32_16x16x32_bf16 v[32:35], v[200:203], v[100:103], v[32:35]
    s_waitcnt vmcnt(12)
    v_mfma_f32_16x16x32_bf16 v[32:35], v[220:223], v[104:107], v[32:35]
    s_waitcnt vmcnt(11)
    v_mfma_f32_16x16x32_bf16 v[32:35], v[240:243], v[108:111], v[32:35]
    ds_write_b128 v17, v[64:67] offset:8192
    buffer_load_dwordx4 a[172:175], v1, s[4:7], s84 offen offset:3072 sc1
    v_mfma_f32_16x16x32_bf16 v[36:39], v[164:167], a[244:247], 0
    v_mfma_f32_16x16x32_bf16 v[36:39], v[184:187], a[248:251], v[36:39]
    v_mfma_f32_16x16x32_bf16 v[36:39], v[204:207], v[100:103], v[36:39]
    v_mfma_f32_16x16x32_bf16 v[36:39], v[224:227], v[104:107], v[36:39]
    s_add_u32 s84, s84, 4096
    ds_write_b128 v17, v[68:71] offset:9216
    buffer_load_dwordx4 a[176:179], v1, s[4:7], s84 offen offset:0 sc1
    v_mfma_f32_16x16x32_bf16 v[36:39], v[244:247], v[108:111], v[36:39]
    v_mfma_f32_16x16x32_bf16 v[40:43], v[168:171], a[244:247], 0
    v_mfma_f32_16x16x32_bf16 v[40:43], v[188:191], a[248:251], v[40:43]
    v_mfma_f32_16x16x32_bf16 v[40:43], v[208:211], v[100:103], v[40:43]
    ds_write_b128 v18, v[32:35] offset:10240
    buffer_load_dwordx4 a[180:183], v1, s[4:7], s84 offen offset:1024 sc1
    v_mfma_f32_16x16x32_bf16 v[40:43], v[228:231], v[104:107], v[40:43]
    s_waitcnt lgkmcnt(1)
    s_barrier
    ds_read_b128 v[80:83], v9 offset:0
    v_mfma_f32_16x16x32_bf16 v[40:43], v[248:251], v[108:111], v[40:43]
    ds_read_b128 v[84:87], v9 offset:1024
    ds_read_b128 v[88:91], v9 offset:2048
    v_mfma_f32_16x16x32_bf16 v[44:47], v[172:175], a[244:247], 0
    ds_read_b128 v[92:95], v9 offset:3072
    ds_read_b128 v[96:99], v9 offset:4096
    v_mfma_f32_16x16x32_bf16 v[44:47], v[192:195], a[248:251], v[44:47]
    ds_write_b128 v18, v[36:39] offset:11264
    buffer_load_dwordx4 a[184:187], v1, s[4:7], s84 offen offset:2048 sc1
    v_mfma_f32_16x16x32_bf16 v[44:47], v[212:215], v[100:103], v[44:47]
    v_mfma_f32_16x16x32_bf16 v[44:47], v[232:235], v[104:107], v[44:47]
    v_mfma_f32_16x16x32_bf16 v[44:47], v[252:255], v[108:111], v[44:47]
    v_mfma_f32_16x16x32_bf16 v[48:51], v[176:179], a[244:247], 0
    buffer_load_dwordx4 a[188:191], v1, s[4:7], s84 offen offset:3072 sc1
    v_mfma_f32_16x16x32_bf16 v[48:51], v[196:199], a[248:251], v[48:51]
    ds_write_b128 v18, v[40:43] offset:12288
    v_mfma_f32_16x16x32_bf16 v[48:51], v[216:219], v[100:103], v[48:51]
    s_waitcnt lgkmcnt(6)
    v_fmac_f32 v120, v140, v80
    v_fmac_f32 v121, v141, v81
    v_mfma_f32_16x16x32_bf16 v[48:51], v[236:239], v[104:107], v[48:51]
    v_fmac_f32 v122, v142, v82
    v_fmac_f32 v123, v143, v83
    v_mfma_f32_16x16x32_bf16 v[48:51], a[252:255], v[108:111], v[48:51]
    s_waitcnt vmcnt(15)
    s_add_u32 s84, s84, 4096
    buffer_load_dwordx4 a[192:195], v1, s[4:7], s84 offen offset:0 sc1
    ds_read_b128 v[80:83], v9 offset:5120
    v_mfma_f32_16x16x32_bf16 v[52:55], v[160:163], a[224:227], 0
    s_waitcnt vmcnt(15)
    s_waitcnt lgkmcnt(6)
    v_fmac_f32 v124, v144, v84
    v_fmac_f32 v125, v145, v85
    v_mfma_f32_16x16x32_bf16 v[52:55], v[180:183], a[228:231], v[52:55]
    s_waitcnt vmcnt(13)
    ds_write_b128 v18, v[44:47] offset:13312
    v_mfma_f32_16x16x32_bf16 v[52:55], v[200:203], a[232:235], v[52:55]
    s_waitcnt vmcnt(11)
    v_fmac_f32 v126, v146, v86
    v_fmac_f32 v127, v147, v87
    v_mfma_f32_16x16x32_bf16 v[52:55], v[220:223], a[236:239], v[52:55]
    s_waitcnt vmcnt(9)
    buffer_load_dwordx4 a[196:199], v1, s[4:7], s84 offen offset:1024 sc1
    ds_read_b128 v[84:87], v9 offset:6144
    v_mfma_f32_16x16x32_bf16 v[52:55], v[240:243], a[240:243], v[52:55]
    s_waitcnt lgkmcnt(7)
    v_fmac_f32 v128, v148, v88
    v_fmac_f32 v129, v149, v89
    v_mfma_f32_16x16x32_bf16 v[56:59], v[164:167], a[224:227], 0
    v_fmac_f32 v130, v150, v90
    v_fmac_f32 v131, v151, v91
    v_mfma_f32_16x16x32_bf16 v[56:59], v[184:187], a[228:231], v[56:59]
    ds_write_b128 v18, v[48:51] offset:14336
    v_mfma_f32_16x16x32_bf16 v[56:59], v[204:207], a[232:235], v[56:59]
    buffer_load_dwordx4 a[200:203], v1, s[4:7], s84 offen offset:2048 sc1
    ds_read_b128 v[88:91], v9 offset:7168
    v_mfma_f32_16x16x32_bf16 v[56:59], v[224:227], a[236:239], v[56:59]
    s_waitcnt lgkmcnt(8)
    v_fmac_f32 v132, v152, v92
    v_fmac_f32 v133, v153, v93
    v_mfma_f32_16x16x32_bf16 v[56:59], v[244:247], a[240:243], v[56:59]
    v_fmac_f32 v134, v154, v94
    v_fmac_f32 v135, v155, v95
    v_mfma_f32_16x16x32_bf16 v[60:63], v[168:171], a[224:227], 0
    ds_read_b128 v[92:95], v9 offset:8192
    s_waitcnt lgkmcnt(8)
    v_fmac_f32 v136, v156, v96
    v_mfma_f32_16x16x32_bf16 v[60:63], v[188:191], a[228:231], v[60:63]
    s_waitcnt lgkmcnt(2)
    s_barrier
    buffer_load_dwordx4 a[204:207], v1, s[4:7], s84 offen offset:3072 sc1
    v_mfma_f32_16x16x32_bf16 v[60:63], v[208:211], a[232:235], v[60:63]
    v_fmac_f32 v137, v157, v97
    v_fmac_f32 v138, v158, v98
    v_mfma_f32_16x16x32_bf16 v[60:63], v[228:231], a[236:239], v[60:63]
    ds_read_b128 v[32:35], v9 offset:10240
    v_fmac_f32 v139, v159, v99
    v_mfma_f32_16x16x32_bf16 v[60:63], v[248:251], a[240:243], v[60:63]
    ds_read_b128 v[96:99], v9 offset:9216
    ds_read_b128 v[36:39], v9 offset:11264
    v_mfma_f32_16x16x32_bf16 v[64:67], v[172:175], a[224:227], 0
    s_add_u32 s84, s84, 4096
    buffer_load_dwordx4 a[208:211], v1, s[4:7], s84 offen offset:0 sc1
    ds_read_b128 v[40:43], v9 offset:12288
    v_mfma_f32_16x16x32_bf16 v[64:67], v[192:195], a[228:231], v[64:67]
    ds_read_b128 v[44:47], v9 offset:13312
    ds_read_b128 v[48:51], v9 offset:14336
    v_mfma_f32_16x16x32_bf16 v[64:67], v[212:215], a[232:235], v[64:67]
    v_mfma_f32_16x16x32_bf16 v[64:67], v[232:235], a[236:239], v[64:67]
    v_mfma_f32_16x16x32_bf16 v[64:67], v[252:255], a[240:243], v[64:67]
    buffer_load_dwordx4 a[212:215], v1, s[4:7], s84 offen offset:1024 sc1
    v_mfma_f32_16x16x32_bf16 v[68:71], v[176:179], a[224:227], 0
    v_mfma_f32_16x16x32_bf16 v[68:71], v[196:199], a[228:231], v[68:71]
    v_mfma_f32_16x16x32_bf16 v[68:71], v[216:219], a[232:235], v[68:71]
    v_mfma_f32_16x16x32_bf16 v[68:71], v[236:239], a[236:239], v[68:71]
    v_mfma_f32_16x16x32_bf16 v[68:71], a[252:255], a[240:243], v[68:71]
    s_waitcnt lgkmcnt(5)
    v_pk_add_f32 v[80:81], v[80:81], v[32:33]
    v_pk_add_f32 v[82:83], v[82:83], v[34:35]
    s_waitcnt lgkmcnt(3)
    v_pk_add_f32 v[84:85], v[84:85], v[36:37]
    v_pk_add_f32 v[86:87], v[86:87], v[38:39]
    s_waitcnt lgkmcnt(2)
    v_pk_add_f32 v[88:89], v[88:89], v[40:41]
    v_pk_add_f32 v[90:91], v[90:91], v[42:43]
    s_waitcnt lgkmcnt(1)
    v_pk_add_f32 v[92:93], v[92:93], v[44:45]
    v_pk_add_f32 v[94:95], v[94:95], v[46:47]
    s_waitcnt lgkmcnt(0)
    v_pk_add_f32 v[96:97], v[96:97], v[48:49]
    v_pk_add_f32 v[98:99], v[98:99], v[50:51]
    v_pk_add_f32 v[52:53], v[52:53], v[80:81]
    v_pk_fma_f32 v[52:53], v[52:53], v[140:141], v[120:121]
    v_pk_mul_f32 v[72:73], v[72:73], v[52:53]
    v_cvt_pk_bf16_f32 v100, v72, v73
    v_pk_add_f32 v[54:55], v[54:55], v[82:83]
    v_pk_fma_f32 v[54:55], v[54:55], v[142:143], v[122:123]
    v_pk_mul_f32 v[74:75], v[74:75], v[54:55]
    v_cvt_pk_bf16_f32 v101, v74, v75
    v_pk_add_f32 v[56:57], v[56:57], v[84:85]
    v_pk_fma_f32 v[56:57], v[56:57], v[144:145], v[124:125]
    v_pk_mul_f32 v[76:77], v[76:77], v[56:57]
    v_cvt_pk_bf16_f32 v102, v76, v77
    v_pk_add_f32 v[58:59], v[58:59], v[86:87]
    v_pk_fma_f32 v[58:59], v[58:59], v[146:147], v[126:127]
    v_pk_mul_f32 v[78:79], v[78:79], v[58:59]
    v_cvt_pk_bf16_f32 v103, v78, v79
    buffer_store_dwordx4 v[100:103], v1, s[4:7], s92 offen
    v_pk_add_f32 v[60:61], v[60:61], v[88:89]
    v_pk_fma_f32 v[60:61], v[60:61], v[148:149], v[128:129]
    v_pk_mul_f32 v[112:113], v[112:113], v[60:61]
    v_cvt_pk_bf16_f32 v104, v112, v113
    v_pk_add_f32 v[62:63], v[62:63], v[90:91]
    v_pk_fma_f32 v[62:63], v[62:63], v[150:151], v[130:131]
    v_pk_mul_f32 v[114:115], v[114:115], v[62:63]
    v_cvt_pk_bf16_f32 v105, v114, v115
    v_pk_add_f32 v[64:65], v[64:65], v[92:93]
    v_pk_fma_f32 v[64:65], v[64:65], v[152:153], v[132:133]
    v_pk_mul_f32 v[116:117], v[116:117], v[64:65]
    v_cvt_pk_bf16_f32 v106, v116, v117
    v_pk_add_f32 v[66:67], v[66:67], v[94:95]
    v_pk_fma_f32 v[66:67], v[66:67], v[154:155], v[134:135]
    v_pk_mul_f32 v[118:119], v[118:119], v[66:67]
    v_cvt_pk_bf16_f32 v107, v118, v119
    buffer_store_dwordx4 v[104:107], v1, s[4:7], s92 offen offset:1024
    v_pk_add_f32 v[68:69], v[68:69], v[96:97]
    v_pk_fma_f32 v[68:69], v[68:69], v[156:157], v[136:137]
    v_pk_mul_f32 v[12:13], v[12:13], v[68:69]
    v_cvt_pk_bf16_f32 v108, v12, v13
    v_pk_add_f32 v[70:71], v[70:71], v[98:99]
    v_pk_fma_f32 v[70:71], v[70:71], v[158:159], v[138:139]
    v_pk_mul_f32 v[14:15], v[14:15], v[70:71]
    v_cvt_pk_bf16_f32 v109, v14, v15
    buffer_store_dwordx2 v[108:109], v21, s[4:7], s92 offen offset:2048
    v_pk_add_f32 v[84:85], v[52:53], v[54:55]
    v_pk_mul_f32 v[86:87], v[52:53], v[52:53]
    v_pk_fma_f32 v[86:87], v[54:55], v[54:55], v[86:87]
    v_pk_add_f32 v[84:85], v[84:85], v[56:57]
    v_pk_fma_f32 v[86:87], v[56:57], v[56:57], v[86:87]
    v_pk_add_f32 v[84:85], v[84:85], v[58:59]
    v_pk_fma_f32 v[86:87], v[58:59], v[58:59], v[86:87]
    v_pk_add_f32 v[84:85], v[84:85], v[60:61]
    v_pk_fma_f32 v[86:87], v[60:61], v[60:61], v[86:87]
    v_pk_add_f32 v[84:85], v[84:85], v[62:63]
    v_pk_fma_f32 v[86:87], v[62:63], v[62:63], v[86:87]
    v_pk_add_f32 v[84:85], v[84:85], v[64:65]
    v_pk_fma_f32 v[86:87], v[64:65], v[64:65], v[86:87]
    v_pk_add_f32 v[84:85], v[84:85], v[66:67]
    v_pk_fma_f32 v[86:87], v[66:67], v[66:67], v[86:87]
    v_pk_add_f32 v[84:85], v[84:85], v[68:69]
    v_pk_fma_f32 v[86:87], v[68:69], v[68:69], v[86:87]
    v_pk_add_f32 v[84:85], v[84:85], v[70:71]
    v_pk_fma_f32 v[86:87], v[70:71], v[70:71], v[86:87]
    v_add_f32 v84, v84, v85
    v_add_f32 v85, v86, v87
    s_nop 1
    v_permlane16_swap_b32 v84, v85
    v_add_f32 v84, v84, v85
    v_mov_b32 v85, v84
    s_nop 1
    v_permlane32_swap_b32 v84, v85
    v_add_f32 v84, v84, v85
    buffer_store_dword v84, v20, s[4:7], s93 offen
    buffer_load_dwordx4 a[216:219], v1, s[4:7], s84 offen offset:2048 sc1
    buffer_load_dwordx4 a[220:223], v1, s[4:7], s84 offen offset:3072 sc1
    s_add_u32 s84, s84, 4096
    buffer_load_dwordx4 a[224:227], v1, s[4:7], s84 offen offset:0 sc1
    buffer_load_dwordx4 a[228:231], v1, s[4:7], s84 offen offset:1024 sc1
    buffer_load_dwordx4 a[232:235], v1, s[4:7], s84 offen offset:2048 sc1
    buffer_load_dwordx4 a[236:239], v1, s[4:7], s84 offen offset:3072 sc1
    s_add_u32 m0, s81, 122880
    s_nop 0
    buffer_load_dwordx4 v1, s[4:7], s86 offen offset:0 sc1 lds
    s_add_u32 m0, s81, 122880
    s_nop 0
    buffer_load_dwordx4 v1, s[4:7], s86 offen offset:1024 sc1 lds
    s_add_u32 m0, s81, 122880
    s_nop 0
    buffer_load_dwordx4 v1, s[4:7], s86 offen offset:2048 sc1 lds
    s_add_u32 m0, s81, 122880
    s_nop 0
    buffer_load_dwordx4 v1, s[4:7], s86 offen offset:3072 sc1 lds
    v_cvt_pk_bf16_f32 v22, v52, v53
    v_cvt_pk_bf16_f32 v23, v54, v55
    v_cvt_pk_bf16_f32 v24, v56, v57
    v_cvt_pk_bf16_f32 v25, v58, v59
    v_cvt_pk_bf16_f32 v26, v60, v61
    v_cvt_pk_bf16_f32 v27, v62, v63
    v_cvt_pk_bf16_f32 v28, v64, v65
    v_cvt_pk_bf16_f32 v29, v66, v67
    v_cvt_pk_bf16_f32 v30, v68, v69
    v_cvt_pk_bf16_f32 v31, v70, v71
    v_and_b32 v32, 1, v3
    v_mul_u32_u24 v32, 1280, v32
    v_lshrrev_b32 v33, 4, v3
    v_lshlrev_b32 v33, 4, v33
    v_add_u32 v33, 79104, v33
    v_sub_u32 v32, v33, v32
    ds_read_b128 v[160:163], v32 offset:0
    ds_read_b128 v[164:167], v32 offset:64
    ds_read_b128 v[168:171], v32 offset:128
    ds_read_b128 v[172:175], v32 offset:192
    ds_read_b128 v[176:179], v32 offset:256
    ds_read_b128 v[180:183], v32 offset:320
    ds_read_b128 v[184:187], v32 offset:384
    ds_read_b128 v[188:191], v32 offset:448
    v_add_u32 v8, 81920, v1
    v_and_b32 v20, 15, v3
    v_lshlrev_b32 v14, 5, v20
    v_add_u32 v14, 73728, v14
    s_lshl_b32 s72, s3, 10
    v_lshrrev_b32 v15, 4, v3
    s_waitcnt vmcnt(10)
    buffer_store_dword v5, v4, s[4:7], s53 offen offset:0
    s_cmp_eq_u32 s43, 0
    s_cbranch_scc1 .Lpubs_18
.Lpubb_17:
    s_waitcnt lgkmcnt(7)
    v_mfma_f32_16x16x32_bf16 v[140:143], v[160:163], a[0:3], 0
    ds_read_b128 v[192:195], v32 offset:512
    ds_read_b128 v[196:199], v32 offset:576
    v_mfma_f32_16x16x32_bf16 v[144:147], v[160:163], a[4:7], 0
    ds_read_b128 v[200:203], v32 offset:640
    ds_read_b128 v[204:207], v32 offset:704
    v_mfma_f32_16x16x32_bf16 v[148:151], v[160:163], a[8:11], 0
    s_waitcnt lgkmcnt(10)
    ds_read_b128 v[208:211], v32 offset:768
    ds_read_b128 v[212:215], v32 offset:832
    v_mfma_f32_16x16x32_bf16 v[140:143], v[164:167], a[12:15], v[140:143]
    ds_read_b128 v[216:219], v32 offset:896
    ds_read_b128 v[220:223], v32 offset:960
    v_mfma_f32_16x16x32_bf16 v[144:147], v[164:167], a[16:19], v[144:147]
    ds_read_b128 v[224:227], v32 offset:1024
    ds_read_b128 v[228:231], v32 offset:1088
    v_mfma_f32_16x16x32_bf16 v[148:151], v[164:167], a[20:23], v[148:151]
    s_waitcnt lgkmcnt(15)
    ds_read_b128 v[232:235], v32 offset:1152
    ds_read_b128 v[236:239], v32 offset:1216
    v_mfma_f32_16x16x32_bf16 v[140:143], v[168:171], a[24:27], v[140:143]
    v_mfma_f32_16x16x32_bf16 v[144:147], v[168:171], a[28:31], v[144:147]
    v_mfma_f32_16x16x32_bf16 v[148:151], v[168:171], a[32:35], v[148:151]
    s_waitcnt lgkmcnt(15)
    v_lshl_add_u32 v15, v15, 3, v14
    v_add_u32 v15, s72, v15
    v_mfma_f32_16x16x32_bf16 v[140:143], v[172:175], a[36:39], v[140:143]
    s_mov_b32 s64, 0xffff
    s_mov_b32 s65, 0xffff
    v_mfma_f32_16x16x32_bf16 v[144:147], v[172:175], a[40:43], v[144:147]
    v_lshlrev_b32 v20, 4, v20
    v_lshrrev_b32 v12, 5, v3
    v_mfma_f32_16x16x32_bf16 v[148:151], v[172:175], a[44:47], v[148:151]
    v_bfe_u32 v13, v3, 4, 1
    s_mov_b32 s72, 49152
    v_mfma_f32_16x16x32_bf16 v[140:143], v[176:179], a[48:51], v[140:143]
    v_mad_u32_u24 v21, v13, s72, v20
    v_lshl_add_u32 v21, v12, 3, v21
    v_mfma_f32_16x16x32_bf16 v[144:147], v[176:179], a[52:55], v[144:147]
    v_mad_u32_u24 v20, v12, s72, v20
    v_lshl_add_u32 v20, v13, 8, v20
    v_mfma_f32_16x16x32_bf16 v[148:151], v[176:179], a[56:59], v[148:151]
    s_waitcnt lgkmcnt(14)
    v_and_b32 v13, 60, v10
    s_mov_b64 s[50:51], 0xffff
    v_mfma_f32_16x16x32_bf16 v[140:143], v[180:183], a[60:63], v[140:143]
    s_mul_i32 s94, s40, 163840
    s_add_u32 s94, s94, 11796480
    v_mfma_f32_16x16x32_bf16 v[144:147], v[180:183], a[64:67], v[144:147]
    s_add_u32 s94, s94, s81
    s_lshl2_add_u32 s76, s40, s3
    v_mfma_f32_16x16x32_bf16 v[148:151], v[180:183], a[68:71], v[148:151]
    s_waitcnt lgkmcnt(13)
    s_lshl_b32 s76, s76, 11
    s_add_u32 s76, s76, 131072
    v_mfma_f32_16x16x32_bf16 v[140:143], v[184:187], a[72:75], v[140:143]
    s_mul_i32 s60, s40, 393216
    s_mul_i32 s72, s47, 49152
    v_mfma_f32_16x16x32_bf16 v[144:147], v[184:187], a[76:79], v[144:147]
    s_add_u32 s60, s60, s72
    s_mul_i32 s72, s3, 12288
    v_mfma_f32_16x16x32_bf16 v[148:151], v[184:187], a[80:83], v[148:151]
    s_waitcnt lgkmcnt(12)
    s_add_u32 s60, s60, s72
    s_add_u32 s63, s60, 25427968
    v_mfma_f32_16x16x32_bf16 v[140:143], v[188:191], a[84:87], v[140:143]
    s_add_u32 s60, s63, 98304
    s_add_u32 s61, s63, 196608
    v_mfma_f32_16x16x32_bf16 v[144:147], v[188:191], a[88:91], v[144:147]
    s_add_u32 s62, s63, 294912
    s_add_u32 s74, s53, 0
    v_mfma_f32_16x16x32_bf16 v[148:151], v[188:191], a[92:95], v[148:151]
    s_mov_b32 s73, 0
    s_nop 6
.Lpoll_19:
    s_add_u32 s73, s73, 1
    buffer_load_dword v64, v10, s[4:7], s74 offen sc1
    s_waitcnt vmcnt(0)
    v_cmp_ne_u32 vcc, s42, v64
    s_cmp_ge_u32 s73, 20000
    s_cbranch_scc1 .Lpollx_20
    s_cmp_lg_u64 vcc, 0
    s_cbranch_scc1 .Lpoll_19
.Lpollx_20:
    s_cmp_eq_u32 s43, 0
    s_cbranch_scc1 .Lacs_22
.Lacb_21:
    s_add_u32 s87, s94, 0
    s_add_u32 m0, s81, 81920
    s_nop 0
    buffer_load_dwordx4 v1, s[4:7], s87 offen offset:0 sc1 lds
    buffer_load_dwordx4 v1, s[4:7], s87 offen offset:1024 sc1 lds
    buffer_load_dwordx4 v1, s[4:7], s87 offen offset:2048 sc1 lds
    buffer_load_dwordx4 v1, s[4:7], s87 offen offset:3072 sc1 lds
    s_add_u32 s87, s87, 4096
    s_add_u32 m0, m0, 4096
    s_nop 0
    buffer_load_dwordx4 v1, s[4:7], s87 offen offset:0 sc1 lds
    buffer_load_dwordx4 v1, s[4:7], s87 offen offset:1024 sc1 lds
    s_waitcnt lgkmcnt(11)
    v_mfma_f32_16x16x32_bf16 v[140:143], v[192:195], a[96:99], v[140:143]
    buffer_load_dwordx4 v1, s[4:7], s87 offen offset:2048 sc1 lds
    v_mfma_f32_16x16x32_bf16 v[144:147], v[192:195], a[100:103], v[144:147]
    v_mfma_f32_16x16x32_bf16 v[148:151], v[192:195], a[104:107], v[148:151]
    s_waitcnt lgkmcnt(10)
    v_mfma_f32_16x16x32_bf16 v[140:143], v[196:199], a[108:111], v[140:143]
    buffer_load_dwordx4 v1, s[4:7], s87 offen offset:3072 sc1 lds
    v_mfma_f32_16x16x32_bf16 v[144:147], v[196:199], a[112:115], v[144:147]
    v_mfma_f32_16x16x32_bf16 v[148:151], v[196:199], a[116:119], v[148:151]
    s_waitcnt lgkmcnt(9)
    v_mfma_f32_16x16x32_bf16 v[140:143], v[200:203], a[120:123], v[140:143]
    s_add_u32 s87, s87, 4096
    s_add_u32 m0, m0, 4096
    s_nop 0
    buffer_load_dwordx4 v1, s[4:7], s87 offen offset:0 sc1 lds
    v_mfma_f32_16x16x32_bf16 v[144:147], v[200:203], a[124:127], v[144:147]
    v_mfma_f32_16x16x32_bf16 v[148:151], v[200:203], a[128:131], v[148:151]
    s_waitcnt lgkmcnt(8)
    v_mfma_f32_16x16x32_bf16 v[140:143], v[204:207], a[132:135], v[140:143]
    buffer_load_dwordx4 v1, s[4:7], s87 offen offset:1024 sc1 lds
    v_mfma_f32_16x16x32_bf16 v[144:147], v[204:207], a[136:139], v[144:147]
    v_mfma_f32_16x16x32_bf16 v[148:151], v[204:207], a[140:143], v[148:151]
    s_waitcnt lgkmcnt(7)
    v_mfma_f32_16x16x32_bf16 v[140:143], v[208:211], a[144:147], v[140:143]
    buffer_load_dwordx4 v[96:99], v1, s[4:7], s76 offen offset:0 sc1
    v_mfma_f32_16x16x32_bf16 v[144:147], v[208:211], a[148:151], v[144:147]
    v_mfma_f32_16x16x32_bf16 v[148:151], v[208:211], a[152:155], v[148:151]
    s_waitcnt lgkmcnt(6)
    v_mfma_f32_16x16x32_bf16 v[140:143], v[212:215], a[156:159], v[140:143]
    buffer_load_dwordx4 v[104:107], v1, s[4:7], s76 offen offset:1024 sc1
    v_mfma_f32_16x16x32_bf16 v[144:147], v[212:215], a[160:163], v[144:147]
    v_mfma_f32_16x16x32_bf16 v[148:151], v[212:215], a[164:167], v[148:151]
    s_waitcnt lgkmcnt(5)
    v_mfma_f32_16x16x32_bf16 v[140:143], v[216:219], a[168:171], v[140:143]
    v_mfma_f32_16x16x32_bf16 v[144:147], v[216:219], a[172:175], v[144:147]
    v_mfma_f32_16x16x32_bf16 v[148:151], v[216:219], a[176:179], v[148:151]
    s_waitcnt lgkmcnt(4)
    v_mfma_f32_16x16x32_bf16 v[140:143], v[220:223], a[180:183], v[140:143]
    v_mfma_f32_16x16x32_bf16 v[144:147], v[220:223], a[184:187], v[144:147]
    v_mfma_f32_16x16x32_bf16 v[148:151], v[220:223], a[188:191], v[148:151]
    s_waitcnt lgkmcnt(3)
    v_mfma_f32_16x16x32_bf16 v[140:143], v[224:227], a[192:195], v[140:143]
    v_mfma_f32_16x16x32_bf16 v[144:147], v[224:227], a[196:199], v[144:147]
    v_mfma_f32_16x16x32_bf16 v[148:151], v[224:227], a[200:203], v[148:151]
    s_waitcnt lgkmcnt(2)
    v_mfma_f32_16x16x32_bf16 v[140:143], v[228:231], a[204:207], v[140:143]
    v_mfma_f32_16x16x32_bf16 v[144:147], v[228:231], a[208:211], v[144:147]
    v_mfma_f32_16x16x32_bf16 v[148:151], v[228:231], a[212:215], v[148:151]
    s_waitcnt lgkmcnt(1)
    v_mfma_f32_16x16x32_bf16 v[140:143], v[232:235], a[216:219], v[140:143]
    v_mfma_f32_16x16x32_bf16 v[144:147], v[232:235], a[220:223], v[144:147]
    v_mfma_f32_16x16x32_bf16 v[148:151], v[232:235], a[224:227], v[148:151]
    s_waitcnt lgkmcnt(0)
    v_mfma_f32_16x16x32_bf16 v[140:143], v[236:239], a[228:231], v[140:143]
    v_mfma_f32_16x16x32_bf16 v[144:147], v[236:239], a[232:235], v[144:147]
    v_mfma_f32_16x16x32_bf16 v[148:151], v[236:239], a[236:239], v[148:151]
    s_add_u32 s74, s53, 2048
    s_lshl_b32 s72, s3, 6
    s_add_u32 s74, s74, s72
    v_add_u32 v10, s95, v1
    s_add_u32 s72, s81, 122880
    v_add_u32 v9, s72, v1
    s_waitcnt vmcnt(2)
    s_barrier
    ds_read_b128 v[80:83], v8 offset:0
    ds_read_b128 v[84:87], v8 offset:20480
    ds_read_b128 v[88:91], v8 offset:1024
    ds_read_b128 v[92:95], v8 offset:21504
    ds_read_b128 v[116:119], v8 offset:2048
    s_waitcnt lgkmcnt(4)
    v_mfma_f32_16x16x32_bf16 v[32:35], a[0:3], v[80:83], 0
    s_add_u32 s87, s94, 40960
    s_add_u32 m0, s81, 0
    ds_read_b128 v[120:123], v8 offset:22528
    buffer_load_dwordx4 v1, s[4:7], s87 offen offset:0 sc1 lds
    v_mfma_f32_16x16x32_bf16 v[36:39], a[4:7], v[80:83], 0
    v_mfma_f32_16x16x32_bf16 v[40:43], a[8:11], v[80:83], 0
    s_waitcnt lgkmcnt(4)
    v_cvt_pk_bf16_f32 v131, v140, v141
    v_lshlrev_b32 v142, 16, v131
    v_mfma_f32_16x16x32_bf16 v[44:47], a[0:3], v[84:87], 0
    ds_read_b128 v[80:83], v8 offset:3072
    buffer_load_dwordx4 v1, s[4:7], s87 offen offset:1024 sc1 lds
    v_mfma_f32_16x16x32_bf16 v[48:51], a[4:7], v[84:87], 0
    v_and_b32 v143, 0xffff0000, v131
    v_sub_f32 v140, v140, v142
    v_mfma_f32_16x16x32_bf16 v[52:55], a[8:11], v[84:87], 0
    s_waitcnt lgkmcnt(4)
    v_sub_f32 v141, v141, v143
    v_cvt_pk_bf16_f32 v128, v142, v142
    v_mfma_f32_16x16x32_bf16 v[32:35], a[12:15], v[88:91], v[32:35]
    ds_read_b128 v[84:87], v8 offset:23552
    v_cvt_pk_bf16_f32 v129, v140, v143
    v_mfma_f32_16x16x32_bf16 v[36:39], a[16:19], v[88:91], v[36:39]
    v_cvt_pk_bf16_f32 v130, v143, v141
    v_cndmask_b32 v128, 0, v128, s[50:51]
    v_mfma_f32_16x16x32_bf16 v[40:43], a[20:23], v[88:91], v[40:43]
    s_waitcnt lgkmcnt(4)
    v_cndmask_b32 v129, 0, v129, s[50:51]
    v_cndmask_b32 v130, 0, v130, s[50:51]
    v_mfma_f32_16x16x32_bf16 v[44:47], a[12:15], v[92:95], v[44:47]
    ds_read_b128 v[88:91], v8 offset:4096
    buffer_load_dwordx4 v1, s[4:7], s87 offen offset:2048 sc1 lds
    v_mfma_f32_16x16x32_bf16 v[48:51], a[16:19], v[92:95], v[48:51]
    v_mov_b32 v131, 0
    v_cvt_pk_bf16_f32 v135, v144, v145
    v_mfma_f32_16x16x32_bf16 v[52:55], a[20:23], v[92:95], v[52:55]
    s_waitcnt lgkmcnt(4)
    v_lshlrev_b32 v146, 16, v135
    v_and_b32 v147, 0xffff0000, v135
    v_mfma_f32_16x16x32_bf16 v[32:35], a[24:27], v[116:119], v[32:35]
    ds_read_b128 v[92:95], v8 offset:24576
    v_sub_f32 v144, v144, v146
    v_mfma_f32_16x16x32_bf16 v[36:39], a[28:31], v[116:119], v[36:39]
    v_sub_f32 v145, v145, v147
    v_cvt_pk_bf16_f32 v132, v146, v146
    v_mfma_f32_16x16x32_bf16 v[40:43], a[32:35], v[116:119], v[40:43]
    s_waitcnt lgkmcnt(4)
    v_cvt_pk_bf16_f32 v133, v144, v147
    v_cvt_pk_bf16_f32 v134, v147, v145
    v_mfma_f32_16x16x32_bf16 v[44:47], a[24:27], v[120:123], v[44:47]
    ds_read_b128 v[116:119], v8 offset:5120
    buffer_load_dwordx4 v1, s[4:7], s87 offen offset:3072 sc1 lds
    v_mfma_f32_16x16x32_bf16 v[48:51], a[28:31], v[120:123], v[48:51]
    v_cndmask_b32 v132, 0, v132, s[50:51]
    v_cndmask_b32 v133, 0, v133, s[50:51]
    v_mfma_f32_16x16x32_bf16 v[52:55], a[32:35], v[120:123], v[52:55]
    s_waitcnt lgkmcnt(4)
    v_cndmask_b32 v134, 0, v134, s[50:51]
    v_mov_b32 v135, 0
    v_mfma_f32_16x16x32_bf16 v[32:35], a[36:39], v[80:83], v[32:35]
    ds_read_b128 v[120:123], v8 offset:25600
    v_cvt_pk_bf16_f32 v139, v148, v149
    v_mfma_f32_16x16x32_bf16 v[36:39], a[40:43], v[80:83], v[36:39]
    v_lshlrev_b32 v150, 16, v139
    v_and_b32 v151, 0xffff0000, v139
    v_mfma_f32_16x16x32_bf16 v[40:43], a[44:47], v[80:83], v[40:43]
    s_waitcnt lgkmcnt(4)
    v_sub_f32 v148, v148, v150
    v_sub_f32 v149, v149, v151
    v_mfma_f32_16x16x32_bf16 v[44:47], a[36:39], v[84:87], v[44:47]
    s_add_u32 s87, s87, 4096
    s_add_u32 m0, m0, 4096
    ds_read_b128 v[80:83], v8 offset:6144
    buffer_load_dwordx4 v1, s[4:7], s87 offen offset:0 sc1 lds
    v_mfma_f32_16x16x32_bf16 v[48:51], a[40:43], v[84:87], v[48:51]
    v_cvt_pk_bf16_f32 v136, v150, v150
    v_cvt_pk_bf16_f32 v137, v148, v151
    v_mfma_f32_16x16x32_bf16 v[52:55], a[44:47], v[84:87], v[52:55]
    s_waitcnt lgkmcnt(4)
    v_cvt_pk_bf16_f32 v138, v151, v149
    v_cndmask_b32 v136, 0, v136, s[50:51]
    v_mfma_f32_16x16x32_bf16 v[32:35], a[48:51], v[88:91], v[32:35]
    ds_read_b128 v[84:87], v8 offset:26624
    v_cndmask_b32 v137, 0, v137, s[50:51]
    v_mfma_f32_16x16x32_bf16 v[36:39], a[52:55], v[88:91], v[36:39]
    v_cndmask_b32 v138, 0, v138, s[50:51]
    v_mov_b32 v139, 0
    v_mfma_f32_16x16x32_bf16 v[40:43], a[56:59], v[88:91], v[40:43]
    s_waitcnt lgkmcnt(4)
    v_mfma_f32_16x16x32_bf16 v[44:47], a[48:51], v[92:95], v[44:47]
    ds_read_b128 v[88:91], v8 offset:7168
    buffer_load_dwordx4 v1, s[4:7], s87 offen offset:1024 sc1 lds
    v_mfma_f32_16x16x32_bf16 v[48:51], a[52:55], v[92:95], v[48:51]
.Lisl5:
    s_cbranch_execz .Lwarm_ret
    v_mfma_f32_16x16x32_bf16 v[52:55], a[56:59], v[92:95], v[52:55]
    s_waitcnt lgkmcnt(4)
    v_mfma_f32_16x16x32_bf16 v[32:35], a[60:63], v[116:119], v[32:35]
    ds_read_b128 v[92:95], v8 offset:27648
    s_waitcnt vmcnt(7)
    v_add_f32 v96, v96, v98
    v_mfma_f32_16x16x32_bf16 v[36:39], a[64:67], v[116:119], v[36:39]
    v_add_f32 v97, v97, v99
    s_waitcnt vmcnt(6)
    v_add_f32 v104, v104, v106
    v_mfma_f32_16x16x32_bf16 v[40:43], a[68:71], v[116:119], v[40:43]
    s_waitcnt lgkmcnt(4)
    v_permlane16_swap_b32 v96, v97
    v_mfma_f32_16x16x32_bf16 v[44:47], a[60:63], v[120:123], v[44:47]
    ds_read_b128 v[116:119], v8 offset:8192
    buffer_load_dwordx4 v1, s[4:7], s87 offen offset:2048 sc1 lds
    v_mfma_f32_16x16x32_bf16 v[48:51], a[64:67], v[120:123], v[48:51]
    v_add_f32 v96, v96, v97
    v_mov_b32 v97, v96
    v_mfma_f32_16x16x32_bf16 v[52:55], a[68:71], v[120:123], v[52:55]
    s_waitcnt lgkmcnt(4)
    v_permlane32_swap_b32 v96, v97
    v_mfma_f32_16x16x32_bf16 v[32:35], a[72:75], v[80:83], v[32:35]
    ds_read_b128 v[120:123], v8 offset:28672
    v_add_f32 v105, v105, v107
    v_mfma_f32_16x16x32_bf16 v[36:39], a[76:79], v[80:83], v[36:39]
    s_nop 0
    v_permlane16_swap_b32 v104, v105
    v_mfma_f32_16x16x32_bf16 v[40:43], a[80:83], v[80:83], v[40:43]
    s_waitcnt lgkmcnt(4)
    v_add_f32 v96, v96, v97
    v_mul_f32 v98, 0xbacccccd, v96
    v_mfma_f32_16x16x32_bf16 v[44:47], a[72:75], v[84:87], v[44:47]
    ds_read_b128 v[80:83], v8 offset:9216
    buffer_load_dwordx4 v1, s[4:7], s87 offen offset:3072 sc1 lds
    v_mfma_f32_16x16x32_bf16 v[48:51], a[76:79], v[84:87], v[48:51]
    v_add_f32 v104, v104, v105
    v_mul_f32 v102, 0xbacccccd, v96
    v_mfma_f32_16x16x32_bf16 v[52:55], a[80:83], v[84:87], v[52:55]
    s_waitcnt lgkmcnt(4)
    v_permlane16_swap_b32 v98, v102
    v_mfma_f32_16x16x32_bf16 v[32:35], a[84:87], v[88:91], v[32:35]
    ds_read_b128 v[84:87], v8 offset:29696
    v_mov_b32 v105, v104
    v_mfma_f32_16x16x32_bf16 v[36:39], a[88:91], v[88:91], v[36:39]
    s_nop 0
    v_permlane32_swap_b32 v104, v105
    v_mfma_f32_16x16x32_bf16 v[40:43], a[92:95], v[88:91], v[40:43]
    s_waitcnt lgkmcnt(4)
    v_fma_f32 v102, -v98, v98, -v102
    v_add_f32 v104, v104, v105
    v_mfma_f32_16x16x32_bf16 v[44:47], a[84:87], v[92:95], v[44:47]
    s_add_u32 s87, s87, 4096
    s_add_u32 m0, m0, 4096
    ds_read_b128 v[88:91], v8 offset:10240
    buffer_load_dwordx4 v1, s[4:7], s87 offen offset:0 sc1 lds
    v_mfma_f32_16x16x32_bf16 v[48:51], a[88:91], v[92:95], v[48:51]
    v_max_f32 v102, 0, v102
    v_mul_f32 v106, 0xbacccccd, v104
    v_mfma_f32_16x16x32_bf16 v[52:55], a[92:95], v[92:95], v[52:55]
    s_waitcnt lgkmcnt(4)
    v_add_f32 v102, 0x3727c5ac, v102
    v_mul_f32 v110, 0xbacccccd, v104
    v_mfma_f32_16x16x32_bf16 v[32:35], a[96:99], v[116:119], v[32:35]
    ds_read_b128 v[92:95], v8 offset:30720
    v_mfma_f32_16x16x32_bf16 v[36:39], a[100:103], v[116:119], v[36:39]
    v_rsq_f32 v100, v102
    v_mfma_f32_16x16x32_bf16 v[40:43], a[104:107], v[116:119], v[40:43]
    s_waitcnt lgkmcnt(4)
    v_permlane16_swap_b32 v106, v110
    v_mfma_f32_16x16x32_bf16 v[44:47], a[96:99], v[120:123], v[44:47]
    ds_read_b128 v[116:119], v8 offset:11264
    buffer_load_dwordx4 v1, s[4:7], s87 offen offset:1024 sc1 lds
    v_mfma_f32_16x16x32_bf16 v[48:51], a[100:103], v[120:123], v[48:51]
    v_mul_f32 v99, v102, v100
    v_fma_f32 v110, -v106, v106, -v110
    v_mfma_f32_16x16x32_bf16 v[52:55], a[104:107], v[120:123], v[52:55]
    s_waitcnt lgkmcnt(4)
    v_mul_f32 v101, v100, v100
    v_max_f32 v110, 0, v110
    v_mfma_f32_16x16x32_bf16 v[32:35], a[108:111], v[80:83], v[32:35]
    ds_read_b128 v[120:123], v8 offset:31744
    v_mul_f32 v100, 0xc0135761, v100
    v_mfma_f32_16x16x32_bf16 v[36:39], a[112:115], v[80:83], v[36:39]
    v_add_f32 v110, 0x3727c5ac, v110
    v_mul_f32 v101, v101, v100
    v_mfma_f32_16x16x32_bf16 v[40:43], a[116:119], v[80:83], v[40:43]
    s_waitcnt lgkmcnt(4)
    v_rsq_f32 v108, v110
    v_mfma_f32_16x16x32_bf16 v[44:47], a[108:111], v[84:87], v[44:47]
    s_add_u32 s86, s86, 4096
    s_add_u32 m0, s81, 126976
    ds_read_b128 v[80:83], v8 offset:12288
    buffer_load_dwordx4 v1, s[4:7], s86 offen offset:0 sc1 lds
    v_mfma_f32_16x16x32_bf16 v[48:51], a[112:115], v[84:87], v[48:51]
    v_mul_f32 v101, 0x3d372713, v101
    v_mul_f32 v107, v110, v108
    v_mfma_f32_16x16x32_bf16 v[52:55], a[116:119], v[84:87], v[52:55]
    s_waitcnt lgkmcnt(4)
    v_cvt_pk_bf16_f32 v97, v98, v99
    v_mul_f32 v109, v108, v108
    v_mfma_f32_16x16x32_bf16 v[32:35], a[120:123], v[88:91], v[32:35]
    ds_read_b128 v[84:87], v8 offset:32768
    v_lshlrev_b32 v96, 16, v97
    v_mfma_f32_16x16x32_bf16 v[36:39], a[124:127], v[88:91], v[36:39]
    v_mul_f32 v108, 0xc0135761, v108
    v_and_b32 v103, 0xffff0000, v97
    v_mfma_f32_16x16x32_bf16 v[40:43], a[128:131], v[88:91], v[40:43]
    s_waitcnt lgkmcnt(4)
    v_mul_f32 v109, v109, v108
    v_sub_f32 v98, v98, v96
    v_mfma_f32_16x16x32_bf16 v[44:47], a[120:123], v[92:95], v[44:47]
    s_add_u32 m0, s81, 126976
    ds_read_b128 v[88:91], v8 offset:13312
    buffer_load_dwordx4 v1, s[4:7], s86 offen offset:1024 sc1 lds
    v_mfma_f32_16x16x32_bf16 v[48:51], a[124:127], v[92:95], v[48:51]
    v_mul_f32 v109, 0x3d372713, v109
    v_sub_f32 v99, v99, v103
    v_mfma_f32_16x16x32_bf16 v[52:55], a[128:131], v[92:95], v[52:55]
    s_waitcnt lgkmcnt(4)
    v_cvt_pk_bf16_f32 v105, v106, v107
    v_cvt_pk_bf16_f32 v96, v96, v98
    v_mfma_f32_16x16x32_bf16 v[32:35], a[132:135], v[116:119], v[32:35]
    s_add_u32 m0, s81, 126976
    ds_read_b128 v[92:95], v8 offset:33792
    buffer_load_dwordx4 v1, s[4:7], s86 offen offset:2048 sc1 lds
    v_mfma_f32_16x16x32_bf16 v[36:39], a[136:139], v[116:119], v[36:39]
    v_lshlrev_b32 v104, 16, v105
    v_cvt_pk_bf16_f32 v98, v99, v103
    v_mfma_f32_16x16x32_bf16 v[40:43], a[140:143], v[116:119], v[40:43]
    s_waitcnt lgkmcnt(4)
    v_and_b32 v111, 0xffff0000, v105
    v_mov_b32 v99, 0
    v_mfma_f32_16x16x32_bf16 v[44:47], a[132:135], v[120:123], v[44:47]
    ds_read_b128 v[116:119], v8 offset:14336
    v_sub_f32 v106, v106, v104
    v_mfma_f32_16x16x32_bf16 v[48:51], a[136:139], v[120:123], v[48:51]
    v_cndmask_b32 v96, v98, v96, s[64:65]
    v_sub_f32 v107, v107, v111
    v_mfma_f32_16x16x32_bf16 v[52:55], a[140:143], v[120:123], v[52:55]
    s_waitcnt lgkmcnt(4)
    v_cndmask_b32 v100, v102, v100, s[64:65]
    v_cvt_pk_bf16_f32 v104, v104, v106
    v_mfma_f32_16x16x32_bf16 v[32:35], a[144:147], v[80:83], v[32:35]
    s_add_u32 m0, s81, 126976
    ds_read_b128 v[120:123], v8 offset:34816
    buffer_load_dwordx4 v1, s[4:7], s86 offen offset:3072 sc1 lds
    v_mfma_f32_16x16x32_bf16 v[36:39], a[148:151], v[80:83], v[36:39]
    v_cndmask_b32 v97, v99, v97, s[64:65]
    v_cvt_pk_bf16_f32 v106, v107, v111
    v_mfma_f32_16x16x32_bf16 v[40:43], a[152:155], v[80:83], v[40:43]
    s_waitcnt lgkmcnt(4)
    v_cndmask_b32 v101, v103, v101, s[64:65]
    v_mov_b32 v107, 0
    v_mfma_f32_16x16x32_bf16 v[44:47], a[144:147], v[84:87], v[44:47]
    ds_read_b128 v[80:83], v8 offset:15360
    v_cndmask_b32 v96, v100, v96, s[48:49]
    v_mfma_f32_16x16x32_bf16 v[48:51], a[148:151], v[84:87], v[48:51]
    v_cndmask_b32 v104, v106, v104, s[64:65]
    v_cndmask_b32 v97, v101, v97, s[48:49]
    v_mfma_f32_16x16x32_bf16 v[52:55], a[152:155], v[84:87], v[52:55]
    s_waitcnt lgkmcnt(4)
    ds_write_b64 v15, v[96:97] offset:0
    v_mfma_f32_16x16x32_bf16 v[32:35], a[156:159], v[88:91], v[32:35]
    s_add_u32 s86, s86, 4096
    s_add_u32 m0, s81, 131072
    ds_read_b128 v[84:87], v8 offset:35840
    buffer_load_dwordx4 v1, s[4:7], s86 offen offset:0 sc1 lds
    v_mfma_f32_16x16x32_bf16 v[36:39], a[160:163], v[88:91], v[36:39]
    v_cndmask_b32 v108, v110, v108, s[64:65]
    v_cndmask_b32 v105, v107, v105, s[64:65]
    v_mfma_f32_16x16x32_bf16 v[40:43], a[164:167], v[88:91], v[40:43]
    s_waitcnt lgkmcnt(5)
    v_cndmask_b32 v109, v111, v109, s[64:65]
    v_cndmask_b32 v104, v108, v104, s[48:49]
    v_mfma_f32_16x16x32_bf16 v[44:47], a[156:159], v[92:95], v[44:47]
    ds_read_b128 v[88:91], v8 offset:16384
    v_cndmask_b32 v105, v109, v105, s[48:49]
    v_mfma_f32_16x16x32_bf16 v[48:51], a[160:163], v[92:95], v[48:51]
    ds_write_b64 v15, v[104:105] offset:512
    v_mfma_f32_16x16x32_bf16 v[52:55], a[164:167], v[92:95], v[52:55]
    s_waitcnt lgkmcnt(6)
    v_mfma_f32_16x16x32_bf16 v[32:35], a[168:171], v[116:119], v[32:35]
    s_add_u32 m0, s81, 131072
    ds_read_b128 v[92:95], v8 offset:36864
    buffer_load_dwordx4 v1, s[4:7], s86 offen offset:1024 sc1 lds
    v_mfma_f32_16x16x32_bf16 v[36:39], a[172:175], v[116:119], v[36:39]
    v_mfma_f32_16x16x32_bf16 v[40:43], a[176:179], v[116:119], v[40:43]
    s_waitcnt lgkmcnt(6)
    v_mfma_f32_16x16x32_bf16 v[44:47], a[168:171], v[120:123], v[44:47]
    ds_read_b128 v[116:119], v8 offset:17408
    v_mfma_f32_16x16x32_bf16 v[48:51], a[172:175], v[120:123], v[48:51]
    v_mfma_f32_16x16x32_bf16 v[52:55], a[176:179], v[120:123], v[52:55]
    s_waitcnt lgkmcnt(6)
    v_mfma_f32_16x16x32_bf16 v[32:35], a[180:183], v[80:83], v[32:35]
    ds_read_b128 v[120:123], v8 offset:37888
    buffer_load_dwordx4 v[152:155], v1, s[4:7], s86 offen offset:2048 sc1
    v_mfma_f32_16x16x32_bf16 v[36:39], a[184:187], v[80:83], v[36:39]
    v_mfma_f32_16x16x32_bf16 v[40:43], a[188:191], v[80:83], v[40:43]
    s_waitcnt lgkmcnt(5)
    v_mfma_f32_16x16x32_bf16 v[44:47], a[180:183], v[84:87], v[44:47]
    ds_read_b128 v[80:83], v8 offset:18432
    v_mfma_f32_16x16x32_bf16 v[48:51], a[184:187], v[84:87], v[48:51]
    v_mfma_f32_16x16x32_bf16 v[52:55], a[188:191], v[84:87], v[52:55]
    s_waitcnt lgkmcnt(5)
    v_mfma_f32_16x16x32_bf16 v[32:35], a[192:195], v[88:91], v[32:35]
    ds_read_b128 v[84:87], v8 offset:38912
    buffer_load_dwordx4 v[156:159], v1, s[4:7], s86 offen offset:3072 sc1
    v_mfma_f32_16x16x32_bf16 v[36:39], a[196:199], v[88:91], v[36:39]
    v_mfma_f32_16x16x32_bf16 v[40:43], a[200:203], v[88:91], v[40:43]
    s_waitcnt lgkmcnt(4)
    v_mfma_f32_16x16x32_bf16 v[44:47], a[192:195], v[92:95], v[44:47]
    ds_read_b128 v[88:91], v8 offset:19456
    v_mfma_f32_16x16x32_bf16 v[48:51], a[196:199], v[92:95], v[48:51]
    v_mfma_f32_16x16x32_bf16 v[52:55], a[200:203], v[92:95], v[52:55]
    s_waitcnt lgkmcnt(4)
    v_mfma_f32_16x16x32_bf16 v[32:35], a[204:207], v[116:119], v[32:35]
    s_add_u32 s86, s86, 4096
    ds_read_b128 v[92:95], v8 offset:39936
    buffer_load_dwordx4 v[160:163], v1, s[4:7], s86 offen offset:0 sc1
    v_mfma_f32_16x16x32_bf16 v[36:39], a[208:211], v[116:119], v[36:39]
    v_mfma_f32_16x16x32_bf16 v[40:43], a[212:215], v[116:119], v[40:43]
    s_waitcnt lgkmcnt(4)
    v_mfma_f32_16x16x32_bf16 v[44:47], a[204:207], v[120:123], v[44:47]
    s_waitcnt vmcnt(9)
    s_barrier
    ds_read_b128 v[116:119], v1 offset:0
    v_mfma_f32_16x16x32_bf16 v[48:51], a[208:211], v[120:123], v[48:51]
    v_mfma_f32_16x16x32_bf16 v[52:55], a[212:215], v[120:123], v[52:55]
    s_waitcnt lgkmcnt(4)
    v_mfma_f32_16x16x32_bf16 v[32:35], a[216:219], v[80:83], v[32:35]
    ds_read_b128 v[120:123], v1 offset:20480
    buffer_load_dwordx4 v[164:167], v1, s[4:7], s86 offen offset:1024 sc1
    v_mfma_f32_16x16x32_bf16 v[36:39], a[220:223], v[80:83], v[36:39]
    v_mfma_f32_16x16x32_bf16 v[40:43], a[224:227], v[80:83], v[40:43]
    s_waitcnt lgkmcnt(4)
    v_mfma_f32_16x16x32_bf16 v[44:47], a[216:219], v[84:87], v[44:47]
    ds_read_b128 v[80:83], v1 offset:1024
    v_mfma_f32_16x16x32_bf16 v[48:51], a[220:223], v[84:87], v[48:51]
    ds_read_b128 v[96:99], v14 offset:0
    v_mfma_f32_16x16x32_bf16 v[52:55], a[224:227], v[84:87], v[52:55]
    s_waitcnt lgkmcnt(5)
    v_mfma_f32_16x16x32_bf16 v[32:35], a[228:231], v[88:91], v[32:35]
    ds_read_b128 v[84:87], v1 offset:21504
    buffer_load_dwordx4 v[168:171], v1, s[4:7], s86 offen offset:2048 sc1
    v_mfma_f32_16x16x32_bf16 v[36:39], a[232:235], v[88:91], v[36:39]
    ds_read_b128 v[100:103], v14 offset:16
    v_mfma_f32_16x16x32_bf16 v[40:43], a[236:239], v[88:91], v[40:43]
    s_waitcnt lgkmcnt(6)
    v_mfma_f32_16x16x32_bf16 v[44:47], a[228:231], v[92:95], v[44:47]
    ds_read_b128 v[88:91], v1 offset:2048
    v_mfma_f32_16x16x32_bf16 v[48:51], a[232:235], v[92:95], v[48:51]
    ds_read_b128 v[104:107], v14 offset:512
    v_mfma_f32_16x16x32_bf16 v[52:55], a[236:239], v[92:95], v[52:55]
    s_waitcnt lgkmcnt(7)
    v_mfma_f32_16x16x32_bf16 v[56:59], a[0:3], v[116:119], 0
    ds_read_b128 v[92:95], v1 offset:22528
    buffer_load_dwordx4 v[172:175], v1, s[4:7], s86 offen offset:3072 sc1
    v_mfma_f32_16x16x32_bf16 v[60:63], a[4:7], v[116:119], 0
    ds_read_b128 v[108:111], v14 offset:528
    v_mfma_f32_16x16x32_bf16 v[64:67], a[8:11], v[116:119], 0
    s_waitcnt lgkmcnt(8)
    v_mfma_f32_16x16x32_bf16 v[68:71], a[0:3], v[120:123], 0
    ds_read_b128 v[116:119], v1 offset:3072
    v_mfma_f32_16x16x32_bf16 v[72:75], a[4:7], v[120:123], 0
    s_barrier
    v_mfma_f32_16x16x32_bf16 v[76:79], a[8:11], v[120:123], 0
    s_waitcnt lgkmcnt(7)
    v_mfma_f32_16x16x32_bf16 v[32:35], v[128:131], v[96:99], v[32:35]
    s_add_u32 s87, s94, 81920
    s_add_u32 m0, s81, 81920
    s_nop 0
    buffer_load_dwordx4 v1, s[4:7], s87 offen offset:0 sc1 lds
    v_mfma_f32_16x16x32_bf16 v[36:39], v[132:135], v[96:99], v[36:39]
    v_mfma_f32_16x16x32_bf16 v[40:43], v[136:139], v[96:99], v[40:43]
    s_waitcnt lgkmcnt(3)
    v_mfma_f32_16x16x32_bf16 v[44:47], v[128:131], v[104:107], v[44:47]
    buffer_load_dwordx4 v1, s[4:7], s87 offen offset:1024 sc1 lds
    v_mfma_f32_16x16x32_bf16 v[48:51], v[132:135], v[104:107], v[48:51]
    v_mfma_f32_16x16x32_bf16 v[52:55], v[136:139], v[104:107], v[52:55]
    v_mfma_f32_16x16x32_bf16 v[56:59], a[12:15], v[80:83], v[56:59]
    ds_read_b128 v[120:123], v1 offset:23552
    v_mfma_f32_16x16x32_bf16 v[60:63], a[16:19], v[80:83], v[60:63]
    v_mfma_f32_16x16x32_bf16 v[64:67], a[20:23], v[80:83], v[64:67]
    v_mul_f32 v112, v32, v32
    v_mul_f32 v113, v33, v33
    v_mfma_f32_16x16x32_bf16 v[68:71], a[12:15], v[84:87], v[68:71]
    ds_read_b128 v[80:83], v1 offset:4096
    buffer_load_dwordx4 v1, s[4:7], s87 offen offset:2048 sc1 lds
    v_mfma_f32_16x16x32_bf16 v[72:75], a[16:19], v[84:87], v[72:75]
    v_fma_f32 v112, v112, v101, v100
    v_fma_f32 v113, v113, v101, v100
    v_mfma_f32_16x16x32_bf16 v[76:79], a[20:23], v[84:87], v[76:79]
    v_mul_f32 v112, v112, v32
    v_mul_f32 v113, v113, v33
    v_mfma_f32_16x16x32_bf16 v[56:59], a[24:27], v[88:91], v[56:59]
    ds_read_b128 v[84:87], v1 offset:24576
    buffer_load_dwordx4 v1, s[4:7], s87 offen offset:3072 sc1 lds
    v_mfma_f32_16x16x32_bf16 v[60:63], a[28:31], v[88:91], v[60:63]
    v_exp_f32 v112, v112
    v_mfma_f32_16x16x32_bf16 v[64:67], a[32:35], v[88:91], v[64:67]
    s_waitcnt lgkmcnt(5)
    v_exp_f32 v113, v113
    v_mfma_f32_16x16x32_bf16 v[68:71], a[24:27], v[92:95], v[68:71]
    ds_read_b128 v[88:91], v1 offset:5120
    v_mul_f32 v32, v32, v34
    v_mfma_f32_16x16x32_bf16 v[72:75], a[28:31], v[92:95], v[72:75]
    v_mul_f32 v114, v44, v44
    v_fma_f32 v112, v112, v102, v102
    v_mfma_f32_16x16x32_bf16 v[76:79], a[32:35], v[92:95], v[76:79]
    s_waitcnt lgkmcnt(4)
    v_rcp_f32 v112, v112
    v_mfma_f32_16x16x32_bf16 v[56:59], a[36:39], v[116:119], v[56:59]
    s_add_u32 s87, s87, 4096
    s_add_u32 m0, m0, 4096
    ds_read_b128 v[92:95], v1 offset:25600
    buffer_load_dwordx4 v1, s[4:7], s87 offen offset:0 sc1 lds
    v_mfma_f32_16x16x32_bf16 v[60:63], a[40:43], v[116:119], v[60:63]
    v_mul_f32 v115, v45, v45
    v_fma_f32 v113, v113, v102, v102
    v_mfma_f32_16x16x32_bf16 v[64:67], a[44:47], v[116:119], v[64:67]
    s_waitcnt lgkmcnt(4)
    v_rcp_f32 v113, v113
    v_mfma_f32_16x16x32_bf16 v[68:71], a[36:39], v[120:123], v[68:71]
    ds_read_b128 v[116:119], v1 offset:6144
    buffer_load_dwordx4 v1, s[4:7], s87 offen offset:1024 sc1 lds
    v_mfma_f32_16x16x32_bf16 v[72:75], a[40:43], v[120:123], v[72:75]
    v_fma_f32 v114, v114, v109, v108
    v_fma_f32 v115, v115, v109, v108
    v_mfma_f32_16x16x32_bf16 v[76:79], a[44:47], v[120:123], v[76:79]
    s_waitcnt lgkmcnt(4)
    v_mul_f32 v114, v114, v44
    v_mul_f32 v33, v33, v35
    v_mfma_f32_16x16x32_bf16 v[56:59], a[48:51], v[80:83], v[56:59]
    ds_read_b128 v[120:123], v1 offset:26624
    v_mul_f32 v115, v115, v45
    v_mfma_f32_16x16x32_bf16 v[60:63], a[52:55], v[80:83], v[60:63]
    v_exp_f32 v114, v114
    v_mfma_f32_16x16x32_bf16 v[64:67], a[56:59], v[80:83], v[64:67]
    s_waitcnt lgkmcnt(4)
    v_exp_f32 v115, v115
    v_mfma_f32_16x16x32_bf16 v[68:71], a[48:51], v[84:87], v[68:71]
    ds_read_b128 v[80:83], v1 offset:7168
    buffer_load_dwordx4 v1, s[4:7], s87 offen offset:2048 sc1 lds
    v_mfma_f32_16x16x32_bf16 v[72:75], a[52:55], v[84:87], v[72:75]
    v_mul_f32 v32, v32, v112
    v_mul_f32 v33, v33, v113
    v_mfma_f32_16x16x32_bf16 v[76:79], a[56:59], v[84:87], v[76:79]
    s_waitcnt lgkmcnt(4)
    v_cvt_pk_bf16_f32 v16, v32, v33
    v_mul_f32 v44, v44, v46
    v_mfma_f32_16x16x32_bf16 v[56:59], a[60:63], v[88:91], v[56:59]
    ds_read_b128 v[84:87], v1 offset:27648
    v_mul_f32 v112, v36, v36
    v_mfma_f32_16x16x32_bf16 v[60:63], a[64:67], v[88:91], v[60:63]
    v_fma_f32 v114, v114, v110, v110
    v_mul_f32 v113, v37, v37
    v_mfma_f32_16x16x32_bf16 v[64:67], a[68:71], v[88:91], v[64:67]
    s_waitcnt lgkmcnt(4)
    v_rcp_f32 v114, v114
    v_mfma_f32_16x16x32_bf16 v[68:71], a[60:63], v[92:95], v[68:71]
    ds_read_b128 v[88:91], v1 offset:8192
    buffer_load_dwordx4 v1, s[4:7], s87 offen offset:3072 sc1 lds
    v_mfma_f32_16x16x32_bf16 v[72:75], a[64:67], v[92:95], v[72:75]
    v_fma_f32 v115, v115, v110, v110
    v_fma_f32 v112, v112, v101, v100
    v_mfma_f32_16x16x32_bf16 v[76:79], a[68:71], v[92:95], v[76:79]
    s_waitcnt lgkmcnt(4)
    v_rcp_f32 v115, v115
    v_mfma_f32_16x16x32_bf16 v[56:59], a[72:75], v[116:119], v[56:59]
    s_add_u32 s87, s87, 4096
    s_add_u32 m0, m0, 4096
    ds_read_b128 v[92:95], v1 offset:28672
    buffer_load_dwordx4 v1, s[4:7], s87 offen offset:0 sc1 lds
    v_mfma_f32_16x16x32_bf16 v[60:63], a[76:79], v[116:119], v[60:63]
    v_fma_f32 v113, v113, v101, v100
    v_mul_f32 v112, v112, v36
    v_mfma_f32_16x16x32_bf16 v[64:67], a[80:83], v[116:119], v[64:67]
    s_waitcnt lgkmcnt(4)
    v_exp_f32 v112, v112
    v_mfma_f32_16x16x32_bf16 v[68:71], a[72:75], v[120:123], v[68:71]
    ds_read_b128 v[116:119], v1 offset:9216
    v_mul_f32 v45, v45, v47
    v_mfma_f32_16x16x32_bf16 v[72:75], a[76:79], v[120:123], v[72:75]
    v_mul_f32 v113, v113, v37
    v_mul_f32 v44, v44, v114
    v_mfma_f32_16x16x32_bf16 v[76:79], a[80:83], v[120:123], v[76:79]
    s_waitcnt lgkmcnt(4)
    v_exp_f32 v113, v113
    v_mfma_f32_16x16x32_bf16 v[56:59], a[84:87], v[80:83], v[56:59]
    ds_read_b128 v[120:123], v1 offset:29696
    buffer_load_dwordx4 v1, s[4:7], s87 offen offset:1024 sc1 lds
    v_mfma_f32_16x16x32_bf16 v[60:63], a[88:91], v[80:83], v[60:63]
    v_mul_f32 v45, v45, v115
    v_cvt_pk_bf16_f32 v18, v44, v45
    v_mfma_f32_16x16x32_bf16 v[64:67], a[92:95], v[80:83], v[64:67]
    s_waitcnt lgkmcnt(4)
    v_mul_f32 v36, v36, v38
    v_mul_f32 v114, v48, v48
    v_mfma_f32_16x16x32_bf16 v[68:71], a[84:87], v[84:87], v[68:71]
    s_add_u32 s86, s86, 4096
    ds_read_b128 v[80:83], v1 offset:10240
    buffer_load_dwordx4 v[176:179], v1, s[4:7], s86 offen offset:0 sc1
    v_mfma_f32_16x16x32_bf16 v[72:75], a[88:91], v[84:87], v[72:75]
    v_fma_f32 v112, v112, v102, v102
    v_mul_f32 v115, v49, v49
    v_mfma_f32_16x16x32_bf16 v[76:79], a[92:95], v[84:87], v[76:79]
    s_waitcnt lgkmcnt(4)
    v_rcp_f32 v112, v112
    v_mfma_f32_16x16x32_bf16 v[56:59], a[96:99], v[88:91], v[56:59]
    ds_read_b128 v[84:87], v1 offset:30720
    v_fma_f32 v113, v113, v102, v102
    v_mfma_f32_16x16x32_bf16 v[60:63], a[100:103], v[88:91], v[60:63]
    v_rcp_f32 v113, v113
    v_mfma_f32_16x16x32_bf16 v[64:67], a[104:107], v[88:91], v[64:67]
    s_waitcnt lgkmcnt(4)
    v_fma_f32 v114, v114, v109, v108
    v_fma_f32 v115, v115, v109, v108
    v_mfma_f32_16x16x32_bf16 v[68:71], a[96:99], v[92:95], v[68:71]
    ds_read_b128 v[88:91], v1 offset:11264
    buffer_load_dwordx4 v[180:183], v1, s[4:7], s86 offen offset:1024 sc1
    v_mfma_f32_16x16x32_bf16 v[72:75], a[100:103], v[92:95], v[72:75]
    v_mul_f32 v114, v114, v48
    v_mul_f32 v37, v37, v39
    v_mfma_f32_16x16x32_bf16 v[76:79], a[104:107], v[92:95], v[76:79]
    s_waitcnt lgkmcnt(4)
    v_exp_f32 v114, v114
    v_mfma_f32_16x16x32_bf16 v[56:59], a[108:111], v[116:119], v[56:59]
    ds_read_b128 v[92:95], v1 offset:31744
    buffer_load_dwordx4 v[184:187], v1, s[4:7], s86 offen offset:2048 sc1
    v_mfma_f32_16x16x32_bf16 v[60:63], a[112:115], v[116:119], v[60:63]
    v_mul_f32 v115, v115, v49
    v_mul_f32 v36, v36, v112
    v_mfma_f32_16x16x32_bf16 v[64:67], a[116:119], v[116:119], v[64:67]
    s_waitcnt lgkmcnt(4)
    v_exp_f32 v115, v115
    v_mfma_f32_16x16x32_bf16 v[68:71], a[108:111], v[120:123], v[68:71]
    ds_read_b128 v[116:119], v1 offset:12288
    v_mul_f32 v37, v37, v113
    v_mfma_f32_16x16x32_bf16 v[72:75], a[112:115], v[120:123], v[72:75]
    v_cvt_pk_bf16_f32 v17, v36, v37
    v_mul_f32 v48, v48, v50
    v_mfma_f32_16x16x32_bf16 v[76:79], a[116:119], v[120:123], v[76:79]
    s_waitcnt lgkmcnt(4)
    v_mul_f32 v112, v40, v40
    v_fma_f32 v114, v114, v110, v110
    v_mfma_f32_16x16x32_bf16 v[56:59], a[120:123], v[80:83], v[56:59]
    ds_read_b128 v[120:123], v1 offset:32768
    buffer_load_dwordx4 v[188:191], v1, s[4:7], s86 offen offset:3072 sc1
    v_mfma_f32_16x16x32_bf16 v[60:63], a[124:127], v[80:83], v[60:63]
    v_rcp_f32 v114, v114
    v_mfma_f32_16x16x32_bf16 v[64:67], a[128:131], v[80:83], v[64:67]
    s_waitcnt lgkmcnt(4)
    v_mul_f32 v113, v41, v41
    v_fma_f32 v115, v115, v110, v110
    v_mfma_f32_16x16x32_bf16 v[68:71], a[120:123], v[84:87], v[68:71]
    ds_read_b128 v[80:83], v1 offset:13312
    v_fma_f32 v112, v112, v101, v100
    v_mfma_f32_16x16x32_bf16 v[72:75], a[124:127], v[84:87], v[72:75]
    v_rcp_f32 v115, v115
    v_mfma_f32_16x16x32_bf16 v[76:79], a[128:131], v[84:87], v[76:79]
    s_waitcnt lgkmcnt(4)
    v_fma_f32 v113, v113, v101, v100
    v_mul_f32 v112, v112, v40
    v_mfma_f32_16x16x32_bf16 v[56:59], a[132:135], v[88:91], v[56:59]
    s_add_u32 s86, s86, 4096
    ds_read_b128 v[84:87], v1 offset:33792
    buffer_load_dwordx4 v[192:195], v1, s[4:7], s86 offen offset:0 sc1
    v_mfma_f32_16x16x32_bf16 v[60:63], a[136:139], v[88:91], v[60:63]
    v_exp_f32 v112, v112
    v_mfma_f32_16x16x32_bf16 v[64:67], a[140:143], v[88:91], v[64:67]
    s_waitcnt lgkmcnt(4)
    v_mul_f32 v49, v49, v51
    v_mul_f32 v113, v113, v41
    v_mfma_f32_16x16x32_bf16 v[68:71], a[132:135], v[92:95], v[68:71]
    ds_read_b128 v[88:91], v1 offset:14336
    buffer_load_dwordx4 v[196:199], v1, s[4:7], s86 offen offset:1024 sc1
    v_mfma_f32_16x16x32_bf16 v[72:75], a[136:139], v[92:95], v[72:75]
    v_exp_f32 v113, v113
    v_mfma_f32_16x16x32_bf16 v[76:79], a[140:143], v[92:95], v[76:79]
    s_waitcnt lgkmcnt(4)
    v_mul_f32 v48, v48, v114
    v_mul_f32 v49, v49, v115
    v_mfma_f32_16x16x32_bf16 v[56:59], a[144:147], v[116:119], v[56:59]
    ds_read_b128 v[92:95], v1 offset:34816
    v_cvt_pk_bf16_f32 v19, v48, v49
    v_mfma_f32_16x16x32_bf16 v[60:63], a[148:151], v[116:119], v[60:63]
    v_mul_f32 v40, v40, v42
    v_mul_f32 v114, v52, v52
    v_mfma_f32_16x16x32_bf16 v[64:67], a[152:155], v[116:119], v[64:67]
    s_waitcnt lgkmcnt(4)
    v_fma_f32 v112, v112, v102, v102
    v_mul_f32 v115, v53, v53
    v_mfma_f32_16x16x32_bf16 v[68:71], a[144:147], v[120:123], v[68:71]
    ds_read_b128 v[116:119], v1 offset:15360
    buffer_load_dwordx4 v[200:203], v1, s[4:7], s86 offen offset:2048 sc1
    v_mfma_f32_16x16x32_bf16 v[72:75], a[148:151], v[120:123], v[72:75]
    v_rcp_f32 v112, v112
    v_mfma_f32_16x16x32_bf16 v[76:79], a[152:155], v[120:123], v[76:79]
    s_waitcnt lgkmcnt(4)
    v_permlane32_swap_b32 v16, v18
    v_mfma_f32_16x16x32_bf16 v[56:59], a[156:159], v[80:83], v[56:59]
    ds_read_b128 v[120:123], v1 offset:35840
    buffer_load_dwordx4 v[204:207], v1, s[4:7], s86 offen offset:3072 sc1
    v_mfma_f32_16x16x32_bf16 v[60:63], a[160:163], v[80:83], v[60:63]
    v_permlane32_swap_b32 v17, v19
    v_mfma_f32_16x16x32_bf16 v[64:67], a[164:167], v[80:83], v[64:67]
    s_waitcnt lgkmcnt(4)
    v_permlane16_swap_b32 v16, v17
    v_mfma_f32_16x16x32_bf16 v[68:71], a[156:159], v[84:87], v[68:71]
    ds_read_b128 v[80:83], v1 offset:16384
    v_fma_f32 v113, v113, v102, v102
    v_mfma_f32_16x16x32_bf16 v[72:75], a[160:163], v[84:87], v[72:75]
    v_rcp_f32 v113, v113
    v_mfma_f32_16x16x32_bf16 v[76:79], a[164:167], v[84:87], v[76:79]
    s_waitcnt lgkmcnt(4)
    v_permlane16_swap_b32 v18, v19
    v_mfma_f32_16x16x32_bf16 v[56:59], a[168:171], v[88:91], v[56:59]
    s_add_u32 s86, s86, 4096
    ds_read_b128 v[84:87], v1 offset:36864
    buffer_load_dwordx4 v[208:211], v1, s[4:7], s86 offen offset:0 sc1
    v_mfma_f32_16x16x32_bf16 v[60:63], a[172:175], v[88:91], v[60:63]
    v_fma_f32 v114, v114, v109, v108
    v_fma_f32 v115, v115, v109, v108
    v_mfma_f32_16x16x32_bf16 v[64:67], a[176:179], v[88:91], v[64:67]
    s_waitcnt lgkmcnt(4)
    v_mul_f32 v114, v114, v52
    v_mul_f32 v41, v41, v43
    v_mfma_f32_16x16x32_bf16 v[68:71], a[168:171], v[92:95], v[68:71]
    ds_read_b128 v[88:91], v1 offset:17408
    buffer_load_dwordx4 v[212:215], v1, s[4:7], s86 offen offset:1024 sc1
    v_mfma_f32_16x16x32_bf16 v[72:75], a[172:175], v[92:95], v[72:75]
    v_exp_f32 v114, v114
    v_mfma_f32_16x16x32_bf16 v[76:79], a[176:179], v[92:95], v[76:79]
    s_waitcnt lgkmcnt(4)
    v_mul_f32 v115, v115, v53
    v_mul_f32 v40, v40, v112
    v_mfma_f32_16x16x32_bf16 v[56:59], a[180:183], v[116:119], v[56:59]
    ds_read_b128 v[92:95], v1 offset:37888
    v_mul_f32 v41, v41, v113
    v_mfma_f32_16x16x32_bf16 v[60:63], a[184:187], v[116:119], v[60:63]
    v_exp_f32 v115, v115
    v_mfma_f32_16x16x32_bf16 v[64:67], a[188:191], v[116:119], v[64:67]
    s_waitcnt lgkmcnt(4)
    v_cvt_pk_bf16_f32 v6, v40, v41
    v_mul_f32 v52, v52, v54
    v_mfma_f32_16x16x32_bf16 v[68:71], a[180:183], v[120:123], v[68:71]
    ds_read_b128 v[116:119], v1 offset:18432
    buffer_load_dwordx4 v[216:219], v1, s[4:7], s86 offen offset:2048 sc1
    v_mfma_f32_16x16x32_bf16 v[72:75], a[184:187], v[120:123], v[72:75]
    v_fma_f32 v114, v114, v110, v110
    v_fma_f32 v115, v115, v110, v110
    v_mfma_f32_16x16x32_bf16 v[76:79], a[188:191], v[120:123], v[76:79]
    s_waitcnt lgkmcnt(4)
    v_rcp_f32 v114, v114
    v_mfma_f32_16x16x32_bf16 v[56:59], a[192:195], v[80:83], v[56:59]
    ds_read_b128 v[120:123], v1 offset:38912
    v_mul_f32 v53, v53, v55
    v_mfma_f32_16x16x32_bf16 v[60:63], a[196:199], v[80:83], v[60:63]
    v_rcp_f32 v115, v115
    v_mfma_f32_16x16x32_bf16 v[64:67], a[200:203], v[80:83], v[64:67]
    s_waitcnt lgkmcnt(4)
    v_mul_f32 v52, v52, v114
    v_mul_f32 v53, v53, v115
    v_mfma_f32_16x16x32_bf16 v[68:71], a[192:195], v[84:87], v[68:71]
    ds_read_b128 v[80:83], v1 offset:19456
    buffer_load_dwordx4 v[220:223], v1, s[4:7], s86 offen offset:3072 sc1
    v_mfma_f32_16x16x32_bf16 v[72:75], a[196:199], v[84:87], v[72:75]
    v_cvt_pk_bf16_f32 v7, v52, v53
    v_mfma_f32_16x16x32_bf16 v[76:79], a[200:203], v[84:87], v[76:79]
    s_waitcnt lgkmcnt(4)
    v_permlane16_swap_b32 v6, v7
    v_mfma_f32_16x16x32_bf16 v[56:59], a[204:207], v[88:91], v[56:59]
    s_add_u32 s86, s86, 4096
    ds_read_b128 v[84:87], v1 offset:39936
    buffer_load_dwordx4 v[224:227], v1, s[4:7], s86 offen offset:0 sc1
    v_mfma_f32_16x16x32_bf16 v[60:63], a[208:211], v[88:91], v[60:63]
    buffer_store_dwordx2 v[6:7], v21, s[4:7], s82 offen offset:512 sc1
    v_mfma_f32_16x16x32_bf16 v[64:67], a[212:215], v[88:91], v[64:67]
    s_waitcnt lgkmcnt(4)
    buffer_store_dwordx4 v[16:19], v20, s[4:7], s82 offen sc1
    v_mfma_f32_16x16x32_bf16 v[68:71], a[204:207], v[92:95], v[68:71]
    s_waitcnt vmcnt(15)
    s_barrier
    ds_read_b128 v[88:91], v8 offset:0
    s_add_u32 s82, s82, 98304
    v_mfma_f32_16x16x32_bf16 v[72:75], a[208:211], v[92:95], v[72:75]
    ds_read_b128 v[96:99], v14 offset:1024
    v_mfma_f32_16x16x32_bf16 v[76:79], a[212:215], v[92:95], v[76:79]
    s_waitcnt lgkmcnt(5)
    v_mfma_f32_16x16x32_bf16 v[56:59], a[216:219], v[116:119], v[56:59]
    ds_read_b128 v[92:95], v8 offset:20480
    buffer_load_dwordx4 v[228:231], v1, s[4:7], s86 offen offset:1024 sc1
    v_mfma_f32_16x16x32_bf16 v[60:63], a[220:223], v[116:119], v[60:63]
    ds_read_b128 v[100:103], v14 offset:1040
    v_mfma_f32_16x16x32_bf16 v[64:67], a[224:227], v[116:119], v[64:67]
    s_waitcnt lgkmcnt(6)
    v_mfma_f32_16x16x32_bf16 v[68:71], a[216:219], v[120:123], v[68:71]
    ds_read_b128 v[116:119], v8 offset:1024
    buffer_load_dwordx4 v[232:235], v1, s[4:7], s86 offen offset:2048 sc1
    v_mfma_f32_16x16x32_bf16 v[72:75], a[220:223], v[120:123], v[72:75]
    ds_read_b128 v[104:107], v14 offset:1536
    v_mfma_f32_16x16x32_bf16 v[76:79], a[224:227], v[120:123], v[76:79]
    s_waitcnt lgkmcnt(7)
    v_mfma_f32_16x16x32_bf16 v[56:59], a[228:231], v[80:83], v[56:59]
.Lchain2:
.Lisl6:
    s_cbranch_execz .Lisl7
    ds_read_b128 v[120:123], v8 offset:21504
    v_mfma_f32_16x16x32_bf16 v[60:63], a[232:235], v[80:83], v[60:63]
    ds_read_b128 v[108:111], v14 offset:1552
    v_mfma_f32_16x16x32_bf16 v[64:67], a[236:239], v[80:83], v[64:67]
    s_waitcnt lgkmcnt(8)
    v_mfma_f32_16x16x32_bf16 v[68:71], a[228:231], v[84:87], v[68:71]
    ds_read_b128 v[80:83], v8 offset:2048
    buffer_load_dwordx4 v[236:239], v1, s[4:7], s86 offen offset:3072 sc1
    v_mfma_f32_16x16x32_bf16 v[72:75], a[232:235], v[84:87], v[72:75]
    v_mfma_f32_16x16x32_bf16 v[76:79], a[236:239], v[84:87], v[76:79]
    s_waitcnt lgkmcnt(7)
    v_mfma_f32_16x16x32_bf16 v[56:59], v[128:131], v[96:99], v[56:59]
    s_add_u32 s86, s86, 4096
    buffer_load_dwordx4 v[240:243], v1, s[4:7], s86 offen offset:0 sc1
    v_mfma_f32_16x16x32_bf16 v[60:63], v[132:135], v[96:99], v[60:63]
    v_mfma_f32_16x16x32_bf16 v[64:67], v[136:139], v[96:99], v[64:67]
    s_waitcnt lgkmcnt(3)
    v_mfma_f32_16x16x32_bf16 v[68:71], v[128:131], v[104:107], v[68:71]
    v_mfma_f32_16x16x32_bf16 v[72:75], v[132:135], v[104:107], v[72:75]
    v_mfma_f32_16x16x32_bf16 v[76:79], v[136:139], v[104:107], v[76:79]
    v_mfma_f32_16x16x32_bf16 v[32:35], a[0:3], v[88:91], 0
    ds_read_b128 v[84:87], v8 offset:22528
    buffer_load_dwordx4 v[244:247], v1, s[4:7], s86 offen offset:1024 sc1
    v_mfma_f32_16x16x32_bf16 v[36:39], a[4:7], v[88:91], 0
    v_mfma_f32_16x16x32_bf16 v[40:43], a[8:11], v[88:91], 0
    v_mul_f32 v112, v56, v56
    v_mul_f32 v113, v57, v57
    v_mfma_f32_16x16x32_bf16 v[44:47], a[0:3], v[92:95], 0
    ds_read_b128 v[88:91], v8 offset:3072
    v_fma_f32 v112, v112, v101, v100
    v_mfma_f32_16x16x32_bf16 v[48:51], a[4:7], v[92:95], 0
    s_barrier
    v_fma_f32 v113, v113, v101, v100
    v_mfma_f32_16x16x32_bf16 v[52:55], a[8:11], v[92:95], 0
    v_mul_f32 v112, v112, v56
    v_mul_f32 v113, v113, v57
    v_mfma_f32_16x16x32_bf16 v[32:35], a[12:15], v[116:119], v[32:35]
    s_add_u32 s87, s94, 122880
    s_add_u32 m0, s81, 0
    ds_read_b128 v[92:95], v8 offset:23552
    buffer_load_dwordx4 v1, s[4:7], s87 offen offset:0 sc1 lds
    v_mfma_f32_16x16x32_bf16 v[36:39], a[16:19], v[116:119], v[36:39]
    v_exp_f32 v112, v112
    v_mfma_f32_16x16x32_bf16 v[40:43], a[20:23], v[116:119], v[40:43]
    s_waitcnt lgkmcnt(5)
    v_exp_f32 v113, v113
    v_mfma_f32_16x16x32_bf16 v[44:47], a[12:15], v[120:123], v[44:47]
    ds_read_b128 v[116:119], v8 offset:4096
    buffer_load_dwordx4 v1, s[4:7], s87 offen offset:1024 sc1 lds
    v_mfma_f32_16x16x32_bf16 v[48:51], a[16:19], v[120:123], v[48:51]
    v_mul_f32 v56, v56, v58
    v_mul_f32 v114, v68, v68
    v_mfma_f32_16x16x32_bf16 v[52:55], a[20:23], v[120:123], v[52:55]
    s_waitcnt lgkmcnt(4)
    v_fma_f32 v112, v112, v102, v102
    v_mul_f32 v115, v69, v69
    v_mfma_f32_16x16x32_bf16 v[32:35], a[24:27], v[80:83], v[32:35]
    ds_read_b128 v[120:123], v8 offset:24576
    v_fma_f32 v113, v113, v102, v102
    v_mfma_f32_16x16x32_bf16 v[36:39], a[28:31], v[80:83], v[36:39]
    v_rcp_f32 v112, v112
    v_mfma_f32_16x16x32_bf16 v[40:43], a[32:35], v[80:83], v[40:43]
    s_waitcnt lgkmcnt(4)
    v_rcp_f32 v113, v113
    v_mfma_f32_16x16x32_bf16 v[44:47], a[24:27], v[84:87], v[44:47]
    ds_read_b128 v[80:83], v8 offset:5120
    buffer_load_dwordx4 v1, s[4:7], s87 offen offset:2048 sc1 lds
    v_mfma_f32_16x16x32_bf16 v[48:51], a[28:31], v[84:87], v[48:51]
    v_fma_f32 v114, v114, v109, v108
    v_fma_f32 v115, v115, v109, v108
    v_mfma_f32_16x16x32_bf16 v[52:55], a[32:35], v[84:87], v[52:55]
    s_waitcnt lgkmcnt(4)
    v_mul_f32 v114, v114, v68
    v_mul_f32 v57, v57, v59
    v_mfma_f32_16x16x32_bf16 v[32:35], a[36:39], v[88:91], v[32:35]
    ds_read_b128 v[84:87], v8 offset:25600
    buffer_load_dwordx4 v1, s[4:7], s87 offen offset:3072 sc1 lds
    v_mfma_f32_16x16x32_bf16 v[36:39], a[40:43], v[88:91], v[36:39]
    v_exp_f32 v114, v114
    v_mfma_f32_16x16x32_bf16 v[40:43], a[44:47], v[88:91], v[40:43]
    s_waitcnt lgkmcnt(4)
    v_mul_f32 v115, v115, v69
    v_mul_f32 v56, v56, v112
    v_mfma_f32_16x16x32_bf16 v[44:47], a[36:39], v[92:95], v[44:47]
    ds_read_b128 v[88:91], v8 offset:6144
    v_mul_f32 v57, v57, v113
    v_mfma_f32_16x16x32_bf16 v[48:51], a[40:43], v[92:95], v[48:51]
    v_exp_f32 v115, v115
    v_mfma_f32_16x16x32_bf16 v[52:55], a[44:47], v[92:95], v[52:55]
    s_waitcnt lgkmcnt(4)
    v_cvt_pk_bf16_f32 v16, v56, v57
    v_mul_f32 v68, v68, v70
    v_mfma_f32_16x16x32_bf16 v[32:35], a[48:51], v[116:119], v[32:35]
    s_add_u32 s87, s87, 4096
    s_add_u32 m0, m0, 4096
    ds_read_b128 v[92:95], v8 offset:26624
    buffer_load_dwordx4 v1, s[4:7], s87 offen offset:0 sc1 lds
    v_mfma_f32_16x16x32_bf16 v[36:39], a[52:55], v[116:119], v[36:39]
    v_mul_f32 v112, v60, v60
    v_fma_f32 v114, v114, v110, v110
    v_mfma_f32_16x16x32_bf16 v[40:43], a[56:59], v[116:119], v[40:43]
    s_waitcnt lgkmcnt(4)
    v_rcp_f32 v114, v114
    v_mfma_f32_16x16x32_bf16 v[44:47], a[48:51], v[120:123], v[44:47]
    ds_read_b128 v[116:119], v8 offset:7168
    v_mul_f32 v113, v61, v61
    v_mfma_f32_16x16x32_bf16 v[48:51], a[52:55], v[120:123], v[48:51]
    v_fma_f32 v115, v115, v110, v110
    v_fma_f32 v112, v112, v101, v100
    v_mfma_f32_16x16x32_bf16 v[52:55], a[56:59], v[120:123], v[52:55]
    s_waitcnt lgkmcnt(4)
    v_rcp_f32 v115, v115
    v_mfma_f32_16x16x32_bf16 v[32:35], a[60:63], v[80:83], v[32:35]
    ds_read_b128 v[120:123], v8 offset:27648
    buffer_load_dwordx4 v1, s[4:7], s87 offen offset:1024 sc1 lds
    v_mfma_f32_16x16x32_bf16 v[36:39], a[64:67], v[80:83], v[36:39]
    v_fma_f32 v113, v113, v101, v100
    v_mul_f32 v112, v112, v60
    v_mfma_f32_16x16x32_bf16 v[40:43], a[68:71], v[80:83], v[40:43]
    s_waitcnt lgkmcnt(4)
    v_exp_f32 v112, v112
    v_mfma_f32_16x16x32_bf16 v[44:47], a[60:63], v[84:87], v[44:47]
    ds_read_b128 v[80:83], v8 offset:8192
    buffer_load_dwordx4 v1, s[4:7], s87 offen offset:2048 sc1 lds
    v_mfma_f32_16x16x32_bf16 v[48:51], a[64:67], v[84:87], v[48:51]
    v_mul_f32 v69, v69, v71
    v_mul_f32 v113, v113, v61
    v_mfma_f32_16x16x32_bf16 v[52:55], a[68:71], v[84:87], v[52:55]
    s_waitcnt lgkmcnt(4)
    v_exp_f32 v113, v113
    v_mfma_f32_16x16x32_bf16 v[32:35], a[72:75], v[88:91], v[32:35]
    ds_read_b128 v[84:87], v8 offset:28672
    v_mul_f32 v68, v68, v114
    v_mfma_f32_16x16x32_bf16 v[36:39], a[76:79], v[88:91], v[36:39]
    v_mul_f32 v69, v69, v115
    v_cvt_pk_bf16_f32 v18, v68, v69
    v_mfma_f32_16x16x32_bf16 v[40:43], a[80:83], v[88:91], v[40:43]
    s_waitcnt lgkmcnt(4)
    v_mul_f32 v60, v60, v62
    v_mul_f32 v114, v72, v72
    v_mfma_f32_16x16x32_bf16 v[44:47], a[72:75], v[92:95], v[44:47]
    ds_read_b128 v[88:91], v8 offset:9216
    buffer_load_dwordx4 v1, s[4:7], s87 offen offset:3072 sc1 lds
    v_mfma_f32_16x16x32_bf16 v[48:51], a[76:79], v[92:95], v[48:51]
    v_fma_f32 v112, v112, v102, v102
    v_mul_f32 v115, v73, v73
    v_mfma_f32_16x16x32_bf16 v[52:55], a[80:83], v[92:95], v[52:55]
    s_waitcnt lgkmcnt(4)
    v_rcp_f32 v112, v112
    v_mfma_f32_16x16x32_bf16 v[32:35], a[84:87], v[116:119], v[32:35]
    s_add_u32 s87, s87, 4096
    s_add_u32 m0, m0, 4096
    ds_read_b128 v[92:95], v8 offset:29696
    buffer_load_dwordx4 v1, s[4:7], s87 offen offset:0 sc1 lds
    v_mfma_f32_16x16x32_bf16 v[36:39], a[88:91], v[116:119], v[36:39]
    v_fma_f32 v113, v113, v102, v102
    v_fma_f32 v114, v114, v109, v108
    v_mfma_f32_16x16x32_bf16 v[40:43], a[92:95], v[116:119], v[40:43]
    s_waitcnt lgkmcnt(4)
    v_rcp_f32 v113, v113
    v_mfma_f32_16x16x32_bf16 v[44:47], a[84:87], v[120:123], v[44:47]
    ds_read_b128 v[116:119], v8 offset:10240
    v_fma_f32 v115, v115, v109, v108
    v_mfma_f32_16x16x32_bf16 v[48:51], a[88:91], v[120:123], v[48:51]
    v_mul_f32 v114, v114, v72
    v_mul_f32 v61, v61, v63
    v_mfma_f32_16x16x32_bf16 v[52:55], a[92:95], v[120:123], v[52:55]
    s_waitcnt lgkmcnt(4)
    v_exp_f32 v114, v114
    v_mfma_f32_16x16x32_bf16 v[32:35], a[96:99], v[80:83], v[32:35]
    ds_read_b128 v[120:123], v8 offset:30720
    buffer_load_dwordx4 v1, s[4:7], s87 offen offset:1024 sc1 lds
    v_mfma_f32_16x16x32_bf16 v[36:39], a[100:103], v[80:83], v[36:39]
    v_mul_f32 v115, v115, v73
    v_mul_f32 v60, v60, v112
    v_mfma_f32_16x16x32_bf16 v[40:43], a[104:107], v[80:83], v[40:43]
    s_waitcnt lgkmcnt(4)
    v_add_u32 v5, 1, v5
    s_waitcnt vmcnt(15)
    buffer_store_dword v5, v4, s[4:7], s53 offen offset:2048
    buffer_store_dword v5, v0, s[4:7], s53 offen offset:2048 sc1
    v_mfma_f32_16x16x32_bf16 v[44:47], a[96:99], v[84:87], v[44:47]
    ds_read_b128 v[80:83], v8 offset:11264
    v_mul_f32 v61, v61, v113
    v_mfma_f32_16x16x32_bf16 v[48:51], a[100:103], v[84:87], v[48:51]
    v_exp_f32 v115, v115
    v_mfma_f32_16x16x32_bf16 v[52:55], a[104:107], v[84:87], v[52:55]
    s_waitcnt lgkmcnt(4)
    v_cvt_pk_bf16_f32 v17, v60, v61
    v_mul_f32 v72, v72, v74
    v_mfma_f32_16x16x32_bf16 v[32:35], a[108:111], v[88:91], v[32:35]
    ds_read_b128 v[84:87], v8 offset:31744
    buffer_load_dwordx4 v[248:251], v1, s[4:7], s86 offen offset:2048 sc1
    v_mfma_f32_16x16x32_bf16 v[36:39], a[112:115], v[88:91], v[36:39]
    v_mul_f32 v112, v64, v64
    v_fma_f32 v114, v114, v110, v110
    v_mfma_f32_16x16x32_bf16 v[40:43], a[116:119], v[88:91], v[40:43]
    s_waitcnt lgkmcnt(4)
    v_rcp_f32 v114, v114
    v_mfma_f32_16x16x32_bf16 v[44:47], a[108:111], v[92:95], v[44:47]
    ds_read_b128 v[88:91], v8 offset:12288
    buffer_load_dwordx4 v[252:255], v1, s[4:7], s86 offen offset:3072 sc1
    v_mfma_f32_16x16x32_bf16 v[48:51], a[112:115], v[92:95], v[48:51]
    v_mul_f32 v113, v65, v65
    v_fma_f32 v115, v115, v110, v110
    v_mfma_f32_16x16x32_bf16 v[52:55], a[116:119], v[92:95], v[52:55]
    s_waitcnt lgkmcnt(4)
    v_rcp_f32 v115, v115
    v_mfma_f32_16x16x32_bf16 v[32:35], a[120:123], v[116:119], v[32:35]
    ds_read_b128 v[92:95], v8 offset:32768
    v_fma_f32 v112, v112, v101, v100
    v_mfma_f32_16x16x32_bf16 v[36:39], a[124:127], v[116:119], v[36:39]
    v_fma_f32 v113, v113, v101, v100
    v_mul_f32 v112, v112, v64
    v_mfma_f32_16x16x32_bf16 v[40:43], a[128:131], v[116:119], v[40:43]
    s_waitcnt lgkmcnt(4)
    v_exp_f32 v112, v112
    v_mfma_f32_16x16x32_bf16 v[44:47], a[120:123], v[120:123], v[44:47]
    s_add_u32 s86, s86, 4096
    ds_read_b128 v[116:119], v8 offset:13312
    buffer_load_dwordx4 a[240:243], v1, s[4:7], s86 offen offset:0 sc1
    v_mfma_f32_16x16x32_bf16 v[48:51], a[124:127], v[120:123], v[48:51]
    v_mul_f32 v73, v73, v75
    v_mul_f32 v113, v113, v65
    v_mfma_f32_16x16x32_bf16 v[52:55], a[128:131], v[120:123], v[52:55]
    s_waitcnt lgkmcnt(4)
    v_exp_f32 v113, v113
    v_mfma_f32_16x16x32_bf16 v[32:35], a[132:135], v[80:83], v[32:35]
    ds_read_b128 v[120:123], v8 offset:33792
    buffer_load_dwordx4 a[244:247], v1, s[4:7], s86 offen offset:1024 sc1
    v_mfma_f32_16x16x32_bf16 v[36:39], a[136:139], v[80:83], v[36:39]
    v_mul_f32 v72, v72, v114
    v_mul_f32 v73, v73, v115
    v_mfma_f32_16x16x32_bf16 v[40:43], a[140:143], v[80:83], v[40:43]
    s_waitcnt lgkmcnt(4)
    v_cvt_pk_bf16_f32 v19, v72, v73
    v_mul_f32 v64, v64, v66
    v_mfma_f32_16x16x32_bf16 v[44:47], a[132:135], v[84:87], v[44:47]
    ds_read_b128 v[80:83], v8 offset:14336
    v_mul_f32 v114, v76, v76
    v_mfma_f32_16x16x32_bf16 v[48:51], a[136:139], v[84:87], v[48:51]
    v_fma_f32 v112, v112, v102, v102
    v_mul_f32 v115, v77, v77
    v_mfma_f32_16x16x32_bf16 v[52:55], a[140:143], v[84:87], v[52:55]
    s_waitcnt lgkmcnt(4)
    v_rcp_f32 v112, v112
    v_mfma_f32_16x16x32_bf16 v[32:35], a[144:147], v[88:91], v[32:35]
    ds_read_b128 v[84:87], v8 offset:34816
    buffer_load_dwordx4 a[248:251], v1, s[4:7], s86 offen offset:2048 sc1
    v_mfma_f32_16x16x32_bf16 v[36:39], a[148:151], v[88:91], v[36:39]
    v_permlane32_swap_b32 v16, v18
    v_mfma_f32_16x16x32_bf16 v[40:43], a[152:155], v[88:91], v[40:43]
    s_waitcnt lgkmcnt(4)
    v_permlane32_swap_b32 v17, v19
    v_mfma_f32_16x16x32_bf16 v[44:47], a[144:147], v[92:95], v[44:47]
    ds_read_b128 v[88:91], v8 offset:15360
    v_fma_f32 v113, v113, v102, v102
    v_mfma_f32_16x16x32_bf16 v[48:51], a[148:151], v[92:95], v[48:51]
    v_rcp_f32 v113, v113
    v_mfma_f32_16x16x32_bf16 v[52:55], a[152:155], v[92:95], v[52:55]
    s_waitcnt lgkmcnt(4)
    v_permlane16_swap_b32 v16, v17
    v_mfma_f32_16x16x32_bf16 v[32:35], a[156:159], v[116:119], v[32:35]
    ds_read_b128 v[92:95], v8 offset:35840
    buffer_load_dwordx4 a[252:255], v1, s[4:7], s86 offen offset:3072 sc1
    v_mfma_f32_16x16x32_bf16 v[36:39], a[160:163], v[116:119], v[36:39]
    v_permlane16_swap_b32 v18, v19
    v_mfma_f32_16x16x32_bf16 v[40:43], a[164:167], v[116:119], v[40:43]
    s_waitcnt lgkmcnt(4)
    v_fma_f32 v114, v114, v109, v108
    v_fma_f32 v115, v115, v109, v108
    v_mfma_f32_16x16x32_bf16 v[44:47], a[156:159], v[120:123], v[44:47]
    s_add_u32 s86, s86, 4096
    ds_read_b128 v[116:119], v8 offset:16384
    buffer_load_dwordx4 v[124:127], v1, s[4:7], s86 offen offset:0 sc1
    v_mfma_f32_16x16x32_bf16 v[48:51], a[160:163], v[120:123], v[48:51]
    v_mul_f32 v114, v114, v76
    v_mul_f32 v65, v65, v67
    v_mfma_f32_16x16x32_bf16 v[52:55], a[164:167], v[120:123], v[52:55]
    s_waitcnt lgkmcnt(4)
    v_exp_f32 v114, v114
    v_mfma_f32_16x16x32_bf16 v[32:35], a[168:171], v[80:83], v[32:35]
    ds_read_b128 v[120:123], v8 offset:36864
    v_mul_f32 v115, v115, v77
    v_mfma_f32_16x16x32_bf16 v[36:39], a[172:175], v[80:83], v[36:39]
    v_exp_f32 v115, v115
    v_mfma_f32_16x16x32_bf16 v[40:43], a[176:179], v[80:83], v[40:43]
    s_waitcnt lgkmcnt(4)
    v_mul_f32 v64, v64, v112
    v_mul_f32 v65, v65, v113
    v_mfma_f32_16x16x32_bf16 v[44:47], a[168:171], v[84:87], v[44:47]
    ds_read_b128 v[80:83], v8 offset:17408
    buffer_load_dwordx4 v[140:143], v1, s[4:7], s86 offen offset:1024 sc1
    v_mfma_f32_16x16x32_bf16 v[48:51], a[172:175], v[84:87], v[48:51]
    v_cvt_pk_bf16_f32 v6, v64, v65
    v_mul_f32 v76, v76, v78
    v_mfma_f32_16x16x32_bf16 v[52:55], a[176:179], v[84:87], v[52:55]
    s_waitcnt lgkmcnt(4)
    v_fma_f32 v114, v114, v110, v110
    v_fma_f32 v115, v115, v110, v110
    v_mfma_f32_16x16x32_bf16 v[32:35], a[180:183], v[88:91], v[32:35]
    ds_read_b128 v[84:87], v8 offset:37888
    buffer_load_dwordx4 v[144:147], v1, s[4:7], s86 offen offset:2048 sc1
    v_mfma_f32_16x16x32_bf16 v[36:39], a[184:187], v[88:91], v[36:39]
    v_rcp_f32 v114, v114
    v_mfma_f32_16x16x32_bf16 v[40:43], a[188:191], v[88:91], v[40:43]
    s_waitcnt lgkmcnt(4)
    v_rcp_f32 v115, v115
    v_mfma_f32_16x16x32_bf16 v[44:47], a[180:183], v[92:95], v[44:47]
    ds_read_b128 v[88:91], v8 offset:18432
    v_mul_f32 v77, v77, v79
    v_mfma_f32_16x16x32_bf16 v[48:51], a[184:187], v[92:95], v[48:51]
    v_mul_f32 v76, v76, v114
    v_mul_f32 v77, v77, v115
    v_mfma_f32_16x16x32_bf16 v[52:55], a[188:191], v[92:95], v[52:55]
    s_waitcnt lgkmcnt(4)
    v_cvt_pk_bf16_f32 v7, v76, v77
    v_mfma_f32_16x16x32_bf16 v[32:35], a[192:195], v[116:119], v[32:35]
    ds_read_b128 v[92:95], v8 offset:38912
    buffer_load_dwordx4 v[148:151], v1, s[4:7], s86 offen offset:3072 sc1
    v_mfma_f32_16x16x32_bf16 v[36:39], a[196:199], v[116:119], v[36:39]
    v_permlane16_swap_b32 v6, v7
    v_mfma_f32_16x16x32_bf16 v[40:43], a[200:203], v[116:119], v[40:43]
    s_waitcnt lgkmcnt(4)
    buffer_store_dwordx2 v[6:7], v21, s[4:7], s82 offen offset:512 sc1
    v_mfma_f32_16x16x32_bf16 v[44:47], a[192:195], v[120:123], v[44:47]
    ds_read_b128 v[116:119], v8 offset:19456
    v_mfma_f32_16x16x32_bf16 v[48:51], a[196:199], v[120:123], v[48:51]
    buffer_store_dwordx4 v[16:19], v20, s[4:7], s82 offen sc1
    v_mfma_f32_16x16x32_bf16 v[52:55], a[200:203], v[120:123], v[52:55]
    s_waitcnt lgkmcnt(4)
    s_add_u32 s82, s82, 98304
    v_mfma_f32_16x16x32_bf16 v[32:35], a[204:207], v[80:83], v[32:35]
    s_add_u32 s86, s86, 4096
    s_add_u32 m0, s95, 40960
    ds_read_b128 v[120:123], v8 offset:39936
    buffer_load_dwordx4 v1, s[4:7], s86 offen offset:0 sc1 lds
    v_mfma_f32_16x16x32_bf16 v[36:39], a[208:211], v[80:83], v[36:39]
    v_mfma_f32_16x16x32_bf16 v[40:43], a[212:215], v[80:83], v[40:43]
    s_waitcnt lgkmcnt(4)
    v_mfma_f32_16x16x32_bf16 v[44:47], a[204:207], v[84:87], v[44:47]
    s_waitcnt vmcnt(15)
    s_barrier
    ds_read_b128 v[80:83], v1 offset:0
    buffer_load_dwordx4 v1, s[4:7], s86 offen offset:1024 sc1 lds
    v_mfma_f32_16x16x32_bf16 v[48:51], a[208:211], v[84:87], v[48:51]
    ds_read_b128 v[96:99], v14 offset:2048
    v_mfma_f32_16x16x32_bf16 v[52:55], a[212:215], v[84:87], v[52:55]
    s_waitcnt lgkmcnt(5)
    v_mfma_f32_16x16x32_bf16 v[32:35], a[216:219], v[88:91], v[32:35]
    ds_read_b128 v[84:87], v1 offset:20480
    v_mfma_f32_16x16x32_bf16 v[36:39], a[220:223], v[88:91], v[36:39]
    ds_read_b128 v[100:103], v14 offset:2064
    v_mfma_f32_16x16x32_bf16 v[40:43], a[224:227], v[88:91], v[40:43]
    s_waitcnt lgkmcnt(6)
    v_mfma_f32_16x16x32_bf16 v[44:47], a[216:219], v[92:95], v[44:47]
    ds_read_b128 v[88:91], v1 offset:1024
    buffer_load_dwordx4 v1, s[4:7], s86 offen offset:2048 sc1 lds
    v_mfma_f32_16x16x32_bf16 v[48:51], a[220:223], v[92:95], v[48:51]
    ds_read_b128 v[104:107], v14 offset:2560
    v_mfma_f32_16x16x32_bf16 v[52:55], a[224:227], v[92:95], v[52:55]
    s_waitcnt lgkmcnt(7)
    v_mfma_f32_16x16x32_bf16 v[32:35], a[228:231], v[116:119], v[32:35]
    ds_read_b128 v[92:95], v1 offset:21504
    buffer_load_dwordx4 v1, s[4:7], s86 offen offset:3072 sc1 lds
    v_mfma_f32_16x16x32_bf16 v[36:39], a[232:235], v[116:119], v[36:39]
    ds_read_b128 v[108:111], v14 offset:2576
    v_mfma_f32_16x16x32_bf16 v[40:43], a[236:239], v[116:119], v[40:43]
    s_waitcnt lgkmcnt(8)
    v_mfma_f32_16x16x32_bf16 v[44:47], a[228:231], v[120:123], v[44:47]
    ds_read_b128 v[116:119], v1 offset:2048
    v_mfma_f32_16x16x32_bf16 v[48:51], a[232:235], v[120:123], v[48:51]
    v_mfma_f32_16x16x32_bf16 v[52:55], a[236:239], v[120:123], v[52:55]
    s_waitcnt lgkmcnt(7)
    v_mfma_f32_16x16x32_bf16 v[32:35], v[128:131], v[96:99], v[32:35]
    s_add_u32 s86, s86, 4096
    s_add_u32 m0, s95, 45056
    s_nop 0
    buffer_load_dwordx4 v1, s[4:7], s86 offen offset:0 sc1 lds
    v_mfma_f32_16x16x32_bf16 v[36:39], v[132:135], v[96:99], v[36:39]
    v_mfma_f32_16x16x32_bf16 v[40:43], v[136:139], v[96:99], v[40:43]
    s_waitcnt lgkmcnt(3)
    v_mfma_f32_16x16x32_bf16 v[44:47], v[128:131], v[104:107], v[44:47]
    v_mfma_f32_16x16x32_bf16 v[48:51], v[132:135], v[104:107], v[48:51]
    v_mfma_f32_16x16x32_bf16 v[52:55], v[136:139], v[104:107], v[52:55]
    v_mfma_f32_16x16x32_bf16 v[56:59], a[0:3], v[80:83], 0
    ds_read_b128 v[120:123], v1 offset:22528
    buffer_load_dwordx4 v1, s[4:7], s86 offen offset:1024 sc1 lds
    v_mfma_f32_16x16x32_bf16 v[60:63], a[4:7], v[80:83], 0
    v_mfma_f32_16x16x32_bf16 v[64:67], a[8:11], v[80:83], 0
    v_mul_f32 v112, v32, v32
    v_mul_f32 v113, v33, v33
    v_mfma_f32_16x16x32_bf16 v[68:71], a[0:3], v[84:87], 0
    ds_read_b128 v[80:83], v1 offset:3072
    buffer_load_dwordx4 v1, s[4:7], s86 offen offset:2048 sc1 lds
    v_mfma_f32_16x16x32_bf16 v[72:75], a[4:7], v[84:87], 0
    v_fma_f32 v112, v112, v101, v100
    v_fma_f32 v113, v113, v101, v100
    v_mfma_f32_16x16x32_bf16 v[76:79], a[8:11], v[84:87], 0
    v_mul_f32 v112, v112, v32
    v_mul_f32 v113, v113, v33
    v_mfma_f32_16x16x32_bf16 v[56:59], a[12:15], v[88:91], v[56:59]
    ds_read_b128 v[84:87], v1 offset:23552
    v_mul_f32 v32, v32, v34
    v_mfma_f32_16x16x32_bf16 v[60:63], a[16:19], v[88:91], v[60:63]
    v_exp_f32 v112, v112
    v_mfma_f32_16x16x32_bf16 v[64:67], a[20:23], v[88:91], v[64:67]
    s_waitcnt lgkmcnt(5)
    buffer_load_dword v12, v13, s[4:7], s74 offen sc1
    v_mul_f32 v114, v44, v44
    v_mfma_f32_16x16x32_bf16 v[68:71], a[12:15], v[92:95], v[68:71]
    ds_read_b128 v[88:91], v1 offset:4096
    buffer_load_dwordx4 v1, s[4:7], s86 offen offset:3072 sc1 lds
    v_mfma_f32_16x16x32_bf16 v[72:75], a[16:19], v[92:95], v[72:75]
    v_exp_f32 v113, v113
    v_mfma_f32_16x16x32_bf16 v[76:79], a[20:23], v[92:95], v[76:79]
    s_waitcnt lgkmcnt(4)
    v_fma_f32 v112, v112, v102, v102
    v_mul_f32 v115, v45, v45
    v_mfma_f32_16x16x32_bf16 v[56:59], a[24:27], v[116:119], v[56:59]
    ds_read_b128 v[92:95], v1 offset:24576
    v_fma_f32 v113, v113, v102, v102
    v_mfma_f32_16x16x32_bf16 v[60:63], a[28:31], v[116:119], v[60:63]
    v_rcp_f32 v112, v112
    v_mfma_f32_16x16x32_bf16 v[64:67], a[32:35], v[116:119], v[64:67]
    s_waitcnt lgkmcnt(4)
    v_rcp_f32 v113, v113
    v_mfma_f32_16x16x32_bf16 v[68:71], a[24:27], v[120:123], v[68:71]
    ds_read_b128 v[116:119], v1 offset:5120
    v_fma_f32 v114, v114, v109, v108
    v_mfma_f32_16x16x32_bf16 v[72:75], a[28:31], v[120:123], v[72:75]
    v_fma_f32 v115, v115, v109, v108
    v_mul_f32 v114, v114, v44
    v_mfma_f32_16x16x32_bf16 v[76:79], a[32:35], v[120:123], v[76:79]
    s_waitcnt lgkmcnt(4)
    v_exp_f32 v114, v114
    v_mfma_f32_16x16x32_bf16 v[56:59], a[36:39], v[80:83], v[56:59]
    s_add_u32 s86, s86, 4096
    ds_read_b128 v[120:123], v1 offset:25600
    buffer_load_dwordx4 a[0:3], v1, s[4:7], s86 offen offset:0 sc1
    v_mfma_f32_16x16x32_bf16 v[60:63], a[40:43], v[80:83], v[60:63]
    v_mul_f32 v33, v33, v35
    v_mul_f32 v115, v115, v45
    v_mfma_f32_16x16x32_bf16 v[64:67], a[44:47], v[80:83], v[64:67]
    s_waitcnt lgkmcnt(4)
    v_exp_f32 v115, v115
    v_mfma_f32_16x16x32_bf16 v[68:71], a[36:39], v[84:87], v[68:71]
    ds_read_b128 v[80:83], v1 offset:6144
    buffer_load_dwordx4 a[4:7], v1, s[4:7], s86 offen offset:1024 sc1
    v_mfma_f32_16x16x32_bf16 v[72:75], a[40:43], v[84:87], v[72:75]
    v_mul_f32 v32, v32, v112
    v_mul_f32 v33, v33, v113
    v_mfma_f32_16x16x32_bf16 v[76:79], a[44:47], v[84:87], v[76:79]
    s_waitcnt lgkmcnt(4)
    v_cvt_pk_bf16_f32 v16, v32, v33
    v_mul_f32 v44, v44, v46
    v_mfma_f32_16x16x32_bf16 v[56:59], a[48:51], v[88:91], v[56:59]
    ds_read_b128 v[84:87], v1 offset:26624
    v_mul_f32 v112, v36, v36
    v_mfma_f32_16x16x32_bf16 v[60:63], a[52:55], v[88:91], v[60:63]
    v_fma_f32 v114, v114, v110, v110
    v_mul_f32 v113, v37, v37
    v_mfma_f32_16x16x32_bf16 v[64:67], a[56:59], v[88:91], v[64:67]
    s_waitcnt lgkmcnt(4)
    v_rcp_f32 v114, v114
    v_mfma_f32_16x16x32_bf16 v[68:71], a[48:51], v[92:95], v[68:71]
    ds_read_b128 v[88:91], v1 offset:7168
    buffer_load_dwordx4 a[8:11], v1, s[4:7], s86 offen offset:2048 sc1
    v_mfma_f32_16x16x32_bf16 v[72:75], a[52:55], v[92:95], v[72:75]
    v_fma_f32 v115, v115, v110, v110
    v_fma_f32 v112, v112, v101, v100
    v_mfma_f32_16x16x32_bf16 v[76:79], a[56:59], v[92:95], v[76:79]
    s_waitcnt lgkmcnt(4)
    v_rcp_f32 v115, v115
    v_mfma_f32_16x16x32_bf16 v[56:59], a[60:63], v[116:119], v[56:59]
    ds_read_b128 v[92:95], v1 offset:27648
    buffer_load_dwordx4 a[12:15], v1, s[4:7], s86 offen offset:3072 sc1
    v_mfma_f32_16x16x32_bf16 v[60:63], a[64:67], v[116:119], v[60:63]
    v_fma_f32 v113, v113, v101, v100
    v_mul_f32 v112, v112, v36
    v_mfma_f32_16x16x32_bf16 v[64:67], a[68:71], v[116:119], v[64:67]
    s_waitcnt lgkmcnt(4)
    v_exp_f32 v112, v112
    v_mfma_f32_16x16x32_bf16 v[68:71], a[60:63], v[120:123], v[68:71]
    ds_read_b128 v[116:119], v1 offset:8192
    v_mul_f32 v45, v45, v47
    v_mfma_f32_16x16x32_bf16 v[72:75], a[64:67], v[120:123], v[72:75]
    v_mul_f32 v113, v113, v37
    v_mul_f32 v44, v44, v114
    v_mfma_f32_16x16x32_bf16 v[76:79], a[68:71], v[120:123], v[76:79]
    s_waitcnt lgkmcnt(4)
    v_exp_f32 v113, v113
    v_mfma_f32_16x16x32_bf16 v[56:59], a[72:75], v[80:83], v[56:59]
    s_add_u32 s86, s86, 4096
    ds_read_b128 v[120:123], v1 offset:28672
    buffer_load_dwordx4 a[16:19], v1, s[4:7], s86 offen offset:0 sc1
    v_mfma_f32_16x16x32_bf16 v[60:63], a[76:79], v[80:83], v[60:63]
    v_mul_f32 v45, v45, v115
    v_cvt_pk_bf16_f32 v18, v44, v45
    v_mfma_f32_16x16x32_bf16 v[64:67], a[80:83], v[80:83], v[64:67]
    s_waitcnt lgkmcnt(4)
    v_mul_f32 v36, v36, v38
    v_mul_f32 v114, v48, v48
    v_mfma_f32_16x16x32_bf16 v[68:71], a[72:75], v[84:87], v[68:71]
    ds_read_b128 v[80:83], v1 offset:9216
    v_fma_f32 v112, v112, v102, v102
    v_mfma_f32_16x16x32_bf16 v[72:75], a[76:79], v[84:87], v[72:75]
    v_rcp_f32 v112, v112
    v_mfma_f32_16x16x32_bf16 v[76:79], a[80:83], v[84:87], v[76:79]
    s_waitcnt lgkmcnt(4)
    v_mul_f32 v115, v49, v49
    v_fma_f32 v113, v113, v102, v102
    v_mfma_f32_16x16x32_bf16 v[56:59], a[84:87], v[88:91], v[56:59]
    ds_read_b128 v[84:87], v1 offset:29696
    buffer_load_dwordx4 a[20:23], v1, s[4:7], s86 offen offset:1024 sc1
    v_mfma_f32_16x16x32_bf16 v[60:63], a[88:91], v[88:91], v[60:63]
    v_rcp_f32 v113, v113
    v_mfma_f32_16x16x32_bf16 v[64:67], a[92:95], v[88:91], v[64:67]
    s_waitcnt lgkmcnt(4)
    v_fma_f32 v114, v114, v109, v108
    v_fma_f32 v115, v115, v109, v108
    v_mfma_f32_16x16x32_bf16 v[68:71], a[84:87], v[92:95], v[68:71]
    ds_read_b128 v[88:91], v1 offset:10240
    buffer_load_dwordx4 a[24:27], v1, s[4:7], s86 offen offset:2048 sc1
    v_mfma_f32_16x16x32_bf16 v[72:75], a[88:91], v[92:95], v[72:75]
    v_mul_f32 v114, v114, v48
    v_mul_f32 v37, v37, v39
    v_mfma_f32_16x16x32_bf16 v[76:79], a[92:95], v[92:95], v[76:79]
    s_waitcnt lgkmcnt(4)
    v_exp_f32 v114, v114
    v_mfma_f32_16x16x32_bf16 v[56:59], a[96:99], v[116:119], v[56:59]
    ds_read_b128 v[92:95], v1 offset:30720
    v_mul_f32 v115, v115, v49
    v_mfma_f32_16x16x32_bf16 v[60:63], a[100:103], v[116:119], v[60:63]
    v_exp_f32 v115, v115
    v_mfma_f32_16x16x32_bf16 v[64:67], a[104:107], v[116:119], v[64:67]
    s_waitcnt lgkmcnt(4)
    v_add_u32 v5, 1, v5
    s_waitcnt vmcnt(16)
    buffer_store_dword v5, v4, s[4:7], s53 offen offset:2048
    buffer_store_dword v5, v0, s[4:7], s53 offen offset:2048 sc1
    v_mfma_f32_16x16x32_bf16 v[68:71], a[96:99], v[120:123], v[68:71]
    ds_read_b128 v[116:119], v1 offset:11264
    buffer_load_dwordx4 a[28:31], v1, s[4:7], s86 offen offset:3072 sc1
    v_mfma_f32_16x16x32_bf16 v[72:75], a[100:103], v[120:123], v[72:75]
    v_mul_f32 v36, v36, v112
    v_mul_f32 v37, v37, v113
    v_mfma_f32_16x16x32_bf16 v[76:79], a[104:107], v[120:123], v[76:79]
    s_waitcnt lgkmcnt(4)
    v_cvt_pk_bf16_f32 v17, v36, v37
    v_mul_f32 v48, v48, v50
    v_mfma_f32_16x16x32_bf16 v[56:59], a[108:111], v[80:83], v[56:59]
    ds_read_b128 v[120:123], v1 offset:31744
    v_mul_f32 v112, v40, v40
    v_mfma_f32_16x16x32_bf16 v[60:63], a[112:115], v[80:83], v[60:63]
    v_fma_f32 v114, v114, v110, v110
    v_mul_f32 v113, v41, v41
    v_mfma_f32_16x16x32_bf16 v[64:67], a[116:119], v[80:83], v[64:67]
    s_waitcnt lgkmcnt(4)
    v_rcp_f32 v114, v114
    v_mfma_f32_16x16x32_bf16 v[68:71], a[108:111], v[84:87], v[68:71]
    s_waitcnt vmcnt(10)
    ds_read_b128 v[80:83], v1 offset:12288
    ds_read_b128 a[32:35], v9 offset:0
    v_mfma_f32_16x16x32_bf16 v[72:75], a[112:115], v[84:87], v[72:75]
    v_fma_f32 v115, v115, v110, v110
    v_fma_f32 v112, v112, v101, v100
    v_mfma_f32_16x16x32_bf16 v[76:79], a[116:119], v[84:87], v[76:79]
    s_waitcnt lgkmcnt(5)
    v_rcp_f32 v115, v115
    v_mfma_f32_16x16x32_bf16 v[56:59], a[120:123], v[88:91], v[56:59]
    ds_read_b128 v[84:87], v1 offset:32768
    ds_read_b128 a[36:39], v9 offset:1024
    v_mfma_f32_16x16x32_bf16 v[60:63], a[124:127], v[88:91], v[60:63]
    v_fma_f32 v113, v113, v101, v100
    v_mul_f32 v112, v112, v40
    v_mfma_f32_16x16x32_bf16 v[64:67], a[128:131], v[88:91], v[64:67]
    s_waitcnt lgkmcnt(6)
    v_exp_f32 v112, v112
    v_mfma_f32_16x16x32_bf16 v[68:71], a[120:123], v[92:95], v[68:71]
    ds_read_b128 v[88:91], v1 offset:13312
    ds_read_b128 a[40:43], v9 offset:2048
    v_mfma_f32_16x16x32_bf16 v[72:75], a[124:127], v[92:95], v[72:75]
    v_mul_f32 v49, v49, v51
    v_mul_f32 v113, v113, v41
    v_mfma_f32_16x16x32_bf16 v[76:79], a[128:131], v[92:95], v[76:79]
    s_waitcnt lgkmcnt(7)
    v_exp_f32 v113, v113
    v_mfma_f32_16x16x32_bf16 v[56:59], a[132:135], v[116:119], v[56:59]
    ds_read_b128 v[92:95], v1 offset:33792
    ds_read_b128 a[44:47], v9 offset:3072
    v_mfma_f32_16x16x32_bf16 v[60:63], a[136:139], v[116:119], v[60:63]
    v_mul_f32 v48, v48, v114
    v_mul_f32 v49, v49, v115
    v_mfma_f32_16x16x32_bf16 v[64:67], a[140:143], v[116:119], v[64:67]
    s_waitcnt lgkmcnt(8)
    v_cvt_pk_bf16_f32 v19, v48, v49
    v_mul_f32 v40, v40, v42
    v_mfma_f32_16x16x32_bf16 v[68:71], a[132:135], v[120:123], v[68:71]
    ds_read_b128 v[116:119], v1 offset:14336
    ds_read_b128 a[48:51], v9 offset:4096
    v_mfma_f32_16x16x32_bf16 v[72:75], a[136:139], v[120:123], v[72:75]
    v_mul_f32 v114, v52, v52
    v_fma_f32 v112, v112, v102, v102
    v_mfma_f32_16x16x32_bf16 v[76:79], a[140:143], v[120:123], v[76:79]
    s_waitcnt lgkmcnt(9)
    v_rcp_f32 v112, v112
    v_mfma_f32_16x16x32_bf16 v[56:59], a[144:147], v[80:83], v[56:59]
    ds_read_b128 v[120:123], v1 offset:34816
    ds_read_b128 a[52:55], v9 offset:5120
    v_mfma_f32_16x16x32_bf16 v[60:63], a[148:151], v[80:83], v[60:63]
    v_permlane32_swap_b32 v16, v18
    v_mfma_f32_16x16x32_bf16 v[64:67], a[152:155], v[80:83], v[64:67]
    s_waitcnt lgkmcnt(9)
    v_permlane32_swap_b32 v17, v19
    v_mfma_f32_16x16x32_bf16 v[68:71], a[144:147], v[84:87], v[68:71]
.Lisl7:
    s_cbranch_execz .Lisl8
    ds_read_b128 v[80:83], v1 offset:15360
    ds_read_b128 a[56:59], v9 offset:6144
    v_mfma_f32_16x16x32_bf16 v[72:75], a[148:151], v[84:87], v[72:75]
    v_permlane16_swap_b32 v16, v17
    v_mfma_f32_16x16x32_bf16 v[76:79], a[152:155], v[84:87], v[76:79]
    s_waitcnt lgkmcnt(9)
    s_add_u32 s75, s42, 1
    v_subrev_u32 v12, s75, v12
    v_cmp_lt_u32 vcc, 6, v12
    s_nop 0
    s_cmp_lg_u64 vcc, 0
    s_cbranch_scc1 .Lrcs_24
.Lrcb_23:
    v_mfma_f32_16x16x32_bf16 v[56:59], a[156:159], v[88:91], v[56:59]
    ds_read_b128 v[84:87], v1 offset:35840
    v_mul_f32 v115, v53, v53
    v_mfma_f32_16x16x32_bf16 v[60:63], a[160:163], v[88:91], v[60:63]
    v_permlane16_swap_b32 v18, v19
    v_mfma_f32_16x16x32_bf16 v[64:67], a[164:167], v[88:91], v[64:67]
    s_waitcnt lgkmcnt(8)
    v_fma_f32 v113, v113, v102, v102
    v_fma_f32 v114, v114, v109, v108
    v_mfma_f32_16x16x32_bf16 v[68:71], a[156:159], v[92:95], v[68:71]
    ds_read_b128 v[88:91], v1 offset:16384
    buffer_load_dwordx4 a[104:107], v1, s[4:7], s60 offen offset:0 sc1
    v_mfma_f32_16x16x32_bf16 v[72:75], a[160:163], v[92:95], v[72:75]
    v_rcp_f32 v113, v113
    v_mfma_f32_16x16x32_bf16 v[76:79], a[164:167], v[92:95], v[76:79]
    s_waitcnt lgkmcnt(7)
    v_fma_f32 v115, v115, v109, v108
    v_mul_f32 v114, v114, v52
    v_mfma_f32_16x16x32_bf16 v[56:59], a[168:171], v[116:119], v[56:59]
    ds_read_b128 v[92:95], v1 offset:36864
    buffer_load_dwordx4 a[108:111], v1, s[4:7], s60 offen offset:1024 sc1
    v_mfma_f32_16x16x32_bf16 v[60:63], a[172:175], v[116:119], v[60:63]
    v_exp_f32 v114, v114
    v_mfma_f32_16x16x32_bf16 v[64:67], a[176:179], v[116:119], v[64:67]
    s_waitcnt lgkmcnt(6)
    v_mul_f32 v41, v41, v43
    v_mul_f32 v115, v115, v53
    v_mfma_f32_16x16x32_bf16 v[68:71], a[168:171], v[120:123], v[68:71]
    ds_read_b128 v[116:119], v1 offset:17408
    v_mul_f32 v40, v40, v112
    v_mfma_f32_16x16x32_bf16 v[72:75], a[172:175], v[120:123], v[72:75]
    ds_read_b128 a[60:63], v9 offset:7168
    v_mul_f32 v41, v41, v113
    v_mfma_f32_16x16x32_bf16 v[76:79], a[176:179], v[120:123], v[76:79]
    s_waitcnt lgkmcnt(6)
    v_exp_f32 v115, v115
    v_mfma_f32_16x16x32_bf16 v[56:59], a[180:183], v[80:83], v[56:59]
    ds_read_b128 v[120:123], v1 offset:37888
    buffer_load_dwordx4 a[112:115], v1, s[4:7], s60 offen offset:2048 sc1
    v_mfma_f32_16x16x32_bf16 v[60:63], a[184:187], v[80:83], v[60:63]
    ds_read_b128 a[64:67], v9 offset:8192
    v_cvt_pk_bf16_f32 v6, v40, v41
    v_mfma_f32_16x16x32_bf16 v[64:67], a[188:191], v[80:83], v[64:67]
    s_waitcnt lgkmcnt(6)
    v_mul_f32 v52, v52, v54
    v_fma_f32 v114, v114, v110, v110
    v_mfma_f32_16x16x32_bf16 v[68:71], a[180:183], v[84:87], v[68:71]
    ds_read_b128 v[80:83], v1 offset:18432
    buffer_load_dwordx4 a[116:119], v1, s[4:7], s60 offen offset:3072 sc1
    v_mfma_f32_16x16x32_bf16 v[72:75], a[184:187], v[84:87], v[72:75]
    ds_read_b128 a[68:71], v9 offset:9216
    v_fma_f32 v115, v115, v110, v110
    v_mfma_f32_16x16x32_bf16 v[76:79], a[188:191], v[84:87], v[76:79]
    s_waitcnt lgkmcnt(7)
    v_rcp_f32 v114, v114
    v_mfma_f32_16x16x32_bf16 v[56:59], a[192:195], v[88:91], v[56:59]
    ds_read_b128 v[84:87], v1 offset:38912
    v_mul_f32 v53, v53, v55
    v_mfma_f32_16x16x32_bf16 v[60:63], a[196:199], v[88:91], v[60:63]
    ds_read_b128 a[72:75], v10 offset:40960
    v_mul_f32 v52, v52, v114
    v_mfma_f32_16x16x32_bf16 v[64:67], a[200:203], v[88:91], v[64:67]
    s_waitcnt lgkmcnt(8)
    v_rcp_f32 v115, v115
    v_mfma_f32_16x16x32_bf16 v[68:71], a[192:195], v[92:95], v[68:71]
    s_add_u32 s60, s60, 4096
    ds_read_b128 v[88:91], v1 offset:19456
    buffer_load_dwordx4 a[120:123], v1, s[4:7], s60 offen offset:0 sc1
    v_mfma_f32_16x16x32_bf16 v[72:75], a[196:199], v[92:95], v[72:75]
    ds_read_b128 a[76:79], v10 offset:41984
    v_mul_f32 v53, v53, v115
    v_mfma_f32_16x16x32_bf16 v[76:79], a[200:203], v[92:95], v[76:79]
    s_waitcnt lgkmcnt(9)
    v_cvt_pk_bf16_f32 v7, v52, v53
    v_mfma_f32_16x16x32_bf16 v[56:59], a[204:207], v[116:119], v[56:59]
    ds_read_b128 v[92:95], v1 offset:39936
    buffer_load_dwordx4 a[124:127], v1, s[4:7], s60 offen offset:1024 sc1
    v_mfma_f32_16x16x32_bf16 v[60:63], a[208:211], v[116:119], v[60:63]
    ds_read_b128 a[80:83], v10 offset:43008
    v_mfma_f32_16x16x32_bf16 v[64:67], a[212:215], v[116:119], v[64:67]
    s_waitcnt lgkmcnt(9)
    buffer_load_dword v12, v13, s[4:7], s74 offen sc1
    v_mfma_f32_16x16x32_bf16 v[68:71], a[204:207], v[120:123], v[68:71]
    v_permlane16_swap_b32 v6, v7
    buffer_store_dwordx2 v[6:7], v21, s[4:7], s82 offen offset:512 sc1
    buffer_store_dwordx4 v[16:19], v20, s[4:7], s82 offen sc1
    s_sub_u32 s82, s82, 294912
    v_mfma_f32_16x16x32_bf16 v[72:75], a[208:211], v[120:123], v[72:75]
    ds_read_b128 v[96:99], v14 offset:3072
    v_mfma_f32_16x16x32_bf16 v[76:79], a[212:215], v[120:123], v[76:79]
    s_waitcnt lgkmcnt(8)
    v_mfma_f32_16x16x32_bf16 v[56:59], a[216:219], v[80:83], v[56:59]
    buffer_load_dwordx4 a[128:131], v1, s[4:7], s60 offen offset:2048 sc1
    v_mfma_f32_16x16x32_bf16 v[60:63], a[220:223], v[80:83], v[60:63]
    ds_read_b128 v[100:103], v14 offset:3088
    ds_read_b128 a[84:87], v10 offset:44032
    v_mfma_f32_16x16x32_bf16 v[64:67], a[224:227], v[80:83], v[64:67]
    s_waitcnt lgkmcnt(8)
    v_mfma_f32_16x16x32_bf16 v[68:71], a[216:219], v[84:87], v[68:71]
    buffer_load_dwordx4 a[132:135], v1, s[4:7], s60 offen offset:3072 sc1
    v_mfma_f32_16x16x32_bf16 v[72:75], a[220:223], v[84:87], v[72:75]
    ds_read_b128 v[104:107], v14 offset:3584
    ds_read_b128 a[88:91], v10 offset:45056
    v_mfma_f32_16x16x32_bf16 v[76:79], a[224:227], v[84:87], v[76:79]
    s_waitcnt lgkmcnt(8)
    v_mfma_f32_16x16x32_bf16 v[56:59], a[228:231], v[88:91], v[56:59]
    v_mfma_f32_16x16x32_bf16 v[60:63], a[232:235], v[88:91], v[60:63]
    ds_read_b128 v[108:111], v14 offset:3600
    ds_read_b128 a[92:95], v10 offset:46080
    v_mfma_f32_16x16x32_bf16 v[64:67], a[236:239], v[88:91], v[64:67]
    s_waitcnt lgkmcnt(8)
    v_mfma_f32_16x16x32_bf16 v[68:71], a[228:231], v[92:95], v[68:71]
    s_add_u32 s60, s60, 4096
    buffer_load_dwordx4 a[136:139], v1, s[4:7], s60 offen offset:0 sc1
    v_mfma_f32_16x16x32_bf16 v[72:75], a[232:235], v[92:95], v[72:75]
    ds_read_b128 a[96:99], v10 offset:47104
    v_mfma_f32_16x16x32_bf16 v[76:79], a[236:239], v[92:95], v[76:79]
    s_waitcnt lgkmcnt(7)
    v_mfma_f32_16x16x32_bf16 v[56:59], v[128:131], v[96:99], v[56:59]
    buffer_load_dwordx4 a[140:143], v1, s[4:7], s60 offen offset:1024 sc1
    v_mfma_f32_16x16x32_bf16 v[60:63], v[132:135], v[96:99], v[60:63]
    ds_read_b128 a[100:103], v10 offset:48128
    v_mfma_f32_16x16x32_bf16 v[64:67], v[136:139], v[96:99], v[64:67]
    s_waitcnt lgkmcnt(5)
    v_mfma_f32_16x16x32_bf16 v[68:71], v[128:131], v[104:107], v[68:71]
    v_mfma_f32_16x16x32_bf16 v[72:75], v[132:135], v[104:107], v[72:75]
    v_mfma_f32_16x16x32_bf16 v[76:79], v[136:139], v[104:107], v[76:79]
    buffer_load_dwordx4 a[144:147], v1, s[4:7], s60 offen offset:2048 sc1
    buffer_load_dwordx4 a[148:151], v1, s[4:7], s60 offen offset:3072 sc1
    s_mul_i32 s76, s3, 5120
    s_add_u32 s76, s76, 81920
    v_lshrrev_b32 v9, 2, v3
    v_and_b32 v9, 12, v9
    v_add_u32 v9, v9, v3
    v_and_b32 v9, 15, v9
    v_and_or_b32 v9, v3, 48, v9
    v_lshl_add_u32 v8, v9, 4, s76
    s_mul_i32 s76, s3, 20480
    s_add_u32 s76, s76, 81920
    s_waitcnt vmcnt(14)
    v_mfma_f32_16x16x32_bf16 v[32:35], a[32:35], a[104:107], 0
    v_mfma_f32_16x16x32_bf16 v[36:39], a[36:39], a[104:107], 0
    v_mfma_f32_16x16x32_bf16 v[40:43], a[40:43], a[104:107], 0
    s_add_u32 s75, s42, 2
    s_waitcnt vmcnt(8)
    v_subrev_u32 v12, s75, v12
    v_cmp_lt_u32 vcc, 5, v12
    s_nop 0
    s_cmp_lg_u64 vcc, 0
    s_cbranch_scc1 .Lrcs_26
.Lrcb_25:
    v_mfma_f32_16x16x32_bf16 v[44:47], a[44:47], a[104:107], 0
    buffer_load_dwordx4 a[152:155], v1, s[4:7], s61 offen offset:0 sc1
    v_mul_f32 v112, v56, v56
    v_mul_f32 v113, v57, v57
    v_fma_f32 v112, v112, v101, v100
    v_mfma_f32_16x16x32_bf16 v[48:51], a[48:51], a[104:107], 0
    v_fma_f32 v113, v113, v101, v100
    v_mul_f32 v112, v112, v56
    v_exp_f32 v112, v112
    v_mfma_f32_16x16x32_bf16 v[32:35], a[52:55], a[108:111], v[32:35]
    v_mul_f32 v113, v113, v57
    v_exp_f32 v113, v113
    v_mul_f32 v56, v56, v58
    v_mfma_f32_16x16x32_bf16 v[36:39], a[56:59], a[108:111], v[36:39]
    buffer_load_dwordx4 a[156:159], v1, s[4:7], s61 offen offset:1024 sc1
    v_mul_f32 v114, v68, v68
    v_fma_f32 v112, v112, v102, v102
    v_mul_f32 v115, v69, v69
    v_mfma_f32_16x16x32_bf16 v[40:43], a[60:63], a[108:111], v[40:43]
    v_rcp_f32 v112, v112
    v_fma_f32 v113, v113, v102, v102
    s_waitcnt lgkmcnt(3)
    v_fma_f32 v114, v114, v109, v108
    v_mfma_f32_16x16x32_bf16 v[44:47], a[64:67], a[108:111], v[44:47]
    v_rcp_f32 v113, v113
    v_fma_f32 v115, v115, v109, v108
    v_mul_f32 v114, v114, v68
    v_mfma_f32_16x16x32_bf16 v[48:51], a[68:71], a[108:111], v[48:51]
    v_exp_f32 v114, v114
    v_mul_f32 v57, v57, v59
    v_mul_f32 v115, v115, v69
    v_mfma_f32_16x16x32_bf16 v[32:35], v[152:155], a[112:115], v[32:35]
    buffer_load_dwordx4 a[160:163], v1, s[4:7], s61 offen offset:2048 sc1
    v_exp_f32 v115, v115
    v_mul_f32 v56, v56, v112
    v_mfma_f32_16x16x32_bf16 v[36:39], v[156:159], a[112:115], v[36:39]
    v_mul_f32 v57, v57, v113
    v_cvt_pk_bf16_f32 v16, v56, v57
    v_mul_f32 v68, v68, v70
    v_mul_f32 v112, v60, v60
    v_mfma_f32_16x16x32_bf16 v[40:43], v[160:163], a[112:115], v[40:43]
    v_fma_f32 v114, v114, v110, v110
    v_rcp_f32 v114, v114
    v_mul_f32 v113, v61, v61
    v_mfma_f32_16x16x32_bf16 v[44:47], v[164:167], a[112:115], v[44:47]
    v_fma_f32 v115, v115, v110, v110
    v_rcp_f32 v115, v115
    v_fma_f32 v112, v112, v101, v100
    v_mfma_f32_16x16x32_bf16 v[48:51], v[168:171], a[112:115], v[48:51]
    buffer_load_dwordx4 a[164:167], v1, s[4:7], s61 offen offset:3072 sc1
    v_fma_f32 v113, v113, v101, v100
    v_mul_f32 v112, v112, v60
    v_mul_f32 v69, v69, v71
    v_mfma_f32_16x16x32_bf16 v[32:35], v[172:175], a[116:119], v[32:35]
    v_exp_f32 v112, v112
    v_mul_f32 v113, v113, v61
    v_mul_f32 v68, v68, v114
    v_mfma_f32_16x16x32_bf16 v[36:39], v[176:179], a[116:119], v[36:39]
    v_exp_f32 v113, v113
    v_mul_f32 v69, v69, v115
    v_cvt_pk_bf16_f32 v18, v68, v69
    v_mfma_f32_16x16x32_bf16 v[40:43], v[180:183], a[116:119], v[40:43]
    s_add_u32 s61, s61, 4096
    buffer_load_dwordx4 a[168:171], v1, s[4:7], s61 offen offset:0 sc1
    v_mul_f32 v60, v60, v62
    v_mul_f32 v114, v72, v72
    v_fma_f32 v112, v112, v102, v102
    v_mfma_f32_16x16x32_bf16 v[44:47], v[184:187], a[116:119], v[44:47]
    v_rcp_f32 v112, v112
    v_mul_f32 v115, v73, v73
    v_fma_f32 v113, v113, v102, v102
    v_mfma_f32_16x16x32_bf16 v[48:51], v[188:191], a[116:119], v[48:51]
    v_rcp_f32 v113, v113
    v_fma_f32 v114, v114, v109, v108
    v_fma_f32 v115, v115, v109, v108
    v_mfma_f32_16x16x32_bf16 v[32:35], v[192:195], a[120:123], v[32:35]
    v_mul_f32 v114, v114, v72
    v_exp_f32 v114, v114
    v_mul_f32 v61, v61, v63
    v_mfma_f32_16x16x32_bf16 v[36:39], v[196:199], a[120:123], v[36:39]
    buffer_load_dwordx4 a[172:175], v1, s[4:7], s61 offen offset:1024 sc1
    v_mul_f32 v115, v115, v73
    v_exp_f32 v115, v115
    v_mfma_f32_16x16x32_bf16 v[40:43], v[200:203], a[120:123], v[40:43]
    v_mul_f32 v60, v60, v112
    v_mul_f32 v61, v61, v113
    v_cvt_pk_bf16_f32 v17, v60, v61
    v_mul_f32 v72, v72, v74
    v_mfma_f32_16x16x32_bf16 v[44:47], v[204:207], a[120:123], v[44:47]
    v_mul_f32 v112, v64, v64
    v_fma_f32 v114, v114, v110, v110
    v_rcp_f32 v114, v114
    v_mfma_f32_16x16x32_bf16 v[48:51], v[208:211], a[120:123], v[48:51]
    v_mul_f32 v113, v65, v65
    v_fma_f32 v115, v115, v110, v110
    v_rcp_f32 v115, v115
    v_mfma_f32_16x16x32_bf16 v[32:35], v[212:215], a[124:127], v[32:35]
    buffer_load_dwordx4 a[176:179], v1, s[4:7], s61 offen offset:2048 sc1
    v_fma_f32 v112, v112, v101, v100
    v_fma_f32 v113, v113, v101, v100
    v_mul_f32 v112, v112, v64
    v_mfma_f32_16x16x32_bf16 v[36:39], v[216:219], a[124:127], v[36:39]
    v_exp_f32 v112, v112
    v_mul_f32 v73, v73, v75
    v_mul_f32 v113, v113, v65
    v_mfma_f32_16x16x32_bf16 v[40:43], v[220:223], a[124:127], v[40:43]
    v_exp_f32 v113, v113
    v_mul_f32 v72, v72, v114
    v_mul_f32 v73, v73, v115
    v_mfma_f32_16x16x32_bf16 v[44:47], v[224:227], a[124:127], v[44:47]
    buffer_load_dwordx4 a[180:183], v1, s[4:7], s61 offen offset:3072 sc1
    v_add_u32 v5, 1, v5
    s_waitcnt vmcnt(14)
    buffer_store_dword v5, v4, s[4:7], s53 offen offset:2048
    buffer_store_dword v5, v0, s[4:7], s53 offen offset:2048 sc1
    v_mfma_f32_16x16x32_bf16 v[48:51], v[228:231], a[124:127], v[48:51]
    s_waitcnt vmcnt(15)
    v_cvt_pk_bf16_f32 v19, v72, v73
    v_mul_f32 v64, v64, v66
    v_mul_f32 v114, v76, v76
    v_fma_f32 v112, v112, v102, v102
    v_mfma_f32_16x16x32_bf16 v[32:35], v[232:235], a[128:131], v[32:35]
    v_rcp_f32 v112, v112
    v_permlane32_swap_b32 v16, v18
    v_mfma_f32_16x16x32_bf16 v[36:39], v[236:239], a[128:131], v[36:39]
    v_permlane32_swap_b32 v17, v19
    v_mul_f32 v115, v77, v77
    v_fma_f32 v113, v113, v102, v102
    v_mfma_f32_16x16x32_bf16 v[40:43], v[240:243], a[128:131], v[40:43]
    s_add_u32 s61, s61, 4096
    buffer_load_dwordx4 a[184:187], v1, s[4:7], s61 offen offset:0 sc1
    v_rcp_f32 v113, v113
    v_fma_f32 v114, v114, v109, v108
    v_mfma_f32_16x16x32_bf16 v[44:47], v[244:247], a[128:131], v[44:47]
    v_permlane16_swap_b32 v16, v17
    v_permlane16_swap_b32 v18, v19
    v_mfma_f32_16x16x32_bf16 v[48:51], v[248:251], a[128:131], v[48:51]
    s_waitcnt vmcnt(15)
    v_fma_f32 v115, v115, v109, v108
    v_mul_f32 v114, v114, v76
    v_exp_f32 v114, v114
    v_mfma_f32_16x16x32_bf16 v[32:35], v[252:255], a[132:135], v[32:35]
    v_mul_f32 v65, v65, v67
    v_mul_f32 v115, v115, v77
    v_exp_f32 v115, v115
    v_mfma_f32_16x16x32_bf16 v[36:39], a[240:243], a[132:135], v[36:39]
    buffer_load_dwordx4 a[188:191], v1, s[4:7], s61 offen offset:1024 sc1
    v_mul_f32 v64, v64, v112
    v_mul_f32 v65, v65, v113
    v_cvt_pk_bf16_f32 v6, v64, v65
    v_mfma_f32_16x16x32_bf16 v[40:43], a[244:247], a[132:135], v[40:43]
    v_mul_f32 v76, v76, v78
    v_fma_f32 v114, v114, v110, v110
    v_rcp_f32 v114, v114
    v_mfma_f32_16x16x32_bf16 v[44:47], a[248:251], a[132:135], v[44:47]
    v_fma_f32 v115, v115, v110, v110
    v_rcp_f32 v115, v115
    v_mul_f32 v77, v77, v79
    v_mfma_f32_16x16x32_bf16 v[48:51], a[252:255], a[132:135], v[48:51]
    s_waitcnt vmcnt(15)
    buffer_load_dwordx4 a[192:195], v1, s[4:7], s61 offen offset:2048 sc1
    v_mul_f32 v76, v76, v114
    v_mul_f32 v77, v77, v115
    v_cvt_pk_bf16_f32 v7, v76, v77
    v_mfma_f32_16x16x32_bf16 v[32:35], v[124:127], a[136:139], v[32:35]
    s_nop 0
    v_permlane16_swap_b32 v6, v7
    v_mfma_f32_16x16x32_bf16 v[36:39], v[140:143], a[136:139], v[36:39]
    buffer_store_dwordx2 v[6:7], v21, s[4:7], s82 offen offset:512
    v_mfma_f32_16x16x32_bf16 v[40:43], v[144:147], a[136:139], v[40:43]
    buffer_store_dwordx4 v[16:19], v20, s[4:7], s82 offen
    v_mfma_f32_16x16x32_bf16 v[44:47], v[148:151], a[136:139], v[44:47]
    buffer_load_dwordx4 a[196:199], v1, s[4:7], s61 offen offset:3072 sc1
    v_mfma_f32_16x16x32_bf16 v[48:51], a[72:75], a[136:139], v[48:51]
    s_waitcnt vmcnt(18)
    v_mfma_f32_16x16x32_bf16 v[32:35], a[76:79], a[140:143], v[32:35]
    v_mfma_f32_16x16x32_bf16 v[36:39], a[80:83], a[140:143], v[36:39]
    v_mfma_f32_16x16x32_bf16 v[40:43], a[84:87], a[140:143], v[40:43]
    v_mfma_f32_16x16x32_bf16 v[44:47], a[88:91], a[140:143], v[44:47]
    s_waitcnt lgkmcnt(2)
    v_mfma_f32_16x16x32_bf16 v[48:51], a[92:95], a[140:143], v[48:51]
    s_waitcnt vmcnt(17) lgkmcnt(1)
    v_mfma_f32_16x16x32_bf16 v[32:35], a[96:99], a[144:147], v[32:35]
    s_waitcnt lgkmcnt(0)
    v_mfma_f32_16x16x32_bf16 v[36:39], a[100:103], a[144:147], v[36:39]
    v_mfma_f32_16x16x32_bf16 v[40:43], a[0:3], a[144:147], v[40:43]
    v_mfma_f32_16x16x32_bf16 v[44:47], a[4:7], a[144:147], v[44:47]
    v_mfma_f32_16x16x32_bf16 v[48:51], a[8:11], a[144:147], v[48:51]
    s_waitcnt vmcnt(16)
    v_mfma_f32_16x16x32_bf16 v[32:35], a[12:15], a[148:151], v[32:35]
    v_mfma_f32_16x16x32_bf16 v[36:39], a[16:19], a[148:151], v[36:39]
    v_mfma_f32_16x16x32_bf16 v[40:43], a[20:23], a[148:151], v[40:43]
    v_mfma_f32_16x16x32_bf16 v[44:47], a[24:27], a[148:151], v[44:47]
    v_mfma_f32_16x16x32_bf16 v[48:51], a[28:31], a[148:151], v[48:51]
    s_waitcnt vmcnt(15)
    v_mfma_f32_16x16x32_bf16 v[52:55], a[32:35], a[152:155], 0
    buffer_load_dword v12, v13, s[4:7], s74 offen sc1
    v_mfma_f32_16x16x32_bf16 v[56:59], a[36:39], a[152:155], 0
    s_barrier
    v_mfma_f32_16x16x32_bf16 v[60:63], a[40:43], a[152:155], 0
    v_mfma_f32_16x16x32_bf16 v[64:67], a[44:47], a[152:155], 0
    v_mfma_f32_16x16x32_bf16 v[68:71], a[48:51], a[152:155], 0
    s_waitcnt vmcnt(15)
    v_mfma_f32_16x16x32_bf16 v[52:55], a[52:55], a[156:159], v[52:55]
    v_mfma_f32_16x16x32_bf16 v[56:59], a[56:59], a[156:159], v[56:59]
    v_add_u32 v5, 1, v5
    s_waitcnt vmcnt(2)
    buffer_store_dword v5, v4, s[4:7], s53 offen offset:2048
    s_cmp_eq_u32 s43, 0
    s_cbranch_scc1 .Lpubs_28
.Lpubb_27:
    v_mfma_f32_16x16x32_bf16 v[60:63], a[60:63], a[156:159], v[60:63]
    v_mfma_f32_16x16x32_bf16 v[64:67], a[64:67], a[156:159], v[64:67]
    ds_write_b128 v8, v[32:35] offset:0
    v_mfma_f32_16x16x32_bf16 v[68:71], a[68:71], a[156:159], v[68:71]
    v_mfma_f32_16x16x32_bf16 v[52:55], v[152:155], a[160:163], v[52:55]
    v_mfma_f32_16x16x32_bf16 v[56:59], v[156:159], a[160:163], v[56:59]
    v_mfma_f32_16x16x32_bf16 v[60:63], v[160:163], a[160:163], v[60:63]
    v_mfma_f32_16x16x32_bf16 v[64:67], v[164:167], a[160:163], v[64:67]
    v_mfma_f32_16x16x32_bf16 v[68:71], v[168:171], a[160:163], v[68:71]
    v_mfma_f32_16x16x32_bf16 v[52:55], v[172:175], a[164:167], v[52:55]
    v_mfma_f32_16x16x32_bf16 v[56:59], v[176:179], a[164:167], v[56:59]
    ds_write_b128 v8, v[36:39] offset:1024
    v_mfma_f32_16x16x32_bf16 v[60:63], v[180:183], a[164:167], v[60:63]
    v_mfma_f32_16x16x32_bf16 v[64:67], v[184:187], a[164:167], v[64:67]
    v_mfma_f32_16x16x32_bf16 v[68:71], v[188:191], a[164:167], v[68:71]
    v_mfma_f32_16x16x32_bf16 v[52:55], v[192:195], a[168:171], v[52:55]
    v_mfma_f32_16x16x32_bf16 v[56:59], v[196:199], a[168:171], v[56:59]
    v_mfma_f32_16x16x32_bf16 v[60:63], v[200:203], a[168:171], v[60:63]
    v_mfma_f32_16x16x32_bf16 v[64:67], v[204:207], a[168:171], v[64:67]
    v_mfma_f32_16x16x32_bf16 v[68:71], v[208:211], a[168:171], v[68:71]
    s_add_u32 s75, s42, 3
    s_waitcnt vmcnt(1)
    v_subrev_u32 v12, s75, v12
    v_cmp_lt_u32 vcc, 4, v12
    s_nop 0
    s_cmp_lg_u64 vcc, 0
    s_cbranch_scc1 .Lrcs_30
.Lrcb_29:
    v_mfma_f32_16x16x32_bf16 v[52:55], v[212:215], a[172:175], v[52:55]
    ds_write_b128 v8, v[40:43] offset:2048
    buffer_load_dwordx4 a[200:203], v1, s[4:7], s62 offen offset:0 sc1
    v_mfma_f32_16x16x32_bf16 v[56:59], v[216:219], a[172:175], v[56:59]
    v_mfma_f32_16x16x32_bf16 v[60:63], v[220:223], a[172:175], v[60:63]
    buffer_load_dwordx4 a[204:207], v1, s[4:7], s62 offen offset:1024 sc1
    v_mfma_f32_16x16x32_bf16 v[64:67], v[224:227], a[172:175], v[64:67]
    v_mfma_f32_16x16x32_bf16 v[68:71], v[228:231], a[172:175], v[68:71]
    v_mfma_f32_16x16x32_bf16 v[52:55], v[232:235], a[176:179], v[52:55]
    buffer_load_dwordx4 a[208:211], v1, s[4:7], s62 offen offset:2048 sc1
    v_mfma_f32_16x16x32_bf16 v[56:59], v[236:239], a[176:179], v[56:59]
    v_mfma_f32_16x16x32_bf16 v[60:63], v[240:243], a[176:179], v[60:63]
    buffer_load_dwordx4 a[212:215], v1, s[4:7], s62 offen offset:3072 sc1
    v_mfma_f32_16x16x32_bf16 v[64:67], v[244:247], a[176:179], v[64:67]
    ds_write_b128 v8, v[44:47] offset:3072
    v_mfma_f32_16x16x32_bf16 v[68:71], v[248:251], a[176:179], v[68:71]
    v_mfma_f32_16x16x32_bf16 v[52:55], v[252:255], a[180:183], v[52:55]
    s_add_u32 s62, s62, 4096
    buffer_load_dwordx4 a[216:219], v1, s[4:7], s62 offen offset:0 sc1
    v_mfma_f32_16x16x32_bf16 v[56:59], a[240:243], a[180:183], v[56:59]
    v_mfma_f32_16x16x32_bf16 v[60:63], a[244:247], a[180:183], v[60:63]
    buffer_load_dwordx4 a[220:223], v1, s[4:7], s62 offen offset:1024 sc1
    v_mfma_f32_16x16x32_bf16 v[64:67], a[248:251], a[180:183], v[64:67]
    v_mfma_f32_16x16x32_bf16 v[68:71], a[252:255], a[180:183], v[68:71]
    v_mfma_f32_16x16x32_bf16 v[52:55], v[124:127], a[184:187], v[52:55]
    buffer_load_dwordx4 a[224:227], v1, s[4:7], s62 offen offset:2048 sc1
    v_mfma_f32_16x16x32_bf16 v[56:59], v[140:143], a[184:187], v[56:59]
    v_mfma_f32_16x16x32_bf16 v[60:63], v[144:147], a[184:187], v[60:63]
    ds_write_b128 v8, v[48:51] offset:4096
    buffer_load_dwordx4 a[228:231], v1, s[4:7], s62 offen offset:3072 sc1
    v_mfma_f32_16x16x32_bf16 v[64:67], v[148:151], a[184:187], v[64:67]
    v_mfma_f32_16x16x32_bf16 v[68:71], a[72:75], a[184:187], v[68:71]
    v_mfma_f32_16x16x32_bf16 v[52:55], a[76:79], a[188:191], v[52:55]
    s_add_u32 s62, s62, 4096
    buffer_load_dwordx4 a[232:235], v1, s[4:7], s62 offen offset:0 sc1
    v_mfma_f32_16x16x32_bf16 v[56:59], a[80:83], a[188:191], v[56:59]
    buffer_load_dword v12, v13, s[4:7], s74 offen sc1
    v_mfma_f32_16x16x32_bf16 v[60:63], a[84:87], a[188:191], v[60:63]
    buffer_load_dwordx4 a[236:239], v1, s[4:7], s62 offen offset:1024 sc1
    v_mfma_f32_16x16x32_bf16 v[64:67], a[88:91], a[188:191], v[64:67]
    v_mfma_f32_16x16x32_bf16 v[68:71], a[92:95], a[188:191], v[68:71]
    v_mfma_f32_16x16x32_bf16 v[52:55], a[96:99], a[192:195], v[52:55]
    buffer_load_dwordx4 v[112:115], v1, s[4:7], s62 offen offset:2048 sc1
    v_mfma_f32_16x16x32_bf16 v[56:59], a[100:103], a[192:195], v[56:59]
    v_mfma_f32_16x16x32_bf16 v[60:63], a[0:3], a[192:195], v[60:63]
    buffer_load_dwordx4 v[116:119], v1, s[4:7], s62 offen offset:3072 sc1
    v_mfma_f32_16x16x32_bf16 v[64:67], a[4:7], a[192:195], v[64:67]
    v_mfma_f32_16x16x32_bf16 v[68:71], a[8:11], a[192:195], v[68:71]
    v_mfma_f32_16x16x32_bf16 v[52:55], a[12:15], a[196:199], v[52:55]
    v_mfma_f32_16x16x32_bf16 v[56:59], a[16:19], a[196:199], v[56:59]
    v_mfma_f32_16x16x32_bf16 v[60:63], a[20:23], a[196:199], v[60:63]
    v_mfma_f32_16x16x32_bf16 v[64:67], a[24:27], a[196:199], v[64:67]
    v_mfma_f32_16x16x32_bf16 v[68:71], a[28:31], a[196:199], v[68:71]
    s_waitcnt vmcnt(12)
    v_mfma_f32_16x16x32_bf16 v[32:35], a[32:35], a[200:203], 0
    v_mfma_f32_16x16x32_bf16 v[36:39], a[36:39], a[200:203], 0
    v_mfma_f32_16x16x32_bf16 v[40:43], a[40:43], a[200:203], 0
    v_mfma_f32_16x16x32_bf16 v[44:47], a[44:47], a[200:203], 0
    v_mfma_f32_16x16x32_bf16 v[48:51], a[48:51], a[200:203], 0
    s_waitcnt vmcnt(11)
    v_mfma_f32_16x16x32_bf16 v[32:35], a[52:55], a[204:207], v[32:35]
    v_mfma_f32_16x16x32_bf16 v[36:39], a[56:59], a[204:207], v[36:39]
    v_mfma_f32_16x16x32_bf16 v[40:43], a[60:63], a[204:207], v[40:43]
    v_mfma_f32_16x16x32_bf16 v[44:47], a[64:67], a[204:207], v[44:47]
    ds_write_b128 v8, v[52:55] offset:20480
    v_mfma_f32_16x16x32_bf16 v[48:51], a[68:71], a[204:207], v[48:51]
    s_waitcnt vmcnt(10)
    v_mfma_f32_16x16x32_bf16 v[32:35], v[152:155], a[208:211], v[32:35]
    s_add_u32 s75, s42, 4
    s_waitcnt vmcnt(3)
    v_subrev_u32 v12, s75, v12
    v_cmp_lt_u32 vcc, 3, v12
    s_nop 0
    s_cmp_lg_u64 vcc, 0
    s_cbranch_scc1 .Lrcs_32
.Lrcb_31:
    s_cmp_eq_u32 s43, 0
    s_cbranch_scc1 .Lacs_34
.Lacb_33:
    v_mfma_f32_16x16x32_bf16 v[36:39], v[156:159], a[208:211], v[36:39]
    buffer_load_dwordx4 a[104:107], v1, s[4:7], s63 offen offset:0 sc1
    v_mfma_f32_16x16x32_bf16 v[40:43], v[160:163], a[208:211], v[40:43]
    v_mfma_f32_16x16x32_bf16 v[44:47], v[164:167], a[208:211], v[44:47]
    buffer_load_dwordx4 a[108:111], v1, s[4:7], s63 offen offset:1024 sc1
    v_mfma_f32_16x16x32_bf16 v[48:51], v[168:171], a[208:211], v[48:51]
    v_mfma_f32_16x16x32_bf16 v[32:35], v[172:175], a[212:215], v[32:35]
    v_add_u32 v6, 40960, v8
    v_lshrrev_b32 v16, 2, v3
    v_mfma_f32_16x16x32_bf16 v[36:39], v[176:179], a[212:215], v[36:39]
    ds_write_b128 v8, v[56:59] offset:21504
    buffer_load_dwordx4 a[112:115], v1, s[4:7], s63 offen offset:2048 sc1
    v_mfma_f32_16x16x32_bf16 v[40:43], v[180:183], a[212:215], v[40:43]
    v_and_b32 v19, 3, v3
    v_lshl_add_u32 v9, v19, 2, v16
    v_mfma_f32_16x16x32_bf16 v[44:47], v[184:187], a[212:215], v[44:47]
    buffer_load_dwordx4 a[116:119], v1, s[4:7], s63 offen offset:3072 sc1
    v_and_b32 v9, 15, v9
    v_mfma_f32_16x16x32_bf16 v[48:51], v[188:191], a[212:215], v[48:51]
    v_lshl_add_u32 v9, v19, 4, v9
    v_lshl_add_u32 v9, v9, 4, s76
    v_mfma_f32_16x16x32_bf16 v[32:35], v[192:195], a[216:219], v[32:35]
    v_lshl_add_u32 v7, v19, 4, v16
    v_lshlrev_b32 v7, 2, v7
    v_mfma_f32_16x16x32_bf16 v[36:39], v[196:199], a[216:219], v[36:39]
    s_add_u32 s63, s63, 4096
    buffer_load_dwordx4 a[120:123], v1, s[4:7], s63 offen offset:0 sc1
    ds_bpermute_b32 v22, v7, v22
    v_mfma_f32_16x16x32_bf16 v[40:43], v[200:203], a[216:219], v[40:43]
    ds_bpermute_b32 v23, v7, v23
    ds_bpermute_b32 v24, v7, v24
    v_mfma_f32_16x16x32_bf16 v[44:47], v[204:207], a[216:219], v[44:47]
    buffer_load_dwordx4 a[124:127], v1, s[4:7], s63 offen offset:1024 sc1
    ds_bpermute_b32 v25, v7, v25
    v_mfma_f32_16x16x32_bf16 v[48:51], v[208:211], a[216:219], v[48:51]
    ds_bpermute_b32 v26, v7, v26
    ds_bpermute_b32 v27, v7, v27
    v_mfma_f32_16x16x32_bf16 v[32:35], v[212:215], a[220:223], v[32:35]
    ds_write_b128 v8, v[60:63] offset:22528
    v_mfma_f32_16x16x32_bf16 v[36:39], v[216:219], a[220:223], v[36:39]
    buffer_load_dwordx4 a[128:131], v1, s[4:7], s63 offen offset:2048 sc1
    ds_bpermute_b32 v28, v7, v28
    v_mfma_f32_16x16x32_bf16 v[40:43], v[220:223], a[220:223], v[40:43]
    ds_bpermute_b32 v29, v7, v29
    ds_bpermute_b32 v30, v7, v30
    v_mfma_f32_16x16x32_bf16 v[44:47], v[224:227], a[220:223], v[44:47]
    buffer_load_dwordx4 a[132:135], v1, s[4:7], s63 offen offset:3072 sc1
    ds_bpermute_b32 v31, v7, v31
    v_mfma_f32_16x16x32_bf16 v[48:51], v[228:231], a[220:223], v[48:51]
    v_mul_u32_u24 v16, 1280, v16
    v_lshlrev_b32 v18, 4, v19
    v_mfma_f32_16x16x32_bf16 v[32:35], v[232:235], a[224:227], v[32:35]
    v_lshlrev_b32 v19, 3, v19
    v_add_u32 v17, v16, v19
    v_mfma_f32_16x16x32_bf16 v[36:39], v[236:239], a[224:227], v[36:39]
    s_add_u32 s63, s63, 4096
    buffer_load_dwordx4 a[136:139], v1, s[4:7], s63 offen offset:0 sc1
    v_add_u32 v16, v16, v18
    v_mfma_f32_16x16x32_bf16 v[40:43], v[240:243], a[224:227], v[40:43]
    v_add_u32 v18, 77824, v18
    v_add_u32 v19, 77824, v19
    v_mfma_f32_16x16x32_bf16 v[44:47], v[244:247], a[224:227], v[44:47]
    ds_write_b128 v8, v[64:67] offset:23552
    buffer_load_dwordx4 a[140:143], v1, s[4:7], s63 offen offset:1024 sc1
    v_mfma_f32_16x16x32_bf16 v[48:51], v[248:251], a[224:227], v[48:51]
    ds_read_b128 v[128:131], v18 offset:2720
    ds_read_b128 v[132:135], v18 offset:2784
    v_mfma_f32_16x16x32_bf16 v[32:35], v[252:255], a[228:231], v[32:35]
    ds_read_b64 v[136:137], v19 offset:2848
    s_waitcnt lgkmcnt(2)
    v_lshlrev_b32 v92, 16, v128
    v_mfma_f32_16x16x32_bf16 v[36:39], a[240:243], a[228:231], v[36:39]
    buffer_load_dwordx4 a[144:147], v1, s[4:7], s63 offen offset:2048 sc1
    v_and_b32 v93, 0xffff0000, v128
    v_mfma_f32_16x16x32_bf16 v[40:43], a[244:247], a[228:231], v[40:43]
    v_lshlrev_b32 v94, 16, v129
    v_and_b32 v95, 0xffff0000, v129
    v_mfma_f32_16x16x32_bf16 v[44:47], a[248:251], a[228:231], v[44:47]
    buffer_load_dwordx4 a[148:151], v1, s[4:7], s63 offen offset:3072 sc1
    v_lshlrev_b32 v96, 16, v130
    v_mfma_f32_16x16x32_bf16 v[48:51], a[252:255], a[228:231], v[48:51]
    v_and_b32 v97, 0xffff0000, v130
    v_lshlrev_b32 v98, 16, v131
    v_mfma_f32_16x16x32_bf16 v[32:35], v[124:127], a[232:235], v[32:35]
    v_and_b32 v99, 0xffff0000, v131
    s_waitcnt lgkmcnt(1)
    v_lshlrev_b32 v100, 16, v132
    v_mfma_f32_16x16x32_bf16 v[36:39], v[140:143], a[232:235], v[36:39]
    v_and_b32 v101, 0xffff0000, v132
    v_lshlrev_b32 v102, 16, v133
    v_mfma_f32_16x16x32_bf16 v[40:43], v[144:147], a[232:235], v[40:43]
    ds_write_b128 v8, v[68:71] offset:24576
    v_mfma_f32_16x16x32_bf16 v[44:47], v[148:151], a[232:235], v[44:47]
    v_and_b32 v103, 0xffff0000, v133
    v_lshlrev_b32 v104, 16, v134
    v_mfma_f32_16x16x32_bf16 v[48:51], a[72:75], a[232:235], v[48:51]
    s_waitcnt vmcnt(14)
    v_and_b32 v105, 0xffff0000, v134
    v_lshlrev_b32 v106, 16, v135
    v_mfma_f32_16x16x32_bf16 v[32:35], a[76:79], a[236:239], v[32:35]
    v_and_b32 v107, 0xffff0000, v135
    s_waitcnt lgkmcnt(1)
    v_lshlrev_b32 v108, 16, v136
    v_mfma_f32_16x16x32_bf16 v[36:39], a[80:83], a[236:239], v[36:39]
    v_and_b32 v109, 0xffff0000, v136
    v_lshlrev_b32 v110, 16, v137
    v_mfma_f32_16x16x32_bf16 v[40:43], a[84:87], a[236:239], v[40:43]
    v_and_b32 v111, 0xffff0000, v137
    v_lshlrev_b32 v72, 16, v22
    v_mfma_f32_16x16x32_bf16 v[44:47], a[88:91], a[236:239], v[44:47]
    v_and_b32 v73, 0xffff0000, v22
    v_lshlrev_b32 v74, 16, v23
    v_mfma_f32_16x16x32_bf16 v[48:51], a[92:95], a[236:239], v[48:51]
    s_waitcnt vmcnt(13)
    v_and_b32 v75, 0xffff0000, v23
    v_lshlrev_b32 v76, 16, v24
    v_mfma_f32_16x16x32_bf16 v[32:35], a[96:99], v[112:115], v[32:35]
    v_and_b32 v77, 0xffff0000, v24
    v_lshlrev_b32 v78, 16, v25
    v_mfma_f32_16x16x32_bf16 v[36:39], a[100:103], v[112:115], v[36:39]
    v_and_b32 v79, 0xffff0000, v25
    v_lshlrev_b32 v80, 16, v26
    v_mfma_f32_16x16x32_bf16 v[40:43], a[0:3], v[112:115], v[40:43]
    v_and_b32 v81, 0xffff0000, v26
    v_lshlrev_b32 v82, 16, v27
    v_mfma_f32_16x16x32_bf16 v[44:47], a[4:7], v[112:115], v[44:47]
    v_and_b32 v83, 0xffff0000, v27
    v_lshlrev_b32 v84, 16, v28
    v_mfma_f32_16x16x32_bf16 v[48:51], a[8:11], v[112:115], v[48:51]
    s_waitcnt vmcnt(12)
    v_and_b32 v85, 0xffff0000, v28
    v_lshlrev_b32 v86, 16, v29
    v_mfma_f32_16x16x32_bf16 v[32:35], a[12:15], v[116:119], v[32:35]
    v_and_b32 v87, 0xffff0000, v29
    v_lshlrev_b32 v88, 16, v30
    v_mfma_f32_16x16x32_bf16 v[36:39], a[16:19], v[116:119], v[36:39]
.Lisl8:
    s_cbranch_execz .Lwarm_ret
    v_and_b32 v89, 0xffff0000, v30
    v_lshlrev_b32 v90, 16, v31
    v_mfma_f32_16x16x32_bf16 v[40:43], a[20:23], v[116:119], v[40:43]
    v_and_b32 v91, 0xffff0000, v31
    v_mfma_f32_16x16x32_bf16 v[44:47], a[24:27], v[116:119], v[44:47]
    v_mfma_f32_16x16x32_bf16 v[48:51], a[28:31], v[116:119], v[48:51]
    s_waitcnt vmcnt(11)
    v_mfma_f32_16x16x32_bf16 v[52:55], a[32:35], a[104:107], 0
    s_waitcnt vmcnt(10)
    v_mfma_f32_16x16x32_bf16 v[52:55], a[52:55], a[108:111], v[52:55]
    s_waitcnt vmcnt(9)
    v_mfma_f32_16x16x32_bf16 v[52:55], v[152:155], a[112:115], v[52:55]
    s_waitcnt vmcnt(8)
    v_mfma_f32_16x16x32_bf16 v[52:55], v[172:175], a[116:119], v[52:55]
    s_waitcnt vmcnt(7)
    v_mfma_f32_16x16x32_bf16 v[52:55], v[192:195], a[120:123], v[52:55]
    s_waitcnt vmcnt(6)
    v_mfma_f32_16x16x32_bf16 v[52:55], v[212:215], a[124:127], v[52:55]
    s_waitcnt vmcnt(5)
    v_mfma_f32_16x16x32_bf16 v[52:55], v[232:235], a[128:131], v[52:55]
    s_waitcnt vmcnt(4)
    v_mfma_f32_16x16x32_bf16 v[52:55], v[252:255], a[132:135], v[52:55]
    s_waitcnt vmcnt(3)
    v_mfma_f32_16x16x32_bf16 v[52:55], v[124:127], a[136:139], v[52:55]
    s_waitcnt vmcnt(2)
    ds_write_b128 v8, v[32:35] offset:40960
    v_mfma_f32_16x16x32_bf16 v[52:55], a[76:79], a[140:143], v[52:55]
    s_waitcnt vmcnt(1)
    ds_write_b128 v8, v[36:39] offset:41984
    v_mfma_f32_16x16x32_bf16 v[52:55], a[96:99], a[144:147], v[52:55]
    s_waitcnt vmcnt(0)
    v_mfma_f32_16x16x32_bf16 v[52:55], a[12:15], a[148:151], v[52:55]
    ds_write_b128 v8, v[40:43] offset:43008
    v_mfma_f32_16x16x32_bf16 v[56:59], a[36:39], a[104:107], 0
    v_mfma_f32_16x16x32_bf16 v[56:59], a[56:59], a[108:111], v[56:59]
    ds_write_b128 v8, v[44:47] offset:44032
    v_mfma_f32_16x16x32_bf16 v[56:59], v[156:159], a[112:115], v[56:59]
    v_mfma_f32_16x16x32_bf16 v[56:59], v[176:179], a[116:119], v[56:59]
    ds_write_b128 v8, v[48:51] offset:45056
    v_mfma_f32_16x16x32_bf16 v[56:59], v[196:199], a[120:123], v[56:59]
    v_mfma_f32_16x16x32_bf16 v[56:59], v[216:219], a[124:127], v[56:59]
    v_mfma_f32_16x16x32_bf16 v[56:59], v[236:239], a[128:131], v[56:59]
    ds_write_b128 v8, v[52:55] offset:61440
    v_mfma_f32_16x16x32_bf16 v[56:59], a[240:243], a[132:135], v[56:59]
    v_mfma_f32_16x16x32_bf16 v[56:59], v[140:143], a[136:139], v[56:59]
    v_mfma_f32_16x16x32_bf16 v[56:59], a[80:83], a[140:143], v[56:59]
    v_mfma_f32_16x16x32_bf16 v[56:59], a[100:103], a[144:147], v[56:59]
    v_mfma_f32_16x16x32_bf16 v[56:59], a[16:19], a[148:151], v[56:59]
    v_mfma_f32_16x16x32_bf16 v[60:63], a[40:43], a[104:107], 0
    v_mfma_f32_16x16x32_bf16 v[60:63], a[60:63], a[108:111], v[60:63]
    v_mfma_f32_16x16x32_bf16 v[60:63], v[160:163], a[112:115], v[60:63]
    v_mfma_f32_16x16x32_bf16 v[60:63], v[180:183], a[116:119], v[60:63]
    v_mfma_f32_16x16x32_bf16 v[60:63], v[200:203], a[120:123], v[60:63]
    v_mfma_f32_16x16x32_bf16 v[60:63], v[220:223], a[124:127], v[60:63]
    v_mfma_f32_16x16x32_bf16 v[60:63], v[240:243], a[128:131], v[60:63]
    s_nop 0
    ds_write_b128 v8, v[56:59] offset:62464
    v_mfma_f32_16x16x32_bf16 v[60:63], a[244:247], a[132:135], v[60:63]
    v_mfma_f32_16x16x32_bf16 v[60:63], v[144:147], a[136:139], v[60:63]
    v_mfma_f32_16x16x32_bf16 v[60:63], a[84:87], a[140:143], v[60:63]
    v_mfma_f32_16x16x32_bf16 v[60:63], a[0:3], a[144:147], v[60:63]
    v_mfma_f32_16x16x32_bf16 v[60:63], a[20:23], a[148:151], v[60:63]
    v_mfma_f32_16x16x32_bf16 v[64:67], a[44:47], a[104:107], 0
    s_waitcnt lgkmcnt(0)
    s_barrier
    v_mfma_f32_16x16x32_bf16 v[64:67], a[64:67], a[108:111], v[64:67]
    ds_read_b128 v[32:35], v9 offset:0
    ds_read_b128 v[36:39], v9 offset:5120
    v_mfma_f32_16x16x32_bf16 v[64:67], v[164:167], a[112:115], v[64:67]
    ds_read_b128 v[40:43], v9 offset:10240
    ds_read_b128 v[44:47], v9 offset:15360
    v_mfma_f32_16x16x32_bf16 v[64:67], v[184:187], a[116:119], v[64:67]
    ds_read_b128 v[48:51], v9 offset:1024
    ds_read_b128 v[112:115], v9 offset:6144
    v_mfma_f32_16x16x32_bf16 v[64:67], v[204:207], a[120:123], v[64:67]
    ds_read_b128 v[116:119], v9 offset:11264
    ds_read_b128 v[128:131], v9 offset:16384
    v_mfma_f32_16x16x32_bf16 v[64:67], v[224:227], a[124:127], v[64:67]
    v_mfma_f32_16x16x32_bf16 v[64:67], v[244:247], a[128:131], v[64:67]
    ds_write_b128 v8, v[60:63] offset:63488
    v_mfma_f32_16x16x32_bf16 v[64:67], a[248:251], a[132:135], v[64:67]
    v_mfma_f32_16x16x32_bf16 v[64:67], v[148:151], a[136:139], v[64:67]
    v_mfma_f32_16x16x32_bf16 v[64:67], a[88:91], a[140:143], v[64:67]
    v_mfma_f32_16x16x32_bf16 v[64:67], a[4:7], a[144:147], v[64:67]
    v_mfma_f32_16x16x32_bf16 v[64:67], a[24:27], a[148:151], v[64:67]
    v_mfma_f32_16x16x32_bf16 v[68:71], a[48:51], a[104:107], 0
    v_mfma_f32_16x16x32_bf16 v[68:71], a[68:71], a[108:111], v[68:71]
    v_mfma_f32_16x16x32_bf16 v[68:71], v[168:171], a[112:115], v[68:71]
    v_mfma_f32_16x16x32_bf16 v[68:71], v[188:191], a[116:119], v[68:71]
    v_mfma_f32_16x16x32_bf16 v[68:71], v[208:211], a[120:123], v[68:71]
    v_mfma_f32_16x16x32_bf16 v[68:71], v[228:231], a[124:127], v[68:71]
    v_mfma_f32_16x16x32_bf16 v[68:71], v[248:251], a[128:131], v[68:71]
    s_nop 0
    ds_write_b128 v8, v[64:67] offset:64512
    v_mfma_f32_16x16x32_bf16 v[68:71], a[252:255], a[132:135], v[68:71]
    v_mfma_f32_16x16x32_bf16 v[68:71], a[72:75], a[136:139], v[68:71]
    v_mfma_f32_16x16x32_bf16 v[68:71], a[92:95], a[140:143], v[68:71]
    v_mfma_f32_16x16x32_bf16 v[68:71], a[8:11], a[144:147], v[68:71]
    v_mfma_f32_16x16x32_bf16 v[68:71], a[28:31], a[148:151], v[68:71]
    s_nop 7
    ds_write_b128 v6, v[68:71] offset:24576
    s_waitcnt lgkmcnt(0)
    s_barrier
    ds_read_b128 v[160:163], v9 offset:2048
    ds_read_b128 v[164:167], v9 offset:7168
    ds_read_b128 v[168:171], v9 offset:12288
    ds_read_b128 v[172:175], v9 offset:17408
    ds_read_b128 v[176:179], v9 offset:3072
    ds_read_b128 v[180:183], v9 offset:8192
    ds_read_b128 v[184:187], v9 offset:13312
    ds_read_b128 v[188:191], v9 offset:18432
    ds_read_b128 v[192:195], v9 offset:4096
    ds_read_b128 v[196:199], v9 offset:9216
    ds_read_b128 v[200:203], v9 offset:14336
    ds_read_b128 v[204:207], v9 offset:19456
    v_pk_add_f32 v[32:33], v[32:33], v[36:37]
    v_pk_add_f32 v[40:41], v[40:41], v[44:45]
    v_pk_add_f32 v[34:35], v[34:35], v[38:39]
    v_pk_add_f32 v[42:43], v[42:43], v[46:47]
    v_pk_add_f32 v[32:33], v[32:33], v[40:41]
    v_pk_add_f32 v[34:35], v[34:35], v[42:43]
    v_pk_fma_f32 v[32:33], v[32:33], v[92:93], v[72:73]
    v_pk_fma_f32 v[34:35], v[34:35], v[94:95], v[74:75]
    v_cvt_pk_bf16_f32 v22, v32, v33
    v_cvt_pk_bf16_f32 v23, v34, v35
    v_pk_add_f32 v[48:49], v[48:49], v[112:113]
    v_pk_add_f32 v[116:117], v[116:117], v[128:129]
    v_pk_add_f32 v[50:51], v[50:51], v[114:115]
    v_pk_add_f32 v[118:119], v[118:119], v[130:131]
    v_pk_add_f32 v[48:49], v[48:49], v[116:117]
    v_pk_add_f32 v[50:51], v[50:51], v[118:119]
    v_pk_fma_f32 v[48:49], v[48:49], v[96:97], v[76:77]
    v_pk_fma_f32 v[50:51], v[50:51], v[98:99], v[78:79]
    v_cvt_pk_bf16_f32 v24, v48, v49
    v_cvt_pk_bf16_f32 v25, v50, v51
    buffer_store_dwordx4 v[22:25], v16, s[36:39], s90 offen
    s_waitcnt lgkmcnt(10)
    v_pk_add_f32 v[160:161], v[160:161], v[164:165]
    s_waitcnt lgkmcnt(8)
    v_pk_add_f32 v[168:169], v[168:169], v[172:173]
    v_pk_add_f32 v[162:163], v[162:163], v[166:167]
    v_pk_add_f32 v[170:171], v[170:171], v[174:175]
    v_pk_add_f32 v[160:161], v[160:161], v[168:169]
    v_pk_add_f32 v[162:163], v[162:163], v[170:171]
    v_pk_fma_f32 v[160:161], v[160:161], v[100:101], v[80:81]
    v_pk_fma_f32 v[162:163], v[162:163], v[102:103], v[82:83]
    v_cvt_pk_bf16_f32 v26, v160, v161
    v_cvt_pk_bf16_f32 v27, v162, v163
    s_waitcnt lgkmcnt(6)
    v_pk_add_f32 v[176:177], v[176:177], v[180:181]
    s_waitcnt lgkmcnt(4)
    v_pk_add_f32 v[184:185], v[184:185], v[188:189]
    v_pk_add_f32 v[178:179], v[178:179], v[182:183]
    v_pk_add_f32 v[186:187], v[186:187], v[190:191]
    v_pk_add_f32 v[176:177], v[176:177], v[184:185]
    v_pk_add_f32 v[178:179], v[178:179], v[186:187]
    v_pk_fma_f32 v[176:177], v[176:177], v[104:105], v[84:85]
    v_pk_fma_f32 v[178:179], v[178:179], v[106:107], v[86:87]
    v_cvt_pk_bf16_f32 v28, v176, v177
    v_cvt_pk_bf16_f32 v29, v178, v179
    buffer_store_dwordx4 v[26:29], v16, s[36:39], s90 offen offset:64
    s_waitcnt lgkmcnt(2)
    v_pk_add_f32 v[192:193], v[192:193], v[196:197]
    s_waitcnt lgkmcnt(0)
    v_pk_add_f32 v[200:201], v[200:201], v[204:205]
    v_pk_add_f32 v[194:195], v[194:195], v[198:199]
    v_pk_add_f32 v[202:203], v[202:203], v[206:207]
    v_pk_add_f32 v[192:193], v[192:193], v[200:201]
    v_pk_add_f32 v[194:195], v[194:195], v[202:203]
    v_pk_fma_f32 v[192:193], v[192:193], v[108:109], v[88:89]
    v_pk_fma_f32 v[194:195], v[194:195], v[110:111], v[90:91]
    v_cvt_pk_bf16_f32 v30, v192, v193
    v_cvt_pk_bf16_f32 v31, v194, v195
    buffer_store_dwordx2 v[30:31], v17, s[36:39], s90 offen offset:128
.Lend:
    s_endpgm
.Lfallback:
    s_nop 15
    s_waitcnt vmcnt(0)
    s_lshl2_add_u32 s74, s40, s3
    s_min_u32 s75, s74, 7
    v_mov_b32 v69, 0xf149f2ca
    v_cmp_le_i32 s[60:61], 0, v31
    v_cmp_le_i32 s[62:63], 1, v31
    v_cmp_le_i32 s[64:65], 2, v31
    v_cmp_le_i32 s[66:67], 3, v31
    v_cndmask_b32 v32, v69, 0, s[60:61]
    v_cndmask_b32 v33, v69, 0, s[62:63]
    v_cndmask_b32 v34, v69, 0, s[64:65]
    v_cndmask_b32 v35, v69, 0, s[66:67]
    v_cmp_le_i32 s[60:61], 8, v31
    v_cmp_le_i32 s[62:63], 9, v31
    v_cmp_le_i32 s[64:65], 10, v31
    v_cmp_le_i32 s[66:67], 11, v31
    v_cndmask_b32 v36, v69, 0, s[60:61]
    v_cndmask_b32 v37, v69, 0, s[62:63]
    v_cndmask_b32 v38, v69, 0, s[64:65]
    v_cndmask_b32 v39, v69, 0, s[66:67]
    v_cmp_le_i32 s[60:61], 16, v31
    v_cmp_le_i32 s[62:63], 17, v31
    v_cmp_le_i32 s[64:65], 18, v31
    v_cmp_le_i32 s[66:67], 19, v31
    v_cndmask_b32 v40, v69, 0, s[60:61]
    v_cndmask_b32 v41, v69, 0, s[62:63]
    v_cndmask_b32 v42, v69, 0, s[64:65]
    v_cndmask_b32 v43, v69, 0, s[66:67]
    v_cmp_le_i32 s[60:61], 24, v31
    v_cmp_le_i32 s[62:63], 25, v31
    v_cmp_le_i32 s[64:65], 26, v31
    v_cmp_le_i32 s[66:67], 27, v31
    v_cndmask_b32 v44, v69, 0, s[60:61]
    v_cndmask_b32 v45, v69, 0, s[62:63]
    v_cndmask_b32 v46, v69, 0, s[64:65]
    v_cndmask_b32 v47, v69, 0, s[66:67]
    v_mov_b32 v22, 0
    v_mov_b32 v83, 0xff61b1e6
    v_add_u32 v80, 45056, v28
    v_add_u32 v81, 45056, v29
    v_add_u32 v82, 45056, v30
    ds_read_b128 v[136:139], v80 offset:0
    ds_read_b64 v[144:145], v81 offset:2048
    s_waitcnt lgkmcnt(1)
    v_mfma_f32_32x32x16_bf16 v[64:79], v[136:139], v[12:15], v[32:47]
    s_waitcnt lgkmcnt(0)
    v_mfma_f32_32x32x16_bf16 v[64:79], v[144:147], v[20:23], v[64:79]
    s_nop 11
    v_max3_f32 v83, v83, v64, v65
    v_max3_f32 v83, v83, v66, v67
    v_max3_f32 v83, v83, v68, v69
    v_max3_f32 v83, v83, v70, v71
    v_max3_f32 v83, v83, v72, v73
    v_max3_f32 v83, v83, v74, v75
    v_max3_f32 v83, v83, v76, v77
    v_max3_f32 v83, v83, v78, v79
    v_add_u32 v80, 0xffffea00, v80
    v_add_u32 v81, 0xffffea00, v81
    v_add_u32 v82, 0xffffea00, v82
    s_mov_b32 s77, s75
    s_cmp_eq_u32 s77, 0
    s_cbranch_scc1 .Lalx_36
.Lal_35:
    ds_read_b128 v[136:139], v80 offset:0
    ds_read_b64 v[144:145], v81 offset:2048
    s_waitcnt lgkmcnt(1)
    v_mfma_f32_32x32x16_bf16 v[64:79], v[136:139], v[12:15], 0
    s_waitcnt lgkmcnt(0)
    v_mfma_f32_32x32x16_bf16 v[64:79], v[144:147], v[20:23], v[64:79]
    s_nop 11
    v_max3_f32 v83, v83, v64, v65
    v_max3_f32 v83, v83, v66, v67
    v_max3_f32 v83, v83, v68, v69
    v_max3_f32 v83, v83, v70, v71
    v_max3_f32 v83, v83, v72, v73
    v_max3_f32 v83, v83, v74, v75
    v_max3_f32 v83, v83, v76, v77
    v_max3_f32 v83, v83, v78, v79
    v_add_u32 v80, 0xffffea00, v80
    v_add_u32 v81, 0xffffea00, v81
    v_add_u32 v82, 0xffffea00, v82
    s_sub_u32 s77, s77, 1
    s_cmp_lg_u32 s77, 0
    s_cbranch_scc1 .Lal_35
.Lalx_36:
    s_cmp_lt_u32 s74, 8
    s_cbranch_scc1 .Lald_37
    ds_read_b128 v[136:139], v80 offset:0
    ds_read_b64 v[144:145], v81 offset:2048
    s_waitcnt lgkmcnt(1)
    v_mfma_f32_32x32x16_bf16 v[64:79], v[136:139], v[12:15], v[48:63]
    s_waitcnt lgkmcnt(0)
    v_mfma_f32_32x32x16_bf16 v[64:79], v[144:147], v[20:23], v[64:79]
    s_nop 11
    v_max3_f32 v83, v83, v64, v65
    v_max3_f32 v83, v83, v66, v67
    v_max3_f32 v83, v83, v68, v69
    v_max3_f32 v83, v83, v70, v71
    v_max3_f32 v83, v83, v72, v73
    v_max3_f32 v83, v83, v74, v75
    v_max3_f32 v83, v83, v76, v77
    v_max3_f32 v83, v83, v78, v79
    s_nop 1
.Lald_37:
    v_mov_b32 v84, v83
    s_nop 1
    v_permlane32_swap_b32 v83, v84
    v_max_f32 v83, v83, v84
    v_cvt_pk_bf16_f32 v84, -v83, 0
    v_cndmask_b32 v22, 0, v84, s[48:49]
    v_mov_b32 v96, 0
    v_mov_b32 v97, 0
    v_mov_b32 v98, 0
    v_mov_b32 v99, 0
    v_mov_b32 v100, 0
    v_mov_b32 v101, 0
    v_mov_b32 v102, 0
    v_mov_b32 v103, 0
    v_mov_b32 v104, 0
    v_mov_b32 v105, 0
    v_mov_b32 v106, 0
    v_mov_b32 v107, 0
    v_mov_b32 v108, 0
    v_mov_b32 v109, 0
    v_mov_b32 v110, 0
    v_mov_b32 v111, 0
    v_add_u32 v80, 45056, v28
    v_add_u32 v81, 45056, v29
    v_add_u32 v82, 45056, v30
    ds_read_b128 v[136:139], v80 offset:0
    ds_read_b64 v[144:145], v81 offset:2048
    s_waitcnt lgkmcnt(1)
    v_mfma_f32_32x32x16_bf16 v[64:79], v[136:139], v[12:15], v[32:47]
    s_waitcnt lgkmcnt(0)
    v_mfma_f32_32x32x16_bf16 v[64:79], v[144:147], v[20:23], v[64:79]
    ds_read_b64_tr_b16 v[152:153], v82 offset:2560
    ds_read_b64_tr_b16 v[154:155], v82 offset:2944
    ds_read_b64_tr_b16 v[156:157], v82 offset:3328
    ds_read_b64_tr_b16 v[158:159], v82 offset:3712
    s_nop 7
    v_exp_f32 v64, v64
    v_exp_f32 v65, v65
    v_exp_f32 v66, v66
    v_exp_f32 v67, v67
    v_exp_f32 v68, v68
    v_exp_f32 v69, v69
    v_exp_f32 v70, v70
    v_exp_f32 v71, v71
    v_exp_f32 v72, v72
    v_exp_f32 v73, v73
    v_exp_f32 v74, v74
    v_exp_f32 v75, v75
    v_exp_f32 v76, v76
    v_exp_f32 v77, v77
    v_exp_f32 v78, v78
    v_exp_f32 v79, v79
    v_cvt_pk_bf16_f32 v128, v64, v65
    v_cvt_pk_bf16_f32 v129, v66, v67
    v_cvt_pk_bf16_f32 v130, v68, v69
    v_cvt_pk_bf16_f32 v131, v70, v71
    v_cvt_pk_bf16_f32 v132, v72, v73
    v_cvt_pk_bf16_f32 v133, v74, v75
    v_cvt_pk_bf16_f32 v134, v76, v77
    v_cvt_pk_bf16_f32 v135, v78, v79
    s_waitcnt lgkmcnt(2)
    v_mfma_f32_32x32x16_bf16 v[96:111], v[152:155], v[128:131], v[96:111]
    s_waitcnt lgkmcnt(0)
    v_mfma_f32_32x32x16_bf16 v[96:111], v[156:159], v[132:135], v[96:111]
    v_add_u32 v80, 0xffffea00, v80
    v_add_u32 v81, 0xffffea00, v81
    v_add_u32 v82, 0xffffea00, v82
    s_mov_b32 s77, s75
    s_cmp_eq_u32 s77, 0
    s_nop 6
    s_cbranch_scc1 .Lalx_39
.Lal_38:
    ds_read_b128 v[136:139], v80 offset:0
    ds_read_b64 v[144:145], v81 offset:2048
    s_waitcnt lgkmcnt(1)
    v_mfma_f32_32x32x16_bf16 v[64:79], v[136:139], v[12:15], 0
    s_waitcnt lgkmcnt(0)
    v_mfma_f32_32x32x16_bf16 v[64:79], v[144:147], v[20:23], v[64:79]
    ds_read_b64_tr_b16 v[152:153], v82 offset:2560
    ds_read_b64_tr_b16 v[154:155], v82 offset:2944
    ds_read_b64_tr_b16 v[156:157], v82 offset:3328
    ds_read_b64_tr_b16 v[158:159], v82 offset:3712
    s_nop 7
    v_exp_f32 v64, v64
    v_exp_f32 v65, v65
    v_exp_f32 v66, v66
    v_exp_f32 v67, v67
    v_exp_f32 v68, v68
    v_exp_f32 v69, v69
    v_exp_f32 v70, v70
    v_exp_f32 v71, v71
    v_exp_f32 v72, v72
    v_exp_f32 v73, v73
    v_exp_f32 v74, v74
    v_exp_f32 v75, v75
    v_exp_f32 v76, v76
    v_exp_f32 v77, v77
    v_exp_f32 v78, v78
    v_exp_f32 v79, v79
    v_cvt_pk_bf16_f32 v128, v64, v65
    v_cvt_pk_bf16_f32 v129, v66, v67
    v_cvt_pk_bf16_f32 v130, v68, v69
    v_cvt_pk_bf16_f32 v131, v70, v71
    v_cvt_pk_bf16_f32 v132, v72, v73
    v_cvt_pk_bf16_f32 v133, v74, v75
    v_cvt_pk_bf16_f32 v134, v76, v77
    v_cvt_pk_bf16_f32 v135, v78, v79
    s_waitcnt lgkmcnt(2)
    v_mfma_f32_32x32x16_bf16 v[96:111], v[152:155], v[128:131], v[96:111]
    s_waitcnt lgkmcnt(0)
    v_mfma_f32_32x32x16_bf16 v[96:111], v[156:159], v[132:135], v[96:111]
    v_add_u32 v80, 0xffffea00, v80
    v_add_u32 v81, 0xffffea00, v81
    v_add_u32 v82, 0xffffea00, v82
    s_sub_u32 s77, s77, 1
    s_cmp_lg_u32 s77, 0
    s_nop 6
    s_cbranch_scc1 .Lal_38
.Lalx_39:
    s_cmp_lt_u32 s74, 8
    s_cbranch_scc1 .Lald_40
    ds_read_b128 v[136:139], v80 offset:0
    ds_read_b64 v[144:145], v81 offset:2048
    s_waitcnt lgkmcnt(1)
    v_mfma_f32_32x32x16_bf16 v[64:79], v[136:139], v[12:15], v[48:63]
    s_waitcnt lgkmcnt(0)
    v_mfma_f32_32x32x16_bf16 v[64:79], v[144:147], v[20:23], v[64:79]
    ds_read_b64_tr_b16 v[152:153], v82 offset:2560
    ds_read_b64_tr_b16 v[154:155], v82 offset:2944
    ds_read_b64_tr_b16 v[156:157], v82 offset:3328
    ds_read_b64_tr_b16 v[158:159], v82 offset:3712
    s_nop 7
    v_exp_f32 v64, v64
    v_exp_f32 v65, v65
    v_exp_f32 v66, v66
    v_exp_f32 v67, v67
    v_exp_f32 v68, v68
    v_exp_f32 v69, v69
    v_exp_f32 v70, v70
    v_exp_f32 v71, v71
    v_exp_f32 v72, v72
    v_exp_f32 v73, v73
    v_exp_f32 v74, v74
    v_exp_f32 v75, v75
    v_exp_f32 v76, v76
    v_exp_f32 v77, v77
    v_exp_f32 v78, v78
    v_exp_f32 v79, v79
    v_cvt_pk_bf16_f32 v128, v64, v65
    v_cvt_pk_bf16_f32 v129, v66, v67
    v_cvt_pk_bf16_f32 v130, v68, v69
    v_cvt_pk_bf16_f32 v131, v70, v71
    v_cvt_pk_bf16_f32 v132, v72, v73
    v_cvt_pk_bf16_f32 v133, v74, v75
    v_cvt_pk_bf16_f32 v134, v76, v77
    v_cvt_pk_bf16_f32 v135, v78, v79
    s_waitcnt lgkmcnt(2)
    v_mfma_f32_32x32x16_bf16 v[96:111], v[152:155], v[128:131], v[96:111]
    s_waitcnt lgkmcnt(0)
    v_mfma_f32_32x32x16_bf16 v[96:111], v[156:159], v[132:135], v[96:111]
    s_nop 11
.Lald_40:
    v_mov_b32 v26, 0
    v_mov_b32 v83, 0xff61b1e6
    v_add_u32 v80, 45056, v28
    v_add_u32 v81, 45056, v29
    v_add_u32 v82, 45056, v30
    ds_read_b128 v[136:139], v80 offset:1024
    ds_read_b64 v[144:145], v81 offset:2048
    s_waitcnt lgkmcnt(1)
    v_mfma_f32_32x32x16_bf16 v[64:79], v[136:139], v[16:19], v[32:47]
    s_waitcnt lgkmcnt(0)
    v_mfma_f32_32x32x16_bf16 v[64:79], v[144:147], v[24:27], v[64:79]
    s_nop 11
    v_max3_f32 v83, v83, v64, v65
    v_max3_f32 v83, v83, v66, v67
    v_max3_f32 v83, v83, v68, v69
    v_max3_f32 v83, v83, v70, v71
    v_max3_f32 v83, v83, v72, v73
    v_max3_f32 v83, v83, v74, v75
    v_max3_f32 v83, v83, v76, v77
    v_max3_f32 v83, v83, v78, v79
    v_add_u32 v80, 0xffffea00, v80
    v_add_u32 v81, 0xffffea00, v81
    v_add_u32 v82, 0xffffea00, v82
    s_mov_b32 s77, s75
    s_cmp_eq_u32 s77, 0
    s_cbranch_scc1 .Lalx_42
.Lal_41:
    ds_read_b128 v[136:139], v80 offset:1024
    ds_read_b64 v[144:145], v81 offset:2048
    s_waitcnt lgkmcnt(1)
    v_mfma_f32_32x32x16_bf16 v[64:79], v[136:139], v[16:19], 0
    s_waitcnt lgkmcnt(0)
    v_mfma_f32_32x32x16_bf16 v[64:79], v[144:147], v[24:27], v[64:79]
    s_nop 11
    v_max3_f32 v83, v83, v64, v65
    v_max3_f32 v83, v83, v66, v67
    v_max3_f32 v83, v83, v68, v69
    v_max3_f32 v83, v83, v70, v71
    v_max3_f32 v83, v83, v72, v73
    v_max3_f32 v83, v83, v74, v75
    v_max3_f32 v83, v83, v76, v77
    v_max3_f32 v83, v83, v78, v79
    v_add_u32 v80, 0xffffea00, v80
    v_add_u32 v81, 0xffffea00, v81
    v_add_u32 v82, 0xffffea00, v82
    s_sub_u32 s77, s77, 1
    s_cmp_lg_u32 s77, 0
    s_cbranch_scc1 .Lal_41
.Lalx_42:
    s_cmp_lt_u32 s74, 8
    s_cbranch_scc1 .Lald_43
    ds_read_b128 v[136:139], v80 offset:1024
    ds_read_b64 v[144:145], v81 offset:2048
    s_waitcnt lgkmcnt(1)
    v_mfma_f32_32x32x16_bf16 v[64:79], v[136:139], v[16:19], v[48:63]
    s_waitcnt lgkmcnt(0)
    v_mfma_f32_32x32x16_bf16 v[64:79], v[144:147], v[24:27], v[64:79]
    s_nop 11
    v_max3_f32 v83, v83, v64, v65
    v_max3_f32 v83, v83, v66, v67
    v_max3_f32 v83, v83, v68, v69
    v_max3_f32 v83, v83, v70, v71
    v_max3_f32 v83, v83, v72, v73
    v_max3_f32 v83, v83, v74, v75
    v_max3_f32 v83, v83, v76, v77
    v_max3_f32 v83, v83, v78, v79
    s_nop 1
.Lald_43:
    v_mov_b32 v84, v83
    s_nop 1
    v_permlane32_swap_b32 v83, v84
    v_max_f32 v83, v83, v84
    v_cvt_pk_bf16_f32 v84, -v83, 0
    v_cndmask_b32 v26, 0, v84, s[48:49]
    v_mov_b32 v112, 0
    v_mov_b32 v113, 0
    v_mov_b32 v114, 0
    v_mov_b32 v115, 0
    v_mov_b32 v116, 0
    v_mov_b32 v117, 0
    v_mov_b32 v118, 0
    v_mov_b32 v119, 0
    v_mov_b32 v120, 0
    v_mov_b32 v121, 0
    v_mov_b32 v122, 0
    v_mov_b32 v123, 0
    v_mov_b32 v124, 0
    v_mov_b32 v125, 0
    v_mov_b32 v126, 0
    v_mov_b32 v127, 0
    v_add_u32 v80, 45056, v28
    v_add_u32 v81, 45056, v29
    v_add_u32 v82, 45056, v30
    ds_read_b128 v[136:139], v80 offset:1024
    ds_read_b64 v[144:145], v81 offset:2048
    s_waitcnt lgkmcnt(1)
    v_mfma_f32_32x32x16_bf16 v[64:79], v[136:139], v[16:19], v[32:47]
    s_waitcnt lgkmcnt(0)
    v_mfma_f32_32x32x16_bf16 v[64:79], v[144:147], v[24:27], v[64:79]
    ds_read_b64_tr_b16 v[152:153], v82 offset:4096
    ds_read_b64_tr_b16 v[154:155], v82 offset:4480
    ds_read_b64_tr_b16 v[156:157], v82 offset:4864
    ds_read_b64_tr_b16 v[158:159], v82 offset:5248
    s_nop 7
    v_exp_f32 v64, v64
    v_exp_f32 v65, v65
    v_exp_f32 v66, v66
    v_exp_f32 v67, v67
    v_exp_f32 v68, v68
    v_exp_f32 v69, v69
    v_exp_f32 v70, v70
    v_exp_f32 v71, v71
    v_exp_f32 v72, v72
    v_exp_f32 v73, v73
    v_exp_f32 v74, v74
    v_exp_f32 v75, v75
    v_exp_f32 v76, v76
    v_exp_f32 v77, v77
    v_exp_f32 v78, v78
    v_exp_f32 v79, v79
    v_cvt_pk_bf16_f32 v128, v64, v65
    v_cvt_pk_bf16_f32 v129, v66, v67
    v_cvt_pk_bf16_f32 v130, v68, v69
    v_cvt_pk_bf16_f32 v131, v70, v71
    v_cvt_pk_bf16_f32 v132, v72, v73
    v_cvt_pk_bf16_f32 v133, v74, v75
    v_cvt_pk_bf16_f32 v134, v76, v77
    v_cvt_pk_bf16_f32 v135, v78, v79
    s_waitcnt lgkmcnt(2)
    v_mfma_f32_32x32x16_bf16 v[112:127], v[152:155], v[128:131], v[112:127]
    s_waitcnt lgkmcnt(0)
    v_mfma_f32_32x32x16_bf16 v[112:127], v[156:159], v[132:135], v[112:127]
    v_add_u32 v80, 0xffffea00, v80
    v_add_u32 v81, 0xffffea00, v81
    v_add_u32 v82, 0xffffea00, v82
    s_mov_b32 s77, s75
    s_cmp_eq_u32 s77, 0
    s_nop 6
    s_cbranch_scc1 .Lalx_45
.Lal_44:
    ds_read_b128 v[136:139], v80 offset:1024
    ds_read_b64 v[144:145], v81 offset:2048
    s_waitcnt lgkmcnt(1)
    v_mfma_f32_32x32x16_bf16 v[64:79], v[136:139], v[16:19], 0
    s_waitcnt lgkmcnt(0)
    v_mfma_f32_32x32x16_bf16 v[64:79], v[144:147], v[24:27], v[64:79]
    ds_read_b64_tr_b16 v[152:153], v82 offset:4096
    ds_read_b64_tr_b16 v[154:155], v82 offset:4480
    ds_read_b64_tr_b16 v[156:157], v82 offset:4864
    ds_read_b64_tr_b16 v[158:159], v82 offset:5248
    s_nop 7
    v_exp_f32 v64, v64
    v_exp_f32 v65, v65
    v_exp_f32 v66, v66
    v_exp_f32 v67, v67
    v_exp_f32 v68, v68
    v_exp_f32 v69, v69
    v_exp_f32 v70, v70
    v_exp_f32 v71, v71
    v_exp_f32 v72, v72
    v_exp_f32 v73, v73
    v_exp_f32 v74, v74
    v_exp_f32 v75, v75
    v_exp_f32 v76, v76
    v_exp_f32 v77, v77
    v_exp_f32 v78, v78
    v_exp_f32 v79, v79
    v_cvt_pk_bf16_f32 v128, v64, v65
    v_cvt_pk_bf16_f32 v129, v66, v67
    v_cvt_pk_bf16_f32 v130, v68, v69
    v_cvt_pk_bf16_f32 v131, v70, v71
    v_cvt_pk_bf16_f32 v132, v72, v73
    v_cvt_pk_bf16_f32 v133, v74, v75
    v_cvt_pk_bf16_f32 v134, v76, v77
    v_cvt_pk_bf16_f32 v135, v78, v79
    s_waitcnt lgkmcnt(2)
    v_mfma_f32_32x32x16_bf16 v[112:127], v[152:155], v[128:131], v[112:127]
    s_waitcnt lgkmcnt(0)
    v_mfma_f32_32x32x16_bf16 v[112:127], v[156:159], v[132:135], v[112:127]
    v_add_u32 v80, 0xffffea00, v80
    v_add_u32 v81, 0xffffea00, v81
    v_add_u32 v82, 0xffffea00, v82
    s_sub_u32 s77, s77, 1
    s_cmp_lg_u32 s77, 0
    s_nop 6
    s_cbranch_scc1 .Lal_44
.Lalx_45:
    s_cmp_lt_u32 s74, 8
    s_cbranch_scc1 .Lald_46
    ds_read_b128 v[136:139], v80 offset:1024
    ds_read_b64 v[144:145], v81 offset:2048
    s_waitcnt lgkmcnt(1)
    v_mfma_f32_32x32x16_bf16 v[64:79], v[136:139], v[16:19], v[48:63]
    s_waitcnt lgkmcnt(0)
    v_mfma_f32_32x32x16_bf16 v[64:79], v[144:147], v[24:27], v[64:79]
    ds_read_b64_tr_b16 v[152:153], v82 offset:4096
    ds_read_b64_tr_b16 v[154:155], v82 offset:4480
    ds_read_b64_tr_b16 v[156:157], v82 offset:4864
    ds_read_b64_tr_b16 v[158:159], v82 offset:5248
    s_nop 7
    v_exp_f32 v64, v64
    v_exp_f32 v65, v65
    v_exp_f32 v66, v66
    v_exp_f32 v67, v67
    v_exp_f32 v68, v68
    v_exp_f32 v69, v69
    v_exp_f32 v70, v70
    v_exp_f32 v71, v71
    v_exp_f32 v72, v72
    v_exp_f32 v73, v73
    v_exp_f32 v74, v74
    v_exp_f32 v75, v75
    v_exp_f32 v76, v76
    v_exp_f32 v77, v77
    v_exp_f32 v78, v78
    v_exp_f32 v79, v79
    v_cvt_pk_bf16_f32 v128, v64, v65
    v_cvt_pk_bf16_f32 v129, v66, v67
    v_cvt_pk_bf16_f32 v130, v68, v69
    v_cvt_pk_bf16_f32 v131, v70, v71
    v_cvt_pk_bf16_f32 v132, v72, v73
    v_cvt_pk_bf16_f32 v133, v74, v75
    v_cvt_pk_bf16_f32 v134, v76, v77
    v_cvt_pk_bf16_f32 v135, v78, v79
    s_waitcnt lgkmcnt(2)
    v_mfma_f32_32x32x16_bf16 v[112:127], v[152:155], v[128:131], v[112:127]
    s_waitcnt lgkmcnt(0)
    v_mfma_f32_32x32x16_bf16 v[112:127], v[156:159], v[132:135], v[112:127]
    s_nop 11
.Lald_46:
    s_branch .Lfb_ret
.Lrcs_7:
    s_mov_b32 s73, 0
.Lpoll_47:
    s_add_u32 s73, s73, 1
    buffer_load_dwordx4 v[64:67], v1, s[4:7], s60 offen sc1
    buffer_load_dwordx4 v[68:71], v1, s[4:7], s60 offen offset:1024 sc1
    buffer_load_dwordx4 v[72:75], v93, s[4:7], s60 offen offset:2048 sc1
    buffer_load_dwordx4 v[76:79], v1, s[4:7], s61 offen sc1
    buffer_load_dwordx4 v[80:83], v1, s[4:7], s61 offen offset:1024 sc1
    buffer_load_dwordx4 v[84:87], v95, s[4:7], s62 offen sc1
    s_waitcnt vmcnt(0)
    v_xor_b32 v88, s42, v67
    v_xor_b32 v89, s42, v71
    v_xor_b32 v90, s42, v75
    v_or3_b32 v88, v88, v89, v90
    v_xor_b32 v89, s42, v79
    v_xor_b32 v90, s42, v83
    v_or3_b32 v88, v88, v89, v90
    v_xor_b32 v89, s42, v87
    v_or_b32 v88, v88, v89
    v_cmp_ne_u32 vcc, 0, v88
    s_cbranch_vccz 1
    s_sleep 8
    s_cmp_ge_u32 s73, 20000
    s_cbranch_scc1 .Lpollx_48
    s_cmp_lg_u64 vcc, 0
    s_cbranch_scc1 .Lpoll_47
.Lpollx_48:
    s_branch .Lrcb_6
.Lrcs_12:
    s_mov_b32 s73, 0
.Lpoll_49:
    s_add_u32 s73, s73, 1
    s_sleep 4
    buffer_load_dword v31, v30, s[4:7], s75 offen sc1
    s_waitcnt vmcnt(0)
    v_cmp_ne_u32 vcc, s42, v31
    s_cmp_ge_u32 s73, 20000
    s_cbranch_scc1 .Lpollx_50
    s_cmp_lg_u64 vcc, 0
    s_cbranch_scc1 .Lpoll_49
.Lpollx_50:
    s_nop 0
    s_branch .Lrcb_11
.Lpubs_18:
    buffer_wbl2 sc1
    s_waitcnt vmcnt(0)
    buffer_store_dword v5, v0, s[4:7], s53 offen offset:0 sc1
    s_branch .Lpubb_17
.Lacs_22:
    buffer_inv sc1
    s_waitcnt vmcnt(0)
    s_branch .Lacb_21
.Lrcs_24:
    s_mov_b32 s73, 0
.Lpoll_51:
    s_add_u32 s73, s73, 1
    buffer_load_dword v12, v13, s[4:7], s74 offen sc1
    s_waitcnt vmcnt(0)
    v_subrev_u32 v12, s75, v12
    v_cmp_lt_u32 vcc, 6, v12
    s_cmp_ge_u32 s73, 20000
    s_cbranch_scc1 .Lpollx_52
    s_cmp_lg_u64 vcc, 0
    s_cbranch_scc1 .Lpoll_51
.Lpollx_52:
    s_nop 0
    s_branch .Lrcb_23
.Lrcs_26:
    s_mov_b32 s73, 0
.Lpoll_53:
    s_add_u32 s73, s73, 1
    buffer_load_dword v12, v13, s[4:7], s74 offen sc1
    s_waitcnt vmcnt(0)
    v_subrev_u32 v12, s75, v12
    v_cmp_lt_u32 vcc, 5, v12
    s_cmp_ge_u32 s73, 20000
    s_cbranch_scc1 .Lpollx_54
    s_cmp_lg_u64 vcc, 0
    s_cbranch_scc1 .Lpoll_53
.Lpollx_54:
    s_nop 0
    s_branch .Lrcb_25
.Lpubs_28:
    buffer_wbl2 sc1
    s_waitcnt vmcnt(0)
    buffer_store_dword v5, v0, s[4:7], s53 offen offset:2048 sc1
    s_branch .Lpubb_27
.Lrcs_30:
    s_mov_b32 s73, 0
.Lpoll_55:
    s_add_u32 s73, s73, 1
    buffer_load_dword v12, v13, s[4:7], s74 offen sc1
    s_waitcnt vmcnt(0)
    v_subrev_u32 v12, s75, v12
    v_cmp_lt_u32 vcc, 4, v12
    s_cmp_ge_u32 s73, 20000
    s_cbranch_scc1 .Lpollx_56
    s_cmp_lg_u64 vcc, 0
    s_cbranch_scc1 .Lpoll_55
.Lpollx_56:
    s_nop 0
    s_branch .Lrcb_29
.Lrcs_32:
    s_mov_b32 s73, 0
.Lpoll_57:
    s_add_u32 s73, s73, 1
    buffer_load_dword v12, v13, s[4:7], s74 offen sc1
    s_waitcnt vmcnt(0)
    v_subrev_u32 v12, s75, v12
    v_cmp_lt_u32 vcc, 3, v12
    s_cmp_ge_u32 s73, 20000
    s_cbranch_scc1 .Lpollx_58
    s_cmp_lg_u64 vcc, 0
    s_cbranch_scc1 .Lpoll_57
.Lpollx_58:
    s_nop 0
    s_branch .Lrcb_31
.Lacs_34:
    buffer_inv sc1
    s_waitcnt vmcnt(0)
    s_branch .Lacb_33
.Lcode_end:
.section .rodata,"a"
.p2align 6
.amdhsa_kernel adaLN_cond__sliding_block__glu_gated_geglu__prompt_kernel
  .amdhsa_next_free_vgpr 512
  .amdhsa_next_free_sgpr 102
  .amdhsa_accum_offset 256
  .amdhsa_group_segment_fixed_size 0
  .amdhsa_kernarg_size 96
  .amdhsa_user_sgpr_count 2
  .amdhsa_user_sgpr_kernarg_segment_ptr 1
  .amdhsa_system_sgpr_workgroup_id_x 1
.end_amdhsa_kernel
```
